```python
import torch

def _softmax(x, axis=-1):
    return torch.softmax(x, dim=axis)
def _gelu(x):
    return torch.nn.functional.gelu(x, approximate="tanh")
def _silu(x):
    return torch.nn.functional.silu(x)
def _sigmoid(x):
    return torch.sigmoid(x)
def _layernorm(x, axis=-1, eps=1e-5):
    m = x.mean(dim=axis, keepdim=True)
    v = x.var(dim=axis, keepdim=True, unbiased=False)
    return (x - m) / torch.sqrt(v + eps)
def _scatter_add(tgt, idx, src, axis=0):
    return tgt.clone().index_add_(axis, idx, src)
def _segment_sum(src, seg, n):
    out = torch.zeros((n,) + src.shape[1:], dtype=src.dtype)
    return out.index_add_(0, seg, src)
def _pad(x, pw):
    flat = tuple(v for pair in reversed(pw) for v in pair)
    return torch.nn.functional.pad(x, flat)

kernel_name = 'interleave_layers__sliding_local_dilated__geglu_ffn__prompt'

def setup_inputs():

    _w = (lambda a: (lambda t: t.to(torch.bfloat16) if t.is_floating_point() else t)(torch.as_tensor(a)))
    def _A_setup():
        B, S, D = 1, 2048, 512
        return {
            "x": _w((lambda *s: torch.randn(*s, dtype=torch.bfloat16) * 0.05)(B, S, D)),
            "wqkv": _w((lambda *s: torch.randn(*s, dtype=torch.bfloat16) * 0.05)(D, 3 * D)),
            "wo": _w((lambda *s: torch.randn(*s, dtype=torch.bfloat16) * 0.05)(D, D)),
        }
    _A_in = _A_setup()

    def _B_setup():
        B, S, D, F = 1, 2048, 512, 1792
        return {
            "x": _w((lambda *s: torch.randn(*s, dtype=torch.bfloat16) * 0.05)(B, S, D)),
            "w_gate": _w((lambda *s: torch.randn(*s, dtype=torch.bfloat16) * 0.05)(D, F)),
            "w_up": _w((lambda *s: torch.randn(*s, dtype=torch.bfloat16) * 0.05)(D, F)),
            "w_down": _w((lambda *s: torch.randn(*s, dtype=torch.bfloat16) * 0.05)(F, D)),
        }
    _B_in = _B_setup()

    return {
        "A_x": _A_in["x"],
        "A_wqkv": _A_in["wqkv"],
        "A_wo": _A_in["wo"],
        "B_x": _B_in["x"],
        "B_w_gate": _B_in["w_gate"],
        "B_w_up": _B_in["w_up"],
        "B_w_down": _B_in["w_down"],
    }

def reference(A_x, A_wqkv, A_wo, B_x, B_w_gate, B_w_up, B_w_down):
    def _A_ref(x, wqkv, wo):
        B, S, D = x.shape
        H = 32; Dh = D // H
        W, dil = 8, 2
        qkv = (lambda x, *d: x.permute(*d))((x @ wqkv).reshape(B, S, 3, H, Dh), 2, 0, 3, 1, 4)
        q, k, v = qkv[0], qkv[1], qkv[2]
        scale = Dh ** -0.5
        pos = torch.arange(S)
        off = torch.arange(W) * dil
        idx = pos[:, None] - off[None, :]
        mask = idx >= 0
        idx_c = torch.where(mask, idx, 0).reshape(-1)
        kg = k[:, :, idx_c, :].reshape(B, H, S, W, Dh)
        vg = v[:, :, idx_c, :].reshape(B, H, S, W, Dh)
        logits = torch.einsum("bhsd,bhswd->bhsw", q, kg) * scale
        logits = torch.where(mask[None, None, :, :], logits, -1e9)
        attn = _softmax(logits, axis=-1)
        o = torch.einsum("bhsw,bhswd->bhsd", attn, vg)
        return (lambda x, *d: x.permute(*d))(o, 0, 2, 1, 3).reshape(B, S, D) @ wo

    def _B_ref(x, w_gate, w_up, w_down):
        return (_gelu(x @ w_gate) * (x @ w_up)) @ w_down

    x = A_x
    x = x + _A_ref(_layernorm(x, axis=-1), A_wqkv, A_wo)
    x = x + _B_ref(_layernorm(x, axis=-1), B_w_gate, B_w_up, B_w_down)
    x = x + _A_ref(_layernorm(x, axis=-1), A_wqkv, A_wo)
    x = x + _B_ref(_layernorm(x, axis=-1), B_w_gate, B_w_up, B_w_down)
    return x
```

```asm
; @launch grid=(256,1,1) block=(256,1,1) lds=163840
.amdgcn_target "amdgcn-amd-amdhsa--gfx950"
.text
.globl interleave_layers__sliding_local_dilated__geglu_ffn__prompt_kernel
.p2align 8
.type interleave_layers__sliding_local_dilated__geglu_ffn__prompt_kernel,@function
interleave_layers__sliding_local_dilated__geglu_ffn__prompt_kernel:
  s_cmp_ge_u32 s2, 256
  s_cbranch_scc1 L_end
  s_load_dwordx16 s[64:79], s[0:1], 0
  s_load_dwordx4 s[80:83], s[0:1], 64
  s_getpc_b64 s[90:91]
L_pc:
  s_lshr_b32 s4, s2, 3
  s_mul_i32 s5, s4, 2048
  v_mad_u32_u24 v200, v0, 8, s5
  v_and_b32 v200, -4, v200
  global_load_dword v252, v200, s[90:91]
  s_and_b32 s3, s2, 7
  s_lshl_b32 s48, s3, 5
  s_add_u32 s48, s48, s4
  s_lshl_b32 s5, s48, 13
  v_lshl_add_u32 v254, v0, 5, s5
  v_mul_u32_u24 v220, 3, v0
  v_lshrrev_b32 v220, 4, v220
  s_mul_i32 s5, s4, 49152
  v_lshl_add_u32 v220, v220, 10, s5
  s_waitcnt lgkmcnt(0)
  global_load_dword v251, v220, s[66:67] offset:384
  global_load_dword v253, v254, s[64:65]
  s_lshr_b32 s49, s48, 3
  s_and_b32 s50, s48, 7
  v_lshrrev_b32 v201, 6, v0
  v_and_b32 v1, 63, v0
  v_readfirstlane_b32 s53, v201
  v_lshrrev_b32 v202, 3, v1
  v_and_b32 v203, 7, v1
  v_bfe_u32 v204, v1, 4, 1
  v_lshlrev_b32 v208, 1, v204
  v_xor_b32 v208, v203, v208
  v_lshlrev_b32 v208, 4, v208
  v_mul_u32_u24 v209, 3072, v202
  v_add_u32 v185, v209, v208
  v_xor_b32 v186, 64, v185
  v_xor_b32 v208, v203, v202
  v_lshlrev_b32 v208, 4, v208
  v_lshl_add_u32 v187, v202, 10, v208
  s_mul_i32 s54, s3, 4194304
  s_add_u32 s54, s54, 6291456
  s_lshl_b32 s55, s53, 12
  s_lshl_b32 s100, s53, 11
  s_and_b32 s5, s53, 1
  s_lshl_b32 s101, s5, 10
  s_lshl_b32 s3, s50, 7
  s_mul_i32 s58, s53, 49152
  s_add_u32 s58, s58, s3
  s_lshl_b32 s59, s49, 16
  s_lshl_b32 s5, s5, 13
  s_add_u32 s62, s59, s5
  s_lshl_b32 s5, s53, 13
  s_add_u32 s59, s59, s5
  s_cmp_eq_u32 s49, 0
  s_cselect_b32 s5, 0, 16384
  s_sub_u32 s62, s62, s5
  s_and_b32 s89, s49, 3
  s_mul_i32 s85, s89, 393216
  s_add_u32 s85, s85, s58
  s_lshl_b32 s5, s89, 8
  s_add_u32 s86, s59, s5
  s_add_u32 s88, s62, s5
  s_lshr_b32 s51, s48, 4
  s_and_b32 s52, s48, 15
  s_lshl_b32 s3, s51, 5
  s_lshr_b32 s4, s101, 6
  s_add_u32 s3, s3, s4
  s_mul_i32 s3, s3, 3584
  s_mul_i32 s4, s52, 224
  s_add_u32 s22, s3, s4
  v_and_b32 v206, 15, v1
  v_lshrrev_b32 v207, 4, v1
  v_mul_u32_u24 v209, 3584, v207
  v_lshl_add_u32 v188, v206, 4, v209
  s_min_u32 s3, s48, 223
  s_lshl_b32 s27, s3, 13
  s_add_u32 s27, s27, s100
  v_lshlrev_b32 v2, 4, v1
  s_mov_b32 s46, 1835008
  s_mov_b32 s47, 0x20000
  s_mov_b32 s30, 1835008
  s_mov_b32 s31, 0x20000
  s_mov_b32 s10, 2097152
  s_mov_b32 s11, 0x20000
  s_mov_b32 s14, 1572864
  s_mov_b32 s15, 0x20000
  s_waitcnt lgkmcnt(0)
  s_mov_b64 s[8:9], s[64:65]
  s_mov_b64 s[12:13], s[66:67]
  s_lshl_b32 s84, s53, 10
  s_cmp_lt_u32 s53, 2
  s_cselect_b64 s[44:45], s[72:73], s[74:75]
  s_mov_b64 s[28:29], s[76:77]
  s_bitcmp1_b32 8, s89
  s_cbranch_scc0 L_t_1
  s_add_u32 m0, s55, 147456
  s_add_u32 s6, s22, 0
  buffer_load_dwordx4 v188, s[44:47], s6 offen offset:0 nt lds
  s_add_u32 m0, s55, 147456
  s_add_u32 s6, s22, 13312
  buffer_load_dwordx4 v188, s[44:47], s6 offen offset:1024 nt lds
  s_add_u32 m0, s55, 147456
  s_add_u32 s6, s22, 26624
  buffer_load_dwordx4 v188, s[44:47], s6 offen offset:2048 nt lds
  s_add_u32 m0, s55, 147456
  s_add_u32 s6, s22, 39936
  buffer_load_dwordx4 v188, s[44:47], s6 offen offset:3072 nt lds
  s_add_u32 m0, s100, 139264
  s_nop 0
  buffer_load_dwordx4 v2, s[28:31], s27 offen nt lds
  buffer_load_dwordx4 v2, s[28:31], s27 offen offset:1024 nt lds
L_t_1:
  s_add_u32 m0, s100, 0
  s_add_u32 s6, s85, 0
  buffer_load_dwordx4 v185, s[12:15], s6 offen offset:0 lds
  s_add_u32 s6, s85, 23552
  buffer_load_dwordx4 v186, s[12:15], s6 offen offset:1024 lds
  s_add_u32 m0, s100, 8192
  s_add_u32 s6, s85, 1024
  buffer_load_dwordx4 v185, s[12:15], s6 offen offset:0 lds
  s_add_u32 s6, s85, 24576
  buffer_load_dwordx4 v186, s[12:15], s6 offen offset:1024 lds
  s_add_u32 m0, s100, 16384
  s_add_u32 s6, s85, 2048
  buffer_load_dwordx4 v185, s[12:15], s6 offen offset:0 lds
  s_add_u32 s6, s85, 25600
  buffer_load_dwordx4 v186, s[12:15], s6 offen offset:1024 lds
  s_mov_b64 s[16:17], s[68:69]
  s_mov_b32 s18, 524288
  s_mov_b32 s19, 0x20000
  s_mov_b64 s[32:33], s[78:79]
  s_mov_b32 s34, 2097152
  s_mov_b32 s35, 0x20000
  s_mov_b64 s[40:41], s[82:83]
  s_mov_b32 s42, 39845888
  s_mov_b32 s43, 0x20000
  s_load_dword s36, s[40:41], 32768
  s_lshl_b32 s69, s53, 10
  s_and_b32 s83, s53, 1
  s_lshr_b32 s84, s53, 1
  v_lshlrev_b32 v3, 2, v1
  s_and_b32 s3, s48, 31
  s_lshl_b32 s3, s3, 2
  s_add_u32 s67, s54, s3
  s_and_b32 s4, s3, 96
  s_add_u32 s64, s54, s4
  s_and_b32 s4, s3, 64
  s_add_u32 s65, s54, s4
  s_lshl_b32 s4, s52, 6
  s_lshl_b32 s5, s51, 2
  s_add_u32 s87, s4, s5
  v_lshrrev_b32 v205, 5, v1
  v_lshlrev_b32 v208, 2, v204
  v_xor_b32 v208, v203, v208
  v_lshlrev_b32 v208, 4, v208
  v_lshl_add_u32 v4, v202, 10, v208
  s_lshl_b32 s3, s50, 7
  s_lshl_b32 s4, s83, 15
  s_add_u32 s4, s4, s3
  s_lshl_b32 s56, s84, 18
  s_add_u32 s56, s56, s4
  s_mul_i32 s57, s52, 114688
  s_add_u32 s57, s57, s55
  s_add_u32 s57, s57, 4259840
  s_and_b32 s4, s52, 1
  s_lshl_b32 s4, s4, 10
  v_add_u32 v5, s4, v2
  s_mul_i32 s60, s52, 229376
  s_add_u32 s60, s60, s55
  s_add_u32 s60, s60, 589824
  s_and_b32 s39, s48, 31
  s_lshl_b32 s39, s39, 2
  s_add_u32 s39, s39, s53
  s_lshl_b32 s39, s39, 7
  s_lshl_b32 s68, s89, 2
  s_lshl_b32 s61, s89, 16
  s_add_u32 s61, s61, s54
  s_add_u32 s61, s61, s55
  s_add_u32 s61, s61, 262144
  s_movk_i32 s4, 16384
  s_movk_i32 s6, 4096
  s_cmp_eq_u32 s89, 0
  s_cselect_b32 s4, 3948544, s4
  s_cselect_b32 s5, 4194208, 32
  s_cselect_b32 s6, 4165632, s6
  s_mov_b32 s71, 0x7f800000
  s_cmp_eq_u32 s49, 0
  s_cselect_b32 s4, 0, s4
  s_cselect_b32 s5, 0, s5
  s_cselect_b32 s6, 0, s6
  s_cselect_b32 s71, 0xf149f2ca, s71
  s_cselect_b32 s4, 4294918144, s4
  s_cselect_b32 s6, 4294963200, s6
  s_sub_u32 s63, s61, s4
  s_add_u32 s63, s63, 1048576
  s_sub_u32 s66, s64, s5
  s_and_b32 s66, s66, 0xffffffdf
  s_and_b32 s5, s66, 127
  s_mul_i32 s5, s5, 31
  s_add_u32 s66, s66, s5
  s_add_u32 s66, s66, 4096
  s_lshl_b32 s3, s89, 13
  s_add_u32 s3, s3, s54
  s_add_u32 s3, s3, 65536
  s_sub_u32 s70, s3, s6
  s_lshl_b32 s82, s49, 16
  s_lshl_b32 s3, s83, 15
  s_add_u32 s82, s82, s3
  s_lshl_b32 s3, s50, 7
  s_add_u32 s82, s82, s3
  s_lshl_b32 s3, s84, 6
  s_add_u32 s82, s82, s3
  v_and_b32 v208, 31, v1
  v_lshlrev_b32 v13, 4, v208
  v_add_u32 v13, 151552, v13
  v_lshlrev_b32 v208, 10, v208
  v_lshl_add_u32 v15, v205, 5, v208
  v_lshlrev_b32 v208, 4, v206
  v_lshl_add_u32 v209, v205, 8, v208
  v_lshl_add_u32 v10, v204, 14, v209
  v_lshl_add_u32 v14, v204, 3, v209
  v_mul_u32_u24 v210, 57344, v204
  v_add_u32 v11, v210, v209
  v_lshlrev_b32 v16, 5, v1
  s_add_u32 s24, s68, s53
  s_lshl_b32 s24, s24, 14
  s_lshl_b32 s3, s50, 11
  s_add_u32 s24, s24, s3
  s_add_u32 s24, s24, s54
  s_lshl_b32 s25, s89, 13
  s_lshl_b32 s3, s83, 12
  s_add_u32 s25, s25, s3
  s_lshl_b32 s3, s50, 9
  s_add_u32 s25, s25, s3
  s_lshl_b32 s3, s84, 8
  s_add_u32 s25, s25, s3
  s_add_u32 s25, s25, s54
  s_getreg_b32 s23, hwreg(HW_REG_XCC_ID, 0, 4)
  v_lshl_add_u32 v208, v206, 4, s52
  s_and_b32 s3, s48, 0xe0
  s_sub_u32 s3, s3, 32
  v_add_u32 v209, s3, v1
  v_cmp_le_u32 vcc, 32, v1
  s_nop 1
  v_cndmask_b32 v208, v208, v209, vcc
  v_lshlrev_b32 v27, 7, v208
  v_lshlrev_b32 v17, 2, v206
  v_bfe_u32 v211, v1, 2, 2
  v_and_b32 v212, 3, v1
  v_and_b32 v216, 1, v1
  v_lshrrev_b32 v214, 1, v212
  v_lshl_add_u32 v213, v216, 2, v214
  v_lshl_add_u32 v213, v204, 1, v213
  v_lshl_add_u32 v215, v205, 3, v211
  s_lshl_b32 s3, s84, 13
  v_lshlrev_b32 v208, 7, v215
  v_lshl_add_u32 v208, v213, 3, v208
  v_add_u32 v208, s3, v208
  v_lshrrev_b32 v217, 1, v211
  v_xor_b32 v209, s84, v217
  v_lshl_add_u32 v8, v209, 6, v208
  v_min_u32 v9, 1, v0
  v_lshlrev_b32 v9, 31, v9
  v_cmp_eq_u32 s[72:73], 1, v216
  v_cmp_eq_u32 s[80:81], 1, v214
  v_lshl_add_u32 v208, v207, 2, v216
  v_cmp_le_u32 s[74:75], v208, v206
  v_add_u32 v208, 2, v208
  v_cmp_le_u32 s[76:77], v208, v206
  v_cmp_le_u32 s[78:79], 32, v1
  v_mov_b32 v208, 0xffff
  v_mov_b32 v209, 0xffff0000
  v_cndmask_b32 v208, v208, v209, s[72:73]
  v_cndmask_b32 v18, 0, v208, s[74:75]
  v_cndmask_b32 v19, 0, v208, s[76:77]
  v_xor_b32 v20, v208, v18
  v_xor_b32 v21, v208, v19
  v_mov_b32 v28, 0x3f803f80
  v_mov_b32 v29, 0x3f803f80
  v_mov_b32 v30, 0x3f803f80
  v_mov_b32 v31, 0x3f803f80
  v_add_u32 v24, 147456, v17
  v_lshlrev_b32 v25, 4, v207
  v_add_u32 v25, 147456, v25
  v_lshl_add_u32 v208, v216, 1, v214
  v_lshlrev_b32 v208, 3, v208
  v_lshl_add_u32 v208, v215, 8, v208
  v_lshl_add_u32 v208, v204, 13, v208
  s_lshl_b32 s3, s53, 5
  s_add_u32 s3, s3, 147456
  v_add_u32 v182, s3, v208
  s_add_u32 s5, s53, 4
  s_min_u32 s5, s5, 6
  s_lshl_b32 s3, s5, 5
  s_add_u32 s3, s3, 147456
  v_add_u32 v183, s3, v208
  v_and_b32 v184, 124, v3
  s_sub_u32 s99, s60, s55
  s_mul_i32 s3, s51, 6
  s_add_u32 s3, s3, s53
  s_lshl_b32 s4, s51, 1
  s_add_u32 s6, s4, 96
  s_cmp_lt_u32 s53, 3
  s_cselect_b32 s3, s3, s6
  s_cselect_b32 s6, 3, 1
  s_lshl_b32 s96, s3, 10
  s_add_u32 s96, s96, s99
  s_lshl_b32 s6, s6, 10
  s_add_u32 s97, s96, s6
  s_lshl_b32 s3, s5, 5
  s_add_u32 s3, s3, s4
  s_lshl_b32 s98, s3, 10
  s_add_u32 s98, s98, s99
  s_lshl_b32 s3, s87, 8
  s_lshl_b32 s87, s48, 7
  s_add_u32 s3, s3, 327680
  s_lshl_b32 s99, s53, 7
  s_add_u32 s99, s99, s3
  s_lshl_b32 s20, s5, 7
  s_add_u32 s20, s20, s3
  v_lshlrev_b32 v208, 10, v211
  v_lshl_add_u32 v208, v213, 3, v208
  v_lshl_add_u32 v208, v205, 6, v208
  s_lshl_b32 s3, s53, 8
  s_add_u32 s3, s3, 139264
  v_add_u32 v6, s3, v208
  v_lshl_add_u32 v7, v205, 9, v2
  s_min_u32 s3, s48, 223
  s_mul_i32 s4, s3, 4682
  s_lshr_b32 s4, s4, 16
  s_mul_i32 s5, s4, 14
  s_sub_u32 s3, s3, s5
  s_lshl_b32 s21, s3, 13
  s_lshr_b32 s5, s4, 3
  s_mul_i32 s5, s5, 114688
  s_add_u32 s21, s21, s5
  s_and_b32 s5, s4, 6
  s_lshl_b32 s5, s5, 10
  s_add_u32 s21, s21, s5
  s_and_b32 s5, s4, 1
  s_lshl_b32 s5, s5, 9
  s_add_u32 s21, s21, s5
  s_mul_i32 s5, s53, 458752
  s_add_u32 s21, s21, s5
  s_add_u32 s21, s21, 4259840
  s_add_u32 s26, s21, 229376
  v_bfe_u32 v208, v1, 3, 1
  v_xor_b32 v209, v207, v203
  v_lshlrev_b32 v209, 4, v209
  v_lshl_add_u32 v209, v203, 7, v209
  v_lshl_add_u32 v172, v208, 10, v209
  v_add_u32 v172, 24576, v172
  v_xor_b32 v173, 64, v172
  s_lshl_b32 s3, s83, 6
  v_xor_b32 v176, s3, v172
  s_lshl_b32 s3, s84, 12
  v_add_u32 v175, s3, v176
  v_lshl_add_u32 v208, v207, 3, v211
  v_lshlrev_b32 v208, 7, v208
  v_lshl_add_u32 v208, v212, 3, v208
  v_lshl_add_u32 v209, v204, 1, v217
  v_xor_b32 v209, s53, v209
  v_lshl_add_u32 v174, v209, 5, v208
  v_add_u32 v177, 69632, v172
  v_add_u32 v178, 69632, v173
  v_add_u32 v179, 69632, v174
  v_add_u32 v180, 69632, v175
  v_add_u32 v181, 69632, v176
  v_lshlrev_b32 v190, 3, v0
  v_lshrrev_b32 v254, 4, v0
  v_lshlrev_b32 v254, 10, v254
  s_add_u32 m0, s69, 24576
  s_add_u32 s6, s86, 0
  buffer_load_dwordx4 v187, s[8:11], s6 offen lds
  s_add_u32 m0, s69, 28672
  s_add_u32 s6, s86, 32768
  buffer_load_dwordx4 v187, s[8:11], s6 offen lds
  s_add_u32 m0, s101, 32768
  s_add_u32 s6, s88, 0
  buffer_load_dwordx4 v187, s[8:11], s6 offen lds
  s_add_u32 m0, s100, 34816
  s_add_u32 s6, s85, 196608
  buffer_load_dwordx4 v185, s[12:15], s6 offen offset:0 lds
  s_add_u32 s6, s85, 220160
  buffer_load_dwordx4 v186, s[12:15], s6 offen offset:1024 lds
  s_add_u32 m0, s100, 43008
  s_add_u32 s6, s85, 197632
  buffer_load_dwordx4 v185, s[12:15], s6 offen offset:0 lds
  s_add_u32 s6, s85, 221184
  buffer_load_dwordx4 v186, s[12:15], s6 offen offset:1024 lds
  s_add_u32 m0, s100, 51200
  s_add_u32 s6, s85, 198656
  buffer_load_dwordx4 v185, s[12:15], s6 offen offset:0 lds
  s_add_u32 s6, s85, 222208
  buffer_load_dwordx4 v186, s[12:15], s6 offen offset:1024 lds
  s_add_u32 m0, s69, 59392
  s_add_u32 s6, s86, 128
  buffer_load_dwordx4 v187, s[8:11], s6 offen lds
  s_add_u32 m0, s69, 63488
  s_add_u32 s6, s86, 32896
  buffer_load_dwordx4 v187, s[8:11], s6 offen lds
  s_add_u32 m0, s101, 67584
  s_add_u32 s6, s88, 128
  buffer_load_dwordx4 v187, s[8:11], s6 offen lds
  s_cmp_eq_u32 s89, 1
  s_cbranch_scc1 L_var1
  s_cmp_eq_u32 s89, 2
  s_cbranch_scc1 L_var2
  s_cmp_eq_u32 s89, 3
  s_cbranch_scc1 L_var3
  s_add_u32 m0, s100, 69632
  s_add_u32 s6, s58, 393216
  buffer_load_dwordx4 v185, s[12:15], s6 offen offset:0 lds
  s_add_u32 s6, s58, 416768
  buffer_load_dwordx4 v186, s[12:15], s6 offen offset:1024 lds
  s_add_u32 m0, s100, 77824
  s_add_u32 s6, s58, 394240
  buffer_load_dwordx4 v185, s[12:15], s6 offen offset:0 lds
  s_add_u32 s6, s58, 417792
  buffer_load_dwordx4 v186, s[12:15], s6 offen offset:1024 lds
  s_add_u32 m0, s100, 86016
  s_add_u32 s6, s58, 395264
  buffer_load_dwordx4 v185, s[12:15], s6 offen offset:0 lds
  s_add_u32 s6, s58, 418816
  buffer_load_dwordx4 v186, s[12:15], s6 offen offset:1024 lds
  s_add_u32 m0, s69, 94208
  s_add_u32 s6, s59, 256
  buffer_load_dwordx4 v187, s[8:11], s6 offen lds
  s_add_u32 m0, s69, 98304
  s_add_u32 s6, s59, 33024
  buffer_load_dwordx4 v187, s[8:11], s6 offen lds
  s_add_u32 m0, s101, 102400
  s_add_u32 s6, s62, 256
  buffer_load_dwordx4 v187, s[8:11], s6 offen lds
  s_waitcnt vmcnt(18)
  s_waitcnt lgkmcnt(0)
  s_mul_i32 s37, s36, 0x9e3779c1
  s_barrier
  ds_read_b64_tr_b16 a[0:1], v174 offset:0
  ds_read_b64_tr_b16 a[2:3], v174 offset:512
  ds_read_b64_tr_b16 a[4:5], v174 offset:8192
  ds_read_b64_tr_b16 a[6:7], v174 offset:8704
  ds_read_b64_tr_b16 a[8:9], v174 offset:16384
  ds_read_b64_tr_b16 a[10:11], v174 offset:16896
  ds_read_b128 v[192:195], v172 offset:0
  ds_read_b128 v[196:199], v172 offset:2048
  ds_read_b128 v[200:203], v172 offset:4096
  ds_read_b128 v[204:207], v172 offset:6144
  ds_read_b128 v[208:211], v172 offset:8192
  ds_read_b64_tr_b16 a[12:13], v174 offset:4096
  s_waitcnt lgkmcnt(10)
  ds_read_b64_tr_b16 a[14:15], v174 offset:4608
  s_add_u32 m0, s55, 147456
  s_add_u32 s6, s22, 0
  buffer_load_dwordx4 v188, s[44:47], s6 offen offset:0 nt lds
  v_mfma_f32_16x16x32_bf16 v[32:35], a[0:3], v[28:31], 0
  s_waitcnt lgkmcnt(9)
  ds_read_b64_tr_b16 a[16:17], v174 offset:12288
  s_add_u32 m0, s55, 147456
  v_mfma_f32_16x16x32_bf16 v[36:39], a[4:7], v[28:31], 0
  s_waitcnt lgkmcnt(8)
  ds_read_b64_tr_b16 a[18:19], v174 offset:12800
  s_add_u32 s6, s22, 13312
  v_mfma_f32_16x16x32_bf16 v[116:119], v[28:31], a[8:11], 0
  s_waitcnt lgkmcnt(8)
  ds_read_b64_tr_b16 a[20:21], v174 offset:20480
  buffer_load_dwordx4 v188, s[44:47], s6 offen offset:1024 nt lds
  s_add_u32 s23, s23, s37
  s_add_u32 s23, s23, 32
  v_mov_b32 v26, s23
  v_mfma_f32_16x16x32_bf16 v[56:59], a[0:3], v[192:195], 0
  ds_read_b64_tr_b16 a[22:23], v174 offset:20992
  s_add_u32 m0, s55, 147456
  v_mfma_f32_16x16x32_bf16 v[60:63], a[4:7], v[192:195], 0
  ds_read_b128 v[212:215], v173 offset:0
  s_add_u32 s6, s22, 26624
  buffer_load_dwordx4 v188, s[44:47], s6 offen offset:2048 nt lds
  v_mfma_f32_16x16x32_bf16 v[64:67], v[192:195], a[8:11], 0
  s_waitcnt lgkmcnt(6)
  ds_read_b128 v[216:219], v173 offset:2048
  s_add_u32 m0, s55, 147456
  v_mfma_f32_16x16x32_bf16 v[68:71], a[0:3], v[196:199], 0
  ds_read_b128 v[220:223], v173 offset:4096
  s_add_u32 s6, s22, 39936
  v_mfma_f32_16x16x32_bf16 v[72:75], a[4:7], v[196:199], 0
  ds_read_b128 v[224:227], v173 offset:6144
  buffer_load_dwordx4 v188, s[44:47], s6 offen offset:3072 nt lds
  v_mfma_f32_16x16x32_bf16 v[76:79], v[196:199], a[8:11], 0
  ds_read_b128 v[228:231], v173 offset:8192
  s_add_u32 m0, s100, 139264
  v_mfma_f32_16x16x32_bf16 v[80:83], a[0:3], v[200:203], 0
  ds_read_b128 v[232:235], v175 offset:0
  v_mfma_f32_16x16x32_bf16 v[84:87], a[4:7], v[200:203], 0
  ds_read_b128 v[236:239], v175 offset:2048
  buffer_load_dwordx4 v2, s[28:31], s27 offen nt lds
  v_mfma_f32_16x16x32_bf16 v[88:91], v[200:203], a[8:11], 0
  ds_read_b128 v[240:243], v176 offset:8192
  v_mfma_f32_16x16x32_bf16 v[92:95], a[0:3], v[204:207], 0
  v_mfma_f32_16x16x32_bf16 v[96:99], a[4:7], v[204:207], 0
  buffer_load_dwordx4 v2, s[28:31], s27 offen offset:1024 nt lds
  v_mfma_f32_16x16x32_bf16 v[100:103], v[204:207], a[8:11], 0
  s_lshl_b32 s6, s48, 11
  v_mfma_f32_16x16x32_bf16 v[108:111], a[4:7], v[208:211], 0
  v_mfma_f32_16x16x32_bf16 v[112:115], v[208:211], a[8:11], 0
  s_waitcnt lgkmcnt(4)
  buffer_load_dword v253, v190, s[16:19], s6 offen
  s_and_b32 s6, s48, 31
  s_lshl_b32 s6, s6, 14
  buffer_load_dword v252, v254, s[16:19], s6 offen offset:384
  s_add_u32 m0, s100, 104448
  s_add_u32 s6, s58, 589824
  buffer_load_dwordx4 v185, s[12:15], s6 offen offset:0 lds
  v_mfma_f32_16x16x32_bf16 v[32:35], a[12:15], v[28:31], v[32:35]
  s_add_u32 s6, s58, 613376
  v_mfma_f32_16x16x32_bf16 v[36:39], a[16:19], v[28:31], v[36:39]
  v_mfma_f32_16x16x32_bf16 v[116:119], v[28:31], a[20:23], v[116:119]
  buffer_load_dwordx4 v186, s[12:15], s6 offen offset:1024 lds
  v_mfma_f32_16x16x32_bf16 v[56:59], a[12:15], v[212:215], v[56:59]
  s_add_u32 m0, s100, 112640
  s_add_u32 s6, s58, 590848
  v_mfma_f32_16x16x32_bf16 v[60:63], a[16:19], v[212:215], v[60:63]
  v_mfma_f32_16x16x32_bf16 v[64:67], v[212:215], a[20:23], v[64:67]
  buffer_load_dwordx4 v185, s[12:15], s6 offen offset:0 lds
  v_mfma_f32_16x16x32_bf16 v[68:71], a[12:15], v[216:219], v[68:71]
  s_add_u32 s6, s58, 614400
  v_mfma_f32_16x16x32_bf16 v[72:75], a[16:19], v[216:219], v[72:75]
  v_mfma_f32_16x16x32_bf16 v[76:79], v[216:219], a[20:23], v[76:79]
  s_waitcnt vmcnt(20)
  s_barrier
  ds_read_b64_tr_b16 a[24:25], v174 offset:34816
  buffer_load_dwordx4 v186, s[12:15], s6 offen offset:1024 lds
  v_mfma_f32_16x16x32_bf16 v[80:83], a[12:15], v[220:223], v[80:83]
  ds_read_b64_tr_b16 a[26:27], v174 offset:35328
  s_add_u32 m0, s100, 120832
  v_mfma_f32_16x16x32_bf16 v[84:87], a[16:19], v[220:223], v[84:87]
  ds_read_b64_tr_b16 a[28:29], v174 offset:43008
  s_add_u32 s6, s58, 591872
  v_mfma_f32_16x16x32_bf16 v[88:91], v[220:223], a[20:23], v[88:91]
  ds_read_b64_tr_b16 a[30:31], v174 offset:43520
  buffer_load_dwordx4 v185, s[12:15], s6 offen offset:0 lds
  v_mfma_f32_16x16x32_bf16 v[92:95], a[12:15], v[224:227], v[92:95]
  ds_read_b64_tr_b16 a[32:33], v174 offset:51200
  s_add_u32 s6, s58, 615424
  v_mfma_f32_16x16x32_bf16 v[96:99], a[16:19], v[224:227], v[96:99]
  ds_read_b64_tr_b16 a[34:35], v174 offset:51712
  v_mfma_f32_16x16x32_bf16 v[100:103], v[224:227], a[20:23], v[100:103]
  s_waitcnt lgkmcnt(6)
  ds_read_b128 v[120:123], v172 offset:34816
  buffer_load_dwordx4 v186, s[12:15], s6 offen offset:1024 lds
  v_mfma_f32_16x16x32_bf16 v[108:111], a[16:19], v[228:231], v[108:111]
  ds_read_b128 v[124:127], v172 offset:36864
  s_add_u32 m0, s69, 129024
  v_mfma_f32_16x16x32_bf16 v[112:115], v[228:231], a[20:23], v[112:115]
  ds_read_b128 v[128:131], v172 offset:38912
  s_add_u32 s6, s59, 384
  v_mfma_f32_16x16x32_bf16 a[192:195], v[28:31], v[232:235], 0
  ds_read_b128 v[132:135], v172 offset:40960
  buffer_load_dwordx4 v187, s[8:11], s6 offen lds
  v_mfma_f32_16x16x32_bf16 a[204:207], v[232:235], v[232:235], 0
  ds_read_b128 v[136:139], v172 offset:43008
  s_add_u32 m0, s69, 133120
  v_mfma_f32_16x16x32_bf16 a[196:199], v[28:31], v[236:239], 0
  ds_read_b64_tr_b16 a[36:37], v174 offset:38912
  s_add_u32 s6, s59, 33152
  v_mfma_f32_16x16x32_bf16 a[208:211], v[236:239], v[236:239], 0
  ds_read_b64_tr_b16 a[38:39], v174 offset:39424
  buffer_load_dwordx4 v187, s[8:11], s6 offen lds
  v_mfma_f32_16x16x32_bf16 a[200:203], v[28:31], v[240:243], 0
  ds_read_b64_tr_b16 a[40:41], v174 offset:47104
  s_add_u32 m0, s101, 137216
  v_mfma_f32_16x16x32_bf16 a[212:215], v[240:243], v[240:243], 0
  s_waitcnt lgkmcnt(7)
  ds_read_b64_tr_b16 a[42:43], v174 offset:47616
  s_add_u32 s6, s62, 384
  v_mfma_f32_16x16x32_bf16 v[32:35], a[24:27], v[28:31], v[32:35]
  ds_read_b64_tr_b16 a[44:45], v174 offset:55296
  buffer_load_dwordx4 v187, s[8:11], s6 offen lds
  v_mfma_f32_16x16x32_bf16 v[36:39], a[28:31], v[28:31], v[36:39]
  ds_read_b64_tr_b16 a[46:47], v174 offset:55808
  v_mfma_f32_16x16x32_bf16 v[116:119], v[28:31], a[32:35], v[116:119]
  ds_read_b128 v[140:143], v173 offset:34816
  v_mfma_f32_16x16x32_bf16 v[56:59], a[24:27], v[120:123], v[56:59]
  ds_read_b128 v[144:147], v173 offset:36864
  buffer_load_dwordx4 v[244:247], v15, s[8:11], s82 offen
  v_mfma_f32_16x16x32_bf16 v[60:63], a[28:31], v[120:123], v[60:63]
  ds_read_b128 v[148:151], v173 offset:38912
  v_mfma_f32_16x16x32_bf16 v[64:67], v[120:123], a[32:35], v[64:67]
  s_waitcnt lgkmcnt(7)
  ds_read_b128 v[152:155], v173 offset:40960
  v_mfma_f32_16x16x32_bf16 v[68:71], a[24:27], v[124:127], v[68:71]
  ds_read_b128 v[156:159], v173 offset:43008
  buffer_load_dwordx4 v[248:251], v15, s[8:11], s82 offen offset:16
  v_mfma_f32_16x16x32_bf16 v[72:75], a[28:31], v[124:127], v[72:75]
  ds_read_b128 v[160:163], v175 offset:34816
  v_mfma_f32_16x16x32_bf16 v[76:79], v[124:127], a[32:35], v[76:79]
  ds_read_b128 v[164:167], v175 offset:36864
  v_mfma_f32_16x16x32_bf16 v[80:83], a[24:27], v[128:131], v[80:83]
  ds_read_b128 v[168:171], v176 offset:43008
  v_mfma_f32_16x16x32_bf16 v[84:87], a[28:31], v[128:131], v[84:87]
  v_mfma_f32_16x16x32_bf16 v[88:91], v[128:131], a[32:35], v[88:91]
  v_mfma_f32_16x16x32_bf16 v[92:95], a[24:27], v[132:135], v[92:95]
  v_mfma_f32_16x16x32_bf16 v[96:99], a[28:31], v[132:135], v[96:99]
  v_mfma_f32_16x16x32_bf16 v[100:103], v[132:135], a[32:35], v[100:103]
  v_mfma_f32_16x16x32_bf16 v[108:111], a[28:31], v[136:139], v[108:111]
  v_mfma_f32_16x16x32_bf16 v[112:115], v[136:139], a[32:35], v[112:115]
  v_mfma_f32_16x16x32_bf16 v[32:35], a[36:39], v[28:31], v[32:35]
  s_waitcnt lgkmcnt(1)
  v_mfma_f32_16x16x32_bf16 v[36:39], a[40:43], v[28:31], v[36:39]
  v_mfma_f32_16x16x32_bf16 v[116:119], v[28:31], a[44:47], v[116:119]
  v_mfma_f32_16x16x32_bf16 v[56:59], a[36:39], v[140:143], v[56:59]
  v_mfma_f32_16x16x32_bf16 v[60:63], a[40:43], v[140:143], v[60:63]
  v_mfma_f32_16x16x32_bf16 v[64:67], v[140:143], a[44:47], v[64:67]
  v_mfma_f32_16x16x32_bf16 v[68:71], a[36:39], v[144:147], v[68:71]
  v_mfma_f32_16x16x32_bf16 v[72:75], a[40:43], v[144:147], v[72:75]
  v_mfma_f32_16x16x32_bf16 v[76:79], v[144:147], a[44:47], v[76:79]
  s_waitcnt vmcnt(19)
  s_barrier
  ds_read_b64_tr_b16 a[48:49], v179 offset:0
  v_mfma_f32_16x16x32_bf16 v[80:83], a[36:39], v[148:151], v[80:83]
  ds_read_b64_tr_b16 a[50:51], v179 offset:512
  s_add_u32 m0, s100, 0
  s_add_u32 s6, s58, 786432
  buffer_load_dwordx4 v185, s[12:15], s6 offen offset:0 lds
  v_mfma_f32_16x16x32_bf16 v[84:87], a[40:43], v[148:151], v[84:87]
  ds_read_b64_tr_b16 a[52:53], v179 offset:8192
  s_add_u32 s6, s58, 809984
  v_mfma_f32_16x16x32_bf16 v[88:91], v[148:151], a[44:47], v[88:91]
  ds_read_b64_tr_b16 a[54:55], v179 offset:8704
  v_mfma_f32_16x16x32_bf16 v[92:95], a[36:39], v[152:155], v[92:95]
  ds_read_b64_tr_b16 a[56:57], v179 offset:16384
  buffer_load_dwordx4 v186, s[12:15], s6 offen offset:1024 lds
  v_mfma_f32_16x16x32_bf16 v[96:99], a[40:43], v[152:155], v[96:99]
  ds_read_b64_tr_b16 a[58:59], v179 offset:16896
  s_add_u32 m0, s100, 8192
  v_mfma_f32_16x16x32_bf16 v[100:103], v[152:155], a[44:47], v[100:103]
  ds_read_b128 v[192:195], v177 offset:0
  s_add_u32 s6, s58, 787456
  v_mfma_f32_16x16x32_bf16 v[108:111], a[40:43], v[156:159], v[108:111]
  ds_read_b128 v[196:199], v177 offset:2048
  buffer_load_dwordx4 v185, s[12:15], s6 offen offset:0 lds
  v_mfma_f32_16x16x32_bf16 v[112:115], v[156:159], a[44:47], v[112:115]
  ds_read_b128 v[200:203], v177 offset:4096
  s_add_u32 s6, s58, 811008
  v_mfma_f32_16x16x32_bf16 a[192:195], v[28:31], v[160:163], a[192:195]
  ds_read_b128 v[204:207], v177 offset:6144
  v_mfma_f32_16x16x32_bf16 a[204:207], v[160:163], v[160:163], a[204:207]
  ds_read_b128 v[208:211], v177 offset:8192
  buffer_load_dwordx4 v186, s[12:15], s6 offen offset:1024 lds
  v_mfma_f32_16x16x32_bf16 a[196:199], v[28:31], v[164:167], a[196:199]
  ds_read_b64_tr_b16 a[60:61], v179 offset:4096
  s_add_u32 m0, s100, 16384
  v_mfma_f32_16x16x32_bf16 a[208:211], v[164:167], v[164:167], a[208:211]
  s_waitcnt lgkmcnt(7)
  ds_read_b64_tr_b16 a[62:63], v179 offset:4608
  s_add_u32 s6, s58, 788480
  v_mfma_f32_16x16x32_bf16 a[200:203], v[28:31], v[168:171], a[200:203]
  ds_read_b64_tr_b16 a[64:65], v179 offset:12288
  buffer_load_dwordx4 v185, s[12:15], s6 offen offset:0 lds
  v_mfma_f32_16x16x32_bf16 a[212:215], v[168:171], v[168:171], a[212:215]
  ds_read_b64_tr_b16 a[66:67], v179 offset:12800
  s_add_u32 s6, s58, 812032
  v_mfma_f32_16x16x32_bf16 v[32:35], a[48:51], v[28:31], v[32:35]
  ds_read_b64_tr_b16 a[68:69], v179 offset:20480
  v_mfma_f32_16x16x32_bf16 v[36:39], a[52:55], v[28:31], v[36:39]
  s_waitcnt lgkmcnt(7)
  ds_read_b64_tr_b16 a[70:71], v179 offset:20992
  buffer_load_dwordx4 v186, s[12:15], s6 offen offset:1024 lds
  v_mfma_f32_16x16x32_bf16 v[116:119], v[28:31], a[56:59], v[116:119]
  ds_read_b128 v[212:215], v178 offset:0
  s_add_u32 m0, s69, 24576
  v_mfma_f32_16x16x32_bf16 v[56:59], a[48:51], v[192:195], v[56:59]
  ds_read_b128 v[216:219], v178 offset:2048
  s_add_u32 s6, s59, 512
  v_mfma_f32_16x16x32_bf16 v[60:63], a[52:55], v[192:195], v[60:63]
  ds_read_b128 v[220:223], v178 offset:4096
  buffer_load_dwordx4 v187, s[8:11], s6 offen lds
  v_mfma_f32_16x16x32_bf16 v[64:67], v[192:195], a[56:59], v[64:67]
  ds_read_b128 v[224:227], v178 offset:6144
  s_add_u32 m0, s69, 28672
  v_mfma_f32_16x16x32_bf16 v[68:71], a[48:51], v[196:199], v[68:71]
  ds_read_b128 v[228:231], v178 offset:8192
  s_add_u32 s6, s59, 33280
  v_mfma_f32_16x16x32_bf16 v[72:75], a[52:55], v[196:199], v[72:75]
  ds_read_b128 v[232:235], v180 offset:0
  buffer_load_dwordx4 v187, s[8:11], s6 offen lds
  v_mfma_f32_16x16x32_bf16 v[76:79], v[196:199], a[56:59], v[76:79]
  ds_read_b128 v[236:239], v180 offset:2048
  s_add_u32 m0, s101, 32768
  v_mfma_f32_16x16x32_bf16 v[80:83], a[48:51], v[200:203], v[80:83]
  s_waitcnt lgkmcnt(7)
  ds_read_b128 v[240:243], v181 offset:8192
  s_add_u32 s6, s62, 512
  v_mfma_f32_16x16x32_bf16 v[84:87], a[52:55], v[200:203], v[84:87]
  buffer_load_dwordx4 v187, s[8:11], s6 offen lds
  v_mfma_f32_16x16x32_bf16 v[88:91], v[200:203], a[56:59], v[88:91]
  v_mfma_f32_16x16x32_bf16 v[92:95], a[48:51], v[204:207], v[92:95]
  v_mfma_f32_16x16x32_bf16 v[96:99], a[52:55], v[204:207], v[96:99]
  v_mfma_f32_16x16x32_bf16 v[100:103], v[204:207], a[56:59], v[100:103]
  v_mfma_f32_16x16x32_bf16 v[108:111], a[52:55], v[208:211], v[108:111]
  v_mfma_f32_16x16x32_bf16 v[112:115], v[208:211], a[56:59], v[112:115]
  v_mfma_f32_16x16x32_bf16 v[32:35], a[60:63], v[28:31], v[32:35]
  v_mfma_f32_16x16x32_bf16 v[36:39], a[64:67], v[28:31], v[36:39]
  v_mfma_f32_16x16x32_bf16 v[116:119], v[28:31], a[68:71], v[116:119]
  s_waitcnt lgkmcnt(0)
  v_mfma_f32_16x16x32_bf16 v[56:59], a[60:63], v[212:215], v[56:59]
  v_mfma_f32_16x16x32_bf16 v[60:63], a[64:67], v[212:215], v[60:63]
  v_mfma_f32_16x16x32_bf16 v[64:67], v[212:215], a[68:71], v[64:67]
  v_mfma_f32_16x16x32_bf16 v[68:71], a[60:63], v[216:219], v[68:71]
  v_mfma_f32_16x16x32_bf16 v[72:75], a[64:67], v[216:219], v[72:75]
  v_mfma_f32_16x16x32_bf16 v[76:79], v[216:219], a[68:71], v[76:79]
  s_waitcnt vmcnt(11)
  s_barrier
  ds_read_b64_tr_b16 a[72:73], v179 offset:34816
  v_mfma_f32_16x16x32_bf16 v[80:83], a[60:63], v[220:223], v[80:83]
  ds_read_b64_tr_b16 a[74:75], v179 offset:35328
  s_add_u32 m0, s100, 34816
  s_add_u32 s6, s58, 983040
  buffer_load_dwordx4 v185, s[12:15], s6 offen offset:0 lds
  v_mfma_f32_16x16x32_bf16 v[84:87], a[64:67], v[220:223], v[84:87]
  ds_read_b64_tr_b16 a[76:77], v179 offset:43008
  s_add_u32 s6, s58, 1006592
  v_mfma_f32_16x16x32_bf16 v[88:91], v[220:223], a[68:71], v[88:91]
  ds_read_b64_tr_b16 a[78:79], v179 offset:43520
  ds_read_b64_tr_b16 a[216:217], v182 offset:0
  v_mfma_f32_16x16x32_bf16 v[92:95], a[60:63], v[224:227], v[92:95]
  ds_read_b64_tr_b16 a[80:81], v179 offset:51200
  buffer_load_dwordx4 v186, s[12:15], s6 offen offset:1024 lds
  v_mfma_f32_16x16x32_bf16 v[96:99], a[64:67], v[224:227], v[96:99]
  ds_read_b64_tr_b16 a[82:83], v179 offset:51712
  s_add_u32 m0, s100, 43008
  v_mfma_f32_16x16x32_bf16 v[100:103], v[224:227], a[68:71], v[100:103]
  ds_read_b128 v[120:123], v177 offset:34816
  s_add_u32 s6, s58, 984064
  v_mfma_f32_16x16x32_bf16 v[108:111], a[64:67], v[228:231], v[108:111]
  ds_read_b128 v[124:127], v177 offset:36864
  buffer_load_dwordx4 v185, s[12:15], s6 offen offset:0 lds
  v_mfma_f32_16x16x32_bf16 v[112:115], v[228:231], a[68:71], v[112:115]
  ds_read_b128 v[128:131], v177 offset:38912
  s_add_u32 s6, s58, 1007616
  v_mfma_f32_16x16x32_bf16 a[192:195], v[28:31], v[232:235], a[192:195]
  ds_read_b128 v[132:135], v177 offset:40960
  ds_read_b64_tr_b16 a[218:219], v182 offset:1024
  v_mfma_f32_16x16x32_bf16 a[204:207], v[232:235], v[232:235], a[204:207]
  ds_read_b128 v[136:139], v177 offset:43008
  buffer_load_dwordx4 v186, s[12:15], s6 offen offset:1024 lds
  v_mfma_f32_16x16x32_bf16 a[196:199], v[28:31], v[236:239], a[196:199]
  ds_read_b64_tr_b16 a[84:85], v179 offset:38912
  s_add_u32 m0, s100, 51200
  v_mfma_f32_16x16x32_bf16 a[208:211], v[236:239], v[236:239], a[208:211]
  ds_read_b64_tr_b16 a[86:87], v179 offset:39424
  s_add_u32 s6, s58, 985088
  v_mfma_f32_16x16x32_bf16 a[200:203], v[28:31], v[240:243], a[200:203]
  s_waitcnt lgkmcnt(8)
  ds_read_b64_tr_b16 a[88:89], v179 offset:47104
  buffer_load_dwordx4 v185, s[12:15], s6 offen offset:0 lds
  v_mfma_f32_16x16x32_bf16 a[212:215], v[240:243], v[240:243], a[212:215]
  ds_read_b64_tr_b16 a[90:91], v179 offset:47616
  s_add_u32 s6, s58, 1008640
  v_mfma_f32_16x16x32_bf16 v[32:35], a[72:75], v[28:31], v[32:35]
  ds_read_b64_tr_b16 a[92:93], v179 offset:55296
  ds_read_b64_tr_b16 a[220:221], v182 offset:4096
  v_mfma_f32_16x16x32_bf16 v[36:39], a[76:79], v[28:31], v[36:39]
  ds_read_b64_tr_b16 a[94:95], v179 offset:55808
  buffer_load_dwordx4 v186, s[12:15], s6 offen offset:1024 lds
  v_mfma_f32_16x16x32_bf16 v[116:119], v[28:31], a[80:83], v[116:119]
  s_waitcnt lgkmcnt(8)
  ds_read_b128 v[140:143], v178 offset:34816
  s_add_u32 m0, s69, 59392
  v_mfma_f32_16x16x32_bf16 v[56:59], a[72:75], v[120:123], v[56:59]
  ds_read_b128 v[144:147], v178 offset:36864
  s_add_u32 s6, s59, 640
  ds_read_b64_tr_b16 a[222:223], v182 offset:5120
  ds_read_b64_tr_b16 a[224:225], v183 offset:0
  buffer_load_dwordx4 v187, s[8:11], s6 offen lds
  v_mfma_f32_16x16x32_bf16 v[60:63], a[76:79], v[120:123], v[60:63]
  ds_read_b128 v[148:151], v178 offset:38912
  s_add_u32 m0, s69, 63488
  ds_read_b64_tr_b16 a[226:227], v183 offset:1024
  v_mfma_f32_16x16x32_bf16 v[64:67], v[120:123], a[80:83], v[64:67]
  ds_read_b128 v[152:155], v178 offset:40960
  s_add_u32 s6, s59, 33408
  s_waitcnt lgkmcnt(10)
  ds_read_b64_tr_b16 a[228:229], v183 offset:4096
  buffer_load_dwordx4 v187, s[8:11], s6 offen lds
  v_mfma_f32_16x16x32_bf16 v[68:71], a[72:75], v[124:127], v[68:71]
  ds_read_b128 v[156:159], v178 offset:43008
  s_add_u32 m0, s101, 67584
  ds_read_b64_tr_b16 a[230:231], v183 offset:5120
  ds_read_b64_tr_b16 a[248:249], v6 offset:0
  v_mfma_f32_16x16x32_bf16 v[72:75], a[76:79], v[124:127], v[72:75]
  ds_read_b128 v[160:163], v180 offset:34816
  s_add_u32 s6, s62, 640
  buffer_load_dwordx4 v187, s[8:11], s6 offen lds
  s_waitcnt lgkmcnt(10)
  ds_read_b64_tr_b16 a[250:251], v6 offset:4096
  v_mfma_f32_16x16x32_bf16 v[76:79], v[124:127], a[80:83], v[76:79]
  ds_read_b128 v[164:167], v180 offset:36864
  ds_read_b64_tr_b16 a[252:253], v6 offset:128
  ds_read_b64_tr_b16 a[254:255], v6 offset:4224
  v_mfma_f32_16x16x32_bf16 v[80:83], a[72:75], v[128:131], v[80:83]
  ds_read_b128 v[168:171], v181 offset:43008
  buffer_store_dwordx4 a[216:219], v2, s[40:43], s96 offen sc1
  v_mfma_f32_16x16x32_bf16 v[84:87], a[76:79], v[128:131], v[84:87]
  s_waitcnt lgkmcnt(12)
  buffer_store_dwordx4 a[220:223], v2, s[40:43], s97 offen sc1
  v_mfma_f32_16x16x32_bf16 v[88:91], v[128:131], a[80:83], v[88:91]
  s_waitcnt lgkmcnt(10)
  buffer_store_dwordx4 a[224:227], v2, s[40:43], s98 offen sc1
  v_mfma_f32_16x16x32_bf16 v[92:95], a[72:75], v[132:135], v[92:95]
  v_mfma_f32_16x16x32_bf16 v[96:99], a[76:79], v[132:135], v[96:99]
  v_mfma_f32_16x16x32_bf16 v[100:103], v[132:135], a[80:83], v[100:103]
  s_waitcnt lgkmcnt(6)
  buffer_store_dwordx4 a[228:231], v2, s[40:43], s98 offen offset:1024 sc1
  v_mfma_f32_16x16x32_bf16 v[108:111], a[76:79], v[136:139], v[108:111]
  v_mfma_f32_16x16x32_bf16 v[112:115], v[136:139], a[80:83], v[112:115]
  s_waitcnt lgkmcnt(3)
  buffer_store_dwordx4 a[248:251], v7, s[40:43], s21 offen sc1
  v_mfma_f32_16x16x32_bf16 v[32:35], a[84:87], v[28:31], v[32:35]
  s_waitcnt lgkmcnt(1)
  buffer_store_dwordx4 a[252:255], v7, s[40:43], s26 offen sc1
  v_mfma_f32_32x32x16_bf16 a[232:247], v[28:31], a[216:219], 0
  v_mfma_f32_32x32x16_bf16 a[232:247], v[28:31], a[220:223], a[232:247]
  v_mfma_f32_16x16x32_bf16 v[36:39], a[88:91], v[28:31], v[36:39]
  v_mfma_f32_16x16x32_bf16 v[116:119], v[28:31], a[92:95], v[116:119]
  v_mfma_f32_16x16x32_bf16 v[56:59], a[84:87], v[140:143], v[56:59]
  v_mfma_f32_16x16x32_bf16 v[60:63], a[88:91], v[140:143], v[60:63]
  s_nop 7
  buffer_store_dword a232, v184, s[40:43], s99 offen sc1
  v_mfma_f32_32x32x16_bf16 a[232:247], v[28:31], a[224:227], 0
  v_mfma_f32_32x32x16_bf16 a[232:247], v[28:31], a[228:231], a[232:247]
  v_mfma_f32_16x16x32_bf16 v[64:67], v[140:143], a[92:95], v[64:67]
  v_mfma_f32_16x16x32_bf16 v[68:71], a[84:87], v[144:147], v[68:71]
  v_mfma_f32_16x16x32_bf16 v[72:75], a[88:91], v[144:147], v[72:75]
  v_mfma_f32_16x16x32_bf16 v[76:79], v[144:147], a[92:95], v[76:79]
  s_nop 7
  buffer_store_dword a232, v184, s[40:43], s20 offen sc1
  s_waitcnt vmcnt(17)
  s_barrier
  ds_read_b64_tr_b16 a[96:97], v174 offset:0
  v_mfma_f32_16x16x32_bf16 v[80:83], a[84:87], v[148:151], v[80:83]
  ds_read_b64_tr_b16 a[98:99], v174 offset:512
  s_add_u32 m0, s100, 69632
  s_add_u32 s6, s58, 1179648
  buffer_load_dwordx4 v185, s[12:15], s6 offen offset:0 lds
  v_mfma_f32_16x16x32_bf16 v[84:87], a[88:91], v[148:151], v[84:87]
  ds_read_b64_tr_b16 a[100:101], v174 offset:8192
  s_add_u32 s6, s58, 1203200
  v_mfma_f32_16x16x32_bf16 v[88:91], v[148:151], a[92:95], v[88:91]
  ds_read_b64_tr_b16 a[102:103], v174 offset:8704
  v_mfma_f32_16x16x32_bf16 v[92:95], a[84:87], v[152:155], v[92:95]
  ds_read_b64_tr_b16 a[104:105], v174 offset:16384
  buffer_load_dwordx4 v186, s[12:15], s6 offen offset:1024 lds
  v_mfma_f32_16x16x32_bf16 v[96:99], a[88:91], v[152:155], v[96:99]
  ds_read_b64_tr_b16 a[106:107], v174 offset:16896
  s_add_u32 m0, s100, 77824
  v_mfma_f32_16x16x32_bf16 v[100:103], v[152:155], a[92:95], v[100:103]
  ds_read_b128 v[192:195], v172 offset:0
  s_add_u32 s6, s58, 1180672
  v_mfma_f32_16x16x32_bf16 v[108:111], a[88:91], v[156:159], v[108:111]
  ds_read_b128 v[196:199], v172 offset:2048
  buffer_load_dwordx4 v185, s[12:15], s6 offen offset:0 lds
  v_mfma_f32_16x16x32_bf16 v[112:115], v[156:159], a[92:95], v[112:115]
  ds_read_b128 v[200:203], v172 offset:4096
  s_add_u32 s6, s58, 1204224
  v_mfma_f32_16x16x32_bf16 a[192:195], v[28:31], v[160:163], a[192:195]
  ds_read_b128 v[204:207], v172 offset:6144
  v_mfma_f32_16x16x32_bf16 a[204:207], v[160:163], v[160:163], a[204:207]
  ds_read_b128 v[208:211], v172 offset:8192
  buffer_load_dwordx4 v186, s[12:15], s6 offen offset:1024 lds
  v_mfma_f32_16x16x32_bf16 a[196:199], v[28:31], v[164:167], a[196:199]
  ds_read_b64_tr_b16 a[108:109], v174 offset:4096
  s_add_u32 m0, s100, 86016
  v_mfma_f32_16x16x32_bf16 a[208:211], v[164:167], v[164:167], a[208:211]
  s_waitcnt lgkmcnt(7)
  ds_read_b64_tr_b16 a[110:111], v174 offset:4608
  s_add_u32 s6, s58, 1181696
  v_mfma_f32_16x16x32_bf16 a[200:203], v[28:31], v[168:171], a[200:203]
  ds_read_b64_tr_b16 a[112:113], v174 offset:12288
  buffer_load_dwordx4 v185, s[12:15], s6 offen offset:0 lds
  v_mfma_f32_16x16x32_bf16 a[212:215], v[168:171], v[168:171], a[212:215]
  ds_read_b64_tr_b16 a[114:115], v174 offset:12800
  s_add_u32 s6, s58, 1205248
  v_mfma_f32_16x16x32_bf16 v[32:35], a[96:99], v[28:31], v[32:35]
  ds_read_b64_tr_b16 a[116:117], v174 offset:20480
  v_mfma_f32_16x16x32_bf16 v[36:39], a[100:103], v[28:31], v[36:39]
  s_waitcnt lgkmcnt(7)
  ds_read_b64_tr_b16 a[118:119], v174 offset:20992
  buffer_load_dwordx4 v186, s[12:15], s6 offen offset:1024 lds
  v_mfma_f32_16x16x32_bf16 v[116:119], v[28:31], a[104:107], v[116:119]
  ds_read_b128 v[212:215], v173 offset:0
  s_add_u32 m0, s69, 94208
  v_mfma_f32_16x16x32_bf16 v[56:59], a[96:99], v[192:195], v[56:59]
  ds_read_b128 v[216:219], v173 offset:2048
  s_add_u32 s6, s59, 768
  v_mfma_f32_16x16x32_bf16 v[60:63], a[100:103], v[192:195], v[60:63]
  ds_read_b128 v[220:223], v173 offset:4096
  buffer_load_dwordx4 v187, s[8:11], s6 offen lds
  v_mfma_f32_16x16x32_bf16 v[64:67], v[192:195], a[104:107], v[64:67]
  ds_read_b128 v[224:227], v173 offset:6144
  s_add_u32 m0, s69, 98304
  v_mfma_f32_16x16x32_bf16 v[68:71], a[96:99], v[196:199], v[68:71]
  ds_read_b128 v[228:231], v173 offset:8192
  s_add_u32 s6, s59, 33536
  v_mfma_f32_16x16x32_bf16 v[72:75], a[100:103], v[196:199], v[72:75]
  ds_read_b128 v[232:235], v175 offset:0
  buffer_load_dwordx4 v187, s[8:11], s6 offen lds
  v_mfma_f32_16x16x32_bf16 v[76:79], v[196:199], a[104:107], v[76:79]
  ds_read_b128 v[236:239], v175 offset:2048
  s_add_u32 m0, s101, 102400
  v_mfma_f32_16x16x32_bf16 v[80:83], a[96:99], v[200:203], v[80:83]
  s_waitcnt lgkmcnt(7)
  ds_read_b128 v[240:243], v176 offset:8192
  s_add_u32 s6, s62, 768
  v_mfma_f32_16x16x32_bf16 v[84:87], a[100:103], v[200:203], v[84:87]
  buffer_load_dwordx4 v187, s[8:11], s6 offen lds
  v_mfma_f32_16x16x32_bf16 v[88:91], v[200:203], a[104:107], v[88:91]
  v_mfma_f32_16x16x32_bf16 v[92:95], a[96:99], v[204:207], v[92:95]
  v_lshlrev_b32 v40, 16, v244
  v_and_b32 v41, 0xffff0000, v244
  v_mfma_f32_16x16x32_bf16 v[96:99], a[100:103], v[204:207], v[96:99]
  v_mfma_f32_16x16x32_bf16 v[100:103], v[204:207], a[104:107], v[100:103]
  v_lshlrev_b32 v42, 16, v245
  v_and_b32 v43, 0xffff0000, v245
  v_mfma_f32_16x16x32_bf16 v[108:111], a[100:103], v[208:211], v[108:111]
  v_mfma_f32_16x16x32_bf16 v[112:115], v[208:211], a[104:107], v[112:115]
  v_lshlrev_b32 v44, 16, v246
  v_and_b32 v45, 0xffff0000, v246
  v_mfma_f32_16x16x32_bf16 v[32:35], a[108:111], v[28:31], v[32:35]
  v_mfma_f32_16x16x32_bf16 v[36:39], a[112:115], v[28:31], v[36:39]
  v_lshlrev_b32 v46, 16, v247
  v_and_b32 v47, 0xffff0000, v247
  v_mfma_f32_16x16x32_bf16 v[116:119], v[28:31], a[116:119], v[116:119]
  s_waitcnt lgkmcnt(0)
  v_mfma_f32_16x16x32_bf16 v[56:59], a[108:111], v[212:215], v[56:59]
  v_lshlrev_b32 v48, 16, v248
  v_and_b32 v49, 0xffff0000, v248
  v_mfma_f32_16x16x32_bf16 v[60:63], a[112:115], v[212:215], v[60:63]
  v_mfma_f32_16x16x32_bf16 v[64:67], v[212:215], a[116:119], v[64:67]
  v_lshlrev_b32 v50, 16, v249
  v_and_b32 v51, 0xffff0000, v249
  v_mfma_f32_16x16x32_bf16 v[68:71], a[108:111], v[216:219], v[68:71]
  v_mfma_f32_16x16x32_bf16 v[72:75], a[112:115], v[216:219], v[72:75]
  v_lshlrev_b32 v52, 16, v250
  v_and_b32 v53, 0xffff0000, v250
  v_mfma_f32_16x16x32_bf16 v[76:79], v[216:219], a[116:119], v[76:79]
  s_waitcnt vmcnt(9)
  s_barrier
  ds_read_b64_tr_b16 a[120:121], v174 offset:34816
  v_mfma_f32_16x16x32_bf16 v[80:83], a[108:111], v[220:223], v[80:83]
  ds_read_b64_tr_b16 a[122:123], v174 offset:35328
  s_add_u32 m0, s100, 104448
  s_add_u32 s6, s58, 1376256
  buffer_load_dwordx4 v185, s[12:15], s6 offen offset:0 lds
  v_lshlrev_b32 v54, 16, v251
  v_and_b32 v55, 0xffff0000, v251
  v_mfma_f32_16x16x32_bf16 v[84:87], a[112:115], v[220:223], v[84:87]
  ds_read_b64_tr_b16 a[124:125], v174 offset:43008
  s_add_u32 s6, s58, 1399808
  buffer_store_dword v26, v9, s[40:43], s87 offen sc1
  v_mfma_f32_16x16x32_bf16 v[88:91], v[220:223], a[116:119], v[88:91]
  ds_read_b64_tr_b16 a[126:127], v174 offset:43520
  buffer_load_dwordx4 v186, s[12:15], s6 offen offset:1024 lds
  v_mfma_f32_16x16x32_bf16 v[92:95], a[108:111], v[224:227], v[92:95]
  ds_read_b64_tr_b16 a[128:129], v174 offset:51200
  s_add_u32 m0, s100, 112640
  v_mfma_f32_16x16x32_bf16 v[96:99], a[112:115], v[224:227], v[96:99]
  ds_read_b64_tr_b16 a[130:131], v174 offset:51712
  s_add_u32 s6, s58, 1377280
  v_mfma_f32_16x16x32_bf16 v[100:103], v[224:227], a[116:119], v[100:103]
  ds_read_b128 v[120:123], v172 offset:34816
  buffer_load_dwordx4 v185, s[12:15], s6 offen offset:0 lds
  v_mfma_f32_16x16x32_bf16 v[108:111], a[112:115], v[228:231], v[108:111]
  ds_read_b128 v[124:127], v172 offset:36864
  s_add_u32 s6, s58, 1400832
  v_mfma_f32_16x16x32_bf16 v[112:115], v[228:231], a[116:119], v[112:115]
  ds_read_b128 v[128:131], v172 offset:38912
  v_mfma_f32_16x16x32_bf16 a[192:195], v[28:31], v[232:235], a[192:195]
  ds_read_b128 v[132:135], v172 offset:40960
  buffer_load_dwordx4 v186, s[12:15], s6 offen offset:1024 lds
  v_mfma_f32_16x16x32_bf16 a[204:207], v[232:235], v[232:235], a[204:207]
  ds_read_b128 v[136:139], v172 offset:43008
  s_add_u32 m0, s100, 120832
  v_mfma_f32_16x16x32_bf16 a[196:199], v[28:31], v[236:239], a[196:199]
  ds_read_b64_tr_b16 a[132:133], v174 offset:38912
  s_add_u32 s6, s58, 1378304
  v_mfma_f32_16x16x32_bf16 a[208:211], v[236:239], v[236:239], a[208:211]
  ds_read_b64_tr_b16 a[134:135], v174 offset:39424
  buffer_load_dwordx4 v185, s[12:15], s6 offen offset:0 lds
  v_mfma_f32_16x16x32_bf16 a[200:203], v[28:31], v[240:243], a[200:203]
  ds_read_b64_tr_b16 a[136:137], v174 offset:47104
  s_add_u32 s6, s58, 1401856
  v_mfma_f32_16x16x32_bf16 a[212:215], v[240:243], v[240:243], a[212:215]
  s_waitcnt lgkmcnt(7)
  ds_read_b64_tr_b16 a[138:139], v174 offset:47616
  v_mfma_f32_16x16x32_bf16 v[32:35], a[120:123], v[28:31], v[32:35]
  ds_read_b64_tr_b16 a[140:141], v174 offset:55296
  buffer_load_dwordx4 v186, s[12:15], s6 offen offset:1024 lds
  v_mfma_f32_16x16x32_bf16 v[36:39], a[124:127], v[28:31], v[36:39]
  ds_read_b64_tr_b16 a[142:143], v174 offset:55808
  s_add_u32 m0, s69, 129024
  v_mfma_f32_16x16x32_bf16 v[116:119], v[28:31], a[128:131], v[116:119]
  ds_read_b128 v[140:143], v173 offset:34816
  s_add_u32 s6, s59, 896
  v_mfma_f32_16x16x32_bf16 v[56:59], a[120:123], v[120:123], v[56:59]
  ds_read_b128 v[144:147], v173 offset:36864
  buffer_load_dwordx4 v187, s[8:11], s6 offen lds
  v_mfma_f32_16x16x32_bf16 v[60:63], a[124:127], v[120:123], v[60:63]
  ds_read_b128 v[148:151], v173 offset:38912
  s_add_u32 m0, s69, 133120
  v_mfma_f32_16x16x32_bf16 v[64:67], v[120:123], a[128:131], v[64:67]
  s_waitcnt lgkmcnt(7)
  ds_read_b128 v[152:155], v173 offset:40960
  s_add_u32 s6, s59, 33664
  v_mfma_f32_16x16x32_bf16 v[68:71], a[120:123], v[124:127], v[68:71]
  ds_read_b128 v[156:159], v173 offset:43008
  buffer_load_dwordx4 v187, s[8:11], s6 offen lds
  v_mfma_f32_16x16x32_bf16 v[72:75], a[124:127], v[124:127], v[72:75]
  ds_read_b128 v[160:163], v175 offset:34816
  s_add_u32 m0, s101, 137216
  v_mfma_f32_16x16x32_bf16 v[76:79], v[124:127], a[128:131], v[76:79]
  ds_read_b128 v[164:167], v175 offset:36864
  s_add_u32 s6, s62, 896
  v_mfma_f32_16x16x32_bf16 v[80:83], a[120:123], v[128:131], v[80:83]
  ds_read_b128 v[168:171], v176 offset:43008
  buffer_load_dwordx4 v187, s[8:11], s6 offen lds
  v_mfma_f32_16x16x32_bf16 v[84:87], a[124:127], v[128:131], v[84:87]
  v_mfma_f32_16x16x32_bf16 v[88:91], v[128:131], a[128:131], v[88:91]
  v_mfma_f32_16x16x32_bf16 v[92:95], a[120:123], v[132:135], v[92:95]
  v_mfma_f32_16x16x32_bf16 v[96:99], a[124:127], v[132:135], v[96:99]
  v_mfma_f32_16x16x32_bf16 v[100:103], v[132:135], a[128:131], v[100:103]
  v_mfma_f32_16x16x32_bf16 v[108:111], a[124:127], v[136:139], v[108:111]
  v_mfma_f32_16x16x32_bf16 v[112:115], v[136:139], a[128:131], v[112:115]
  v_mfma_f32_16x16x32_bf16 v[32:35], a[132:135], v[28:31], v[32:35]
  s_waitcnt lgkmcnt(1)
  v_mfma_f32_16x16x32_bf16 v[36:39], a[136:139], v[28:31], v[36:39]
  v_mfma_f32_16x16x32_bf16 v[116:119], v[28:31], a[140:143], v[116:119]
  v_mfma_f32_16x16x32_bf16 v[56:59], a[132:135], v[140:143], v[56:59]
  v_mfma_f32_16x16x32_bf16 v[60:63], a[136:139], v[140:143], v[60:63]
  v_mfma_f32_16x16x32_bf16 v[64:67], v[140:143], a[140:143], v[64:67]
  v_mfma_f32_16x16x32_bf16 v[68:71], a[132:135], v[144:147], v[68:71]
  v_mfma_f32_16x16x32_bf16 v[72:75], a[136:139], v[144:147], v[72:75]
  v_mfma_f32_16x16x32_bf16 v[76:79], v[144:147], a[140:143], v[76:79]
  s_waitcnt vmcnt(10)
  s_barrier
  ds_read_b64_tr_b16 a[144:145], v179 offset:0
  v_mfma_f32_16x16x32_bf16 v[80:83], a[132:135], v[148:151], v[80:83]
  ds_read_b64_tr_b16 a[146:147], v179 offset:512
  s_add_u32 m0, s55, 0
  s_add_u32 s6, s56, 0
  buffer_load_dwordx4 v4, s[16:19], s6 offen offset:0 lds
  v_mfma_f32_16x16x32_bf16 v[84:87], a[136:139], v[148:151], v[84:87]
  ds_read_b64_tr_b16 a[148:149], v179 offset:8192
  s_add_u32 s6, s56, 7168
  v_mfma_f32_16x16x32_bf16 v[88:91], v[148:151], a[140:143], v[88:91]
  ds_read_b64_tr_b16 a[150:151], v179 offset:8704
  v_mfma_f32_16x16x32_bf16 v[92:95], a[132:135], v[152:155], v[92:95]
  ds_read_b64_tr_b16 a[152:153], v179 offset:16384
  buffer_load_dwordx4 v4, s[16:19], s6 offen offset:1024 lds
  v_mfma_f32_16x16x32_bf16 v[96:99], a[136:139], v[152:155], v[96:99]
  ds_read_b64_tr_b16 a[154:155], v179 offset:16896
  s_add_u32 s6, s56, 14336
  v_mfma_f32_16x16x32_bf16 v[100:103], v[152:155], a[140:143], v[100:103]
  ds_read_b128 v[192:195], v177 offset:0
  v_mfma_f32_16x16x32_bf16 v[108:111], a[136:139], v[156:159], v[108:111]
  ds_read_b128 v[196:199], v177 offset:2048
  buffer_load_dwordx4 v4, s[16:19], s6 offen offset:2048 lds
  v_mfma_f32_16x16x32_bf16 v[112:115], v[156:159], a[140:143], v[112:115]
  ds_read_b128 v[200:203], v177 offset:4096
  s_add_u32 s6, s56, 21504
  v_mfma_f32_16x16x32_bf16 a[192:195], v[28:31], v[160:163], a[192:195]
  ds_read_b128 v[204:207], v177 offset:6144
  v_mfma_f32_16x16x32_bf16 a[204:207], v[160:163], v[160:163], a[204:207]
  ds_read_b128 v[208:211], v177 offset:8192
  buffer_load_dwordx4 v4, s[16:19], s6 offen offset:3072 lds
  v_mfma_f32_16x16x32_bf16 a[196:199], v[28:31], v[164:167], a[196:199]
  ds_read_b64_tr_b16 a[156:157], v179 offset:4096
  s_add_u32 m0, s55, 16384
  v_mfma_f32_16x16x32_bf16 a[208:211], v[164:167], v[164:167], a[208:211]
  s_waitcnt lgkmcnt(7)
  ds_read_b64_tr_b16 a[158:159], v179 offset:4608
  s_add_u32 s6, s56, 65536
  v_mfma_f32_16x16x32_bf16 a[200:203], v[28:31], v[168:171], a[200:203]
  ds_read_b64_tr_b16 a[160:161], v179 offset:12288
  buffer_load_dwordx4 v4, s[16:19], s6 offen offset:0 lds
  v_mfma_f32_16x16x32_bf16 a[212:215], v[168:171], v[168:171], a[212:215]
  ds_read_b64_tr_b16 a[162:163], v179 offset:12800
  s_add_u32 s6, s56, 72704
  v_mfma_f32_16x16x32_bf16 v[32:35], a[144:147], v[28:31], v[32:35]
  ds_read_b64_tr_b16 a[164:165], v179 offset:20480
  v_mfma_f32_16x16x32_bf16 v[36:39], a[148:151], v[28:31], v[36:39]
  s_waitcnt lgkmcnt(7)
  ds_read_b64_tr_b16 a[166:167], v179 offset:20992
  buffer_load_dwordx4 v4, s[16:19], s6 offen offset:1024 lds
  v_mfma_f32_16x16x32_bf16 v[116:119], v[28:31], a[152:155], v[116:119]
  ds_read_b128 v[212:215], v178 offset:0
  s_add_u32 s6, s56, 79872
  v_mfma_f32_16x16x32_bf16 v[56:59], a[144:147], v[192:195], v[56:59]
  ds_read_b128 v[216:219], v178 offset:2048
  v_mfma_f32_16x16x32_bf16 v[60:63], a[148:151], v[192:195], v[60:63]
  ds_read_b128 v[220:223], v178 offset:4096
  buffer_load_dwordx4 v4, s[16:19], s6 offen offset:2048 lds
  v_mfma_f32_16x16x32_bf16 v[64:67], v[192:195], a[152:155], v[64:67]
  ds_read_b128 v[224:227], v178 offset:6144
  s_add_u32 s6, s56, 87040
  v_mfma_f32_16x16x32_bf16 v[68:71], a[144:147], v[196:199], v[68:71]
  ds_read_b128 v[228:231], v178 offset:8192
  v_mfma_f32_16x16x32_bf16 v[72:75], a[148:151], v[196:199], v[72:75]
  ds_read_b128 v[232:235], v180 offset:0
  buffer_load_dwordx4 v4, s[16:19], s6 offen offset:3072 lds
  v_mfma_f32_16x16x32_bf16 v[76:79], v[196:199], a[152:155], v[76:79]
  ds_read_b128 v[236:239], v180 offset:2048
  v_mfma_f32_16x16x32_bf16 v[80:83], a[144:147], v[200:203], v[80:83]
  s_waitcnt lgkmcnt(7)
  ds_read_b128 v[240:243], v181 offset:8192
  v_mfma_f32_16x16x32_bf16 v[84:87], a[148:151], v[200:203], v[84:87]
  v_mfma_f32_16x16x32_bf16 v[88:91], v[200:203], a[152:155], v[88:91]
  v_mfma_f32_16x16x32_bf16 v[92:95], a[144:147], v[204:207], v[92:95]
  v_mfma_f32_16x16x32_bf16 v[96:99], a[148:151], v[204:207], v[96:99]
  v_mfma_f32_16x16x32_bf16 v[100:103], v[204:207], a[152:155], v[100:103]
  v_mfma_f32_16x16x32_bf16 v[108:111], a[148:151], v[208:211], v[108:111]
  v_mfma_f32_16x16x32_bf16 v[112:115], v[208:211], a[152:155], v[112:115]
  v_mfma_f32_16x16x32_bf16 v[32:35], a[156:159], v[28:31], v[32:35]
  v_mfma_f32_16x16x32_bf16 v[36:39], a[160:163], v[28:31], v[36:39]
  v_mfma_f32_16x16x32_bf16 v[116:119], v[28:31], a[164:167], v[116:119]
  s_waitcnt lgkmcnt(0)
  v_mfma_f32_16x16x32_bf16 v[56:59], a[156:159], v[212:215], v[56:59]
  v_mfma_f32_16x16x32_bf16 v[60:63], a[160:163], v[212:215], v[60:63]
  v_mfma_f32_16x16x32_bf16 v[64:67], v[212:215], a[164:167], v[64:67]
  v_mfma_f32_16x16x32_bf16 v[68:71], a[156:159], v[216:219], v[68:71]
  v_mfma_f32_16x16x32_bf16 v[72:75], a[160:163], v[216:219], v[72:75]
  v_mfma_f32_16x16x32_bf16 v[76:79], v[216:219], a[164:167], v[76:79]
  s_waitcnt vmcnt(8)
  s_barrier
  ds_read_b128 v[160:163], v180 offset:34816
  v_mfma_f32_16x16x32_bf16 v[80:83], a[156:159], v[220:223], v[80:83]
  ds_read_b128 v[164:167], v180 offset:36864
  v_mov_b32 v7, L_join-L_pc
  v_add_u32 v7, s39, v7
  global_load_dword v6, v7, s[90:91]
  s_add_u32 m0, s55, 32768
  s_add_u32 s6, s56, 131072
  v_mfma_f32_16x16x32_bf16 v[84:87], a[160:163], v[220:223], v[84:87]
  ds_read_b128 v[168:171], v181 offset:43008
  buffer_load_dwordx4 v4, s[16:19], s6 offen offset:0 lds
  v_mfma_f32_16x16x32_bf16 v[88:91], v[220:223], a[164:167], v[88:91]
  ds_read_b64_tr_b16 a[168:169], v179 offset:34816
  s_add_u32 s6, s56, 138240
  v_mfma_f32_16x16x32_bf16 v[92:95], a[156:159], v[224:227], v[92:95]
  ds_read_b64_tr_b16 a[170:171], v179 offset:35328
  v_mfma_f32_16x16x32_bf16 v[96:99], a[160:163], v[224:227], v[96:99]
  ds_read_b64_tr_b16 a[172:173], v179 offset:43008
  buffer_load_dwordx4 v4, s[16:19], s6 offen offset:1024 lds
  v_mfma_f32_16x16x32_bf16 v[100:103], v[224:227], a[164:167], v[100:103]
  ds_read_b64_tr_b16 a[174:175], v179 offset:43520
  s_add_u32 s6, s56, 145408
  v_mfma_f32_16x16x32_bf16 v[108:111], a[160:163], v[228:231], v[108:111]
  ds_read_b64_tr_b16 a[176:177], v179 offset:51200
  v_mfma_f32_16x16x32_bf16 v[112:115], v[228:231], a[164:167], v[112:115]
  ds_read_b64_tr_b16 a[178:179], v179 offset:51712
  buffer_load_dwordx4 v4, s[16:19], s6 offen offset:2048 lds
  v_mfma_f32_16x16x32_bf16 a[192:195], v[28:31], v[232:235], a[192:195]
  ds_read_b128 v[120:123], v177 offset:34816
  s_add_u32 s6, s56, 152576
  v_mfma_f32_16x16x32_bf16 a[204:207], v[232:235], v[232:235], a[204:207]
  ds_read_b128 v[124:127], v177 offset:36864
  v_mfma_f32_16x16x32_bf16 a[196:199], v[28:31], v[236:239], a[196:199]
  ds_read_b128 v[128:131], v177 offset:38912
  buffer_load_dwordx4 v4, s[16:19], s6 offen offset:3072 lds
  v_mfma_f32_16x16x32_bf16 a[208:211], v[236:239], v[236:239], a[208:211]
  ds_read_b128 v[132:135], v177 offset:40960
  s_add_u32 m0, s55, 49152
  v_mfma_f32_16x16x32_bf16 a[200:203], v[28:31], v[240:243], a[200:203]
  ds_read_b128 v[136:139], v177 offset:43008
  s_add_u32 s6, s56, 196608
  v_mfma_f32_16x16x32_bf16 a[212:215], v[240:243], v[240:243], a[212:215]
  s_waitcnt lgkmcnt(7)
  ds_read_b64_tr_b16 a[180:181], v179 offset:38912
  buffer_load_dwordx4 v4, s[16:19], s6 offen offset:0 lds
  v_mfma_f32_16x16x32_bf16 a[192:195], v[28:31], v[160:163], a[192:195]
  ds_read_b64_tr_b16 a[182:183], v179 offset:39424
  s_add_u32 s6, s56, 203776
  s_mul_i32 s3, s83, 768
  s_lshl_b32 s4, s84, 8
  s_add_u32 s3, s3, 148480
  v_add_u32 v201, s3, v17
  v_add_u32 v200, s4, v201
  v_mfma_f32_16x16x32_bf16 a[204:207], v[160:163], v[160:163], a[204:207]
  ds_read_b64_tr_b16 a[184:185], v179 offset:47104
  buffer_load_dwordx4 v4, s[16:19], s6 offen offset:1024 lds
  s_min_u32 s3, s53, 2
  s_lshl_b32 s3, s3, 8
  s_add_u32 s3, s3, 147456
  v_add_u32 v202, s3, v3
  v_mfma_f32_16x16x32_bf16 a[196:199], v[28:31], v[164:167], a[196:199]
  ds_read_b64_tr_b16 a[186:187], v179 offset:47616
  s_add_u32 s6, s56, 210944
  v_mfma_f32_16x16x32_bf16 a[208:211], v[164:167], v[164:167], a[208:211]
  ds_read_b64_tr_b16 a[188:189], v179 offset:55296
  buffer_load_dwordx4 v4, s[16:19], s6 offen offset:2048 lds
  v_mfma_f32_16x16x32_bf16 a[200:203], v[28:31], v[168:171], a[200:203]
  ds_read_b64_tr_b16 a[190:191], v179 offset:55808
  s_add_u32 s6, s56, 218112
  v_mfma_f32_16x16x32_bf16 a[212:215], v[168:171], v[168:171], a[212:215]
  ds_read_b128 v[140:143], v178 offset:34816
  v_accvgpr_read_b32 v205, a204
  v_accvgpr_read_b32 v206, a205
  v_accvgpr_read_b32 v207, a206
  v_accvgpr_read_b32 v208, a207
  v_mfma_f32_16x16x32_bf16 v[32:35], a[168:171], v[28:31], v[32:35]
  ds_read_b128 v[144:147], v178 offset:36864
  buffer_load_dwordx4 v4, s[16:19], s6 offen offset:3072 lds
  v_accvgpr_read_b32 v204, a192
  v_accvgpr_read_b32 v213, a208
  v_mfma_f32_16x16x32_bf16 v[36:39], a[172:175], v[28:31], v[36:39]
  s_waitcnt lgkmcnt(5)
  ds_read_b128 v[148:151], v178 offset:38912
  v_accvgpr_read_b32 v214, a209
  v_accvgpr_read_b32 v215, a210
  v_accvgpr_read_b32 v216, a211
  v_accvgpr_read_b32 v212, a196
  v_mfma_f32_16x16x32_bf16 v[116:119], v[28:31], a[176:179], v[116:119]
  ds_read_b128 v[152:155], v178 offset:40960
  v_accvgpr_read_b32 v221, a212
  v_accvgpr_read_b32 v222, a213
  v_mfma_f32_16x16x32_bf16 v[56:59], a[168:171], v[120:123], v[56:59]
  ds_read_b128 v[156:159], v178 offset:43008
  v_accvgpr_read_b32 v223, a214
  v_accvgpr_read_b32 v224, a215
  v_mfma_f32_16x16x32_bf16 v[60:63], a[172:175], v[120:123], v[60:63]
  v_accvgpr_read_b32 v220, a200
  v_cndmask_b32 v205, v205, v206, s[72:73]
  v_mfma_f32_16x16x32_bf16 v[64:67], v[120:123], a[176:179], v[64:67]
  v_cndmask_b32 v207, v207, v208, s[72:73]
  v_cndmask_b32 v213, v213, v214, s[72:73]
  v_mfma_f32_16x16x32_bf16 v[68:71], a[168:171], v[124:127], v[68:71]
  v_cndmask_b32 v215, v215, v216, s[72:73]
  v_cndmask_b32 v221, v221, v222, s[72:73]
  v_mfma_f32_16x16x32_bf16 v[72:75], a[172:175], v[124:127], v[72:75]
  v_cndmask_b32 v223, v223, v224, s[72:73]
  v_cndmask_b32 v205, v205, v207, s[80:81]
  v_mfma_f32_16x16x32_bf16 v[76:79], v[124:127], a[176:179], v[76:79]
  v_cndmask_b32 v213, v213, v215, s[80:81]
  v_cndmask_b32 v221, v221, v223, s[80:81]
  v_mfma_f32_16x16x32_bf16 v[80:83], a[168:171], v[128:131], v[80:83]
  v_mfma_f32_16x16x32_bf16 v[84:87], a[172:175], v[128:131], v[84:87]
  buffer_load_dword v189, v27, s[40:43], 0 offen sc1
  v_mfma_f32_16x16x32_bf16 v[88:91], v[128:131], a[176:179], v[88:91]
  s_mov_b32 exec_lo, 0x00f0000f
  s_mov_b32 exec_hi, 0xf0000f00
  ds_write2_b32 v200, v204, v205 offset0:0 offset1:32
  ds_write2_b32 v200, v212, v213 offset0:16 offset1:48
  ds_write2_b32 v201, v220, v221 offset0:144 offset1:176
  s_mov_b64 exec, -1
  v_mfma_f32_16x16x32_bf16 v[92:95], a[168:171], v[132:135], v[92:95]
  v_mfma_f32_16x16x32_bf16 v[96:99], a[172:175], v[132:135], v[96:99]
  v_mfma_f32_16x16x32_bf16 v[100:103], v[132:135], a[176:179], v[100:103]
  v_mfma_f32_16x16x32_bf16 v[108:111], a[172:175], v[136:139], v[108:111]
  v_mfma_f32_16x16x32_bf16 v[112:115], v[136:139], a[176:179], v[112:115]
  v_mfma_f32_16x16x32_bf16 v[32:35], a[180:183], v[28:31], v[32:35]
  s_waitcnt lgkmcnt(3)
  s_waitcnt lgkmcnt(0)
  s_barrier
  v_mfma_f32_16x16x32_bf16 v[36:39], a[184:187], v[28:31], v[36:39]
  ds_read_b32 v204, v202 offset:1024
  ds_read_b32 v205, v202 offset:1792
  v_mfma_f32_16x16x32_bf16 v[116:119], v[28:31], a[188:191], v[116:119]
  v_mfma_f32_16x16x32_bf16 v[56:59], a[180:183], v[140:143], v[56:59]
  v_mfma_f32_16x16x32_bf16 v[60:63], a[184:187], v[140:143], v[60:63]
  v_mfma_f32_16x16x32_bf16 v[64:67], v[140:143], a[188:191], v[64:67]
  v_mfma_f32_16x16x32_bf16 v[68:71], a[180:183], v[144:147], v[68:71]
  v_mfma_f32_16x16x32_bf16 v[72:75], a[184:187], v[144:147], v[72:75]
  v_mfma_f32_16x16x32_bf16 v[76:79], v[144:147], a[188:191], v[76:79]
  v_mfma_f32_16x16x32_bf16 v[80:83], a[180:183], v[148:151], v[80:83]
  v_mfma_f32_16x16x32_bf16 v[84:87], a[184:187], v[148:151], v[84:87]
  s_waitcnt lgkmcnt(0)
  v_add_f32 v204, v204, v205
  v_mfma_f32_16x16x32_bf16 v[88:91], v[148:151], a[188:191], v[88:91]
  v_mov_b32 v205, v204
  v_mfma_f32_16x16x32_bf16 v[92:95], a[180:183], v[152:155], v[92:95]
  s_nop 0
  v_permlane32_swap_b32 v204, v205
  v_mfma_f32_16x16x32_bf16 v[96:99], a[184:187], v[152:155], v[96:99]
  v_mul_f32 v206, 0x3b000000, v204
  v_mul_f32 v205, 0x3b000000, v205
  v_mfma_f32_16x16x32_bf16 v[100:103], v[152:155], a[188:191], v[100:103]
  v_fma_f32 v205, -v206, v206, v205
  v_mfma_f32_16x16x32_bf16 v[108:111], a[184:187], v[156:159], v[108:111]
  v_max_f32 v205, 0, v205
  v_mfma_f32_16x16x32_bf16 v[112:115], v[156:159], a[188:191], v[112:115]
  v_add_f32 v207, 0x3727c5ac, v205
  v_rsq_f32 v208, v207
  s_nop 0
  v_cndmask_b32 v206, v206, v208, s[78:79]
  ds_write_b32 v202, v206
L_join:
  v_mov_b32 v22, v116
  s_lshl_b32 s96, s68, 14
  s_add_u32 s96, s96, s54
  s_lshl_b32 s3, s50, 11
  s_add_u32 s96, s96, s3
  s_lshl_b32 s3, s53, 9
  s_add_u32 s96, s96, s3
  s_add_u32 s96, s96, 262144
  s_add_u32 s97, s96, 16384
  s_add_u32 s98, s96, 32768
  s_add_u32 s99, s96, 49152
  s_add_u32 s5, s37, 32
  s_waitcnt vmcnt(0)
  v_subrev_u32 v130, s5, v189
  v_cmp_le_u32 vcc, 16, v130
  s_mov_b32 s7, 0
  s_cbranch_vccz L_spd_3
L_sp_2:
  buffer_load_dword v189, v27, s[40:43], 0 offen sc1
  s_add_u32 s7, s7, 1
  s_waitcnt vmcnt(0)
  v_subrev_u32 v130, s5, v189
  v_cmp_le_u32 vcc, 16, v130
  s_cmp_lt_u32 s7, 0x40000
  s_cbranch_vccz L_spd_3
  s_cbranch_scc1 L_sp_2
L_spd_3:
  v_cmp_ne_u32 vcc, s23, v189
  s_mov_b64 s[12:13], s[40:41]
  s_mov_b64 s[44:45], s[40:41]
  s_cmp_eq_u32 vcc_hi, 0
  s_cselect_b32 s23, 1, 0
  s_cselect_b32 s22, 262143, 3
  s_cmp_lg_u32 s23, 0
  s_cselect_b32 s14, s42, 0
  s_cselect_b32 s46, 0, s42
  s_waitcnt lgkmcnt(0)
  s_barrier
  ds_read2_b32 v[156:157], v24 offset0:0 offset1:32
  ds_read2_b32 v[200:201], v24 offset0:16 offset1:48
  ds_read2_b32 v[210:211], v24 offset0:64 offset1:96
  ds_read2_b32 v[220:221], v24 offset0:80 offset1:112
  ds_read_b128 v[148:151], v25 offset:0
  ds_read_b128 v[158:161], v25 offset:576
  ds_read_b128 v[192:195], v25 offset:64
  ds_read_b128 v[202:205], v25 offset:256
  ds_read_b128 v[212:215], v25 offset:320
  ds_read_b128 v[152:155], v25 offset:128
  ds_read2_b32 v[166:167], v24 offset0:144 offset1:176
  ds_read_b128 v[162:165], v25 offset:704
  ds_read_b128 v[196:199], v25 offset:192
  ds_read_b128 v[206:209], v25 offset:384
  ds_read_b128 v[216:219], v25 offset:448
  s_add_u32 m0, s55, 65536
  s_add_u32 s6, s60, 0
  buffer_load_dwordx4 v2, s[40:43], s6 offen offset:0 sc1 lds
  s_waitcnt lgkmcnt(14)
  v_pk_fma_f32 v[60:61], v[156:157], v[36:37], v[60:61] op_sel:[0,0,0] op_sel_hi:[0,1,1] neg_lo:[1,0,0] neg_hi:[1,0,0]
  s_waitcnt lgkmcnt(13)
  v_pk_fma_f32 v[72:73], v[200:201], v[36:37], v[72:73] op_sel:[0,0,0] op_sel_hi:[0,1,1] neg_lo:[1,0,0] neg_hi:[1,0,0]
  s_waitcnt lgkmcnt(12)
  v_pk_fma_f32 v[84:85], v[210:211], v[36:37], v[84:85] op_sel:[0,0,0] op_sel_hi:[0,1,1] neg_lo:[1,0,0] neg_hi:[1,0,0]
  s_waitcnt lgkmcnt(11)
  v_pk_fma_f32 v[96:97], v[220:221], v[36:37], v[96:97] op_sel:[0,0,0] op_sel_hi:[0,1,1] neg_lo:[1,0,0] neg_hi:[1,0,0]
  v_pk_fma_f32 v[62:63], v[156:157], v[38:39], v[62:63] op_sel:[0,0,0] op_sel_hi:[0,1,1] neg_lo:[1,0,0] neg_hi:[1,0,0]
  v_pk_fma_f32 v[74:75], v[200:201], v[38:39], v[74:75] op_sel:[0,0,0] op_sel_hi:[0,1,1] neg_lo:[1,0,0] neg_hi:[1,0,0]
  v_pk_fma_f32 v[86:87], v[210:211], v[38:39], v[86:87] op_sel:[0,0,0] op_sel_hi:[0,1,1] neg_lo:[1,0,0] neg_hi:[1,0,0]
  v_pk_fma_f32 v[98:99], v[220:221], v[38:39], v[98:99] op_sel:[0,0,0] op_sel_hi:[0,1,1] neg_lo:[1,0,0] neg_hi:[1,0,0]
  v_pk_fma_f32 v[56:57], v[156:157], v[32:33], v[56:57] op_sel:[0,0,0] op_sel_hi:[0,1,1] neg_lo:[1,0,0] neg_hi:[1,0,0]
  v_pk_fma_f32 v[68:69], v[200:201], v[32:33], v[68:69] op_sel:[0,0,0] op_sel_hi:[0,1,1] neg_lo:[1,0,0] neg_hi:[1,0,0]
  buffer_load_dwordx4 v2, s[40:43], s6 offen offset:1024 sc1 lds
  v_pk_fma_f32 v[80:81], v[210:211], v[32:33], v[80:81] op_sel:[0,0,0] op_sel_hi:[0,1,1] neg_lo:[1,0,0] neg_hi:[1,0,0]
  v_pk_fma_f32 v[92:93], v[220:221], v[32:33], v[92:93] op_sel:[0,0,0] op_sel_hi:[0,1,1] neg_lo:[1,0,0] neg_hi:[1,0,0]
  v_pk_fma_f32 v[58:59], v[156:157], v[34:35], v[58:59] op_sel:[0,0,0] op_sel_hi:[0,1,1] neg_lo:[1,0,0] neg_hi:[1,0,0]
  v_pk_fma_f32 v[70:71], v[200:201], v[34:35], v[70:71] op_sel:[0,0,0] op_sel_hi:[0,1,1] neg_lo:[1,0,0] neg_hi:[1,0,0]
  v_pk_fma_f32 v[82:83], v[210:211], v[34:35], v[82:83] op_sel:[0,0,0] op_sel_hi:[0,1,1] neg_lo:[1,0,0] neg_hi:[1,0,0]
  v_pk_fma_f32 v[94:95], v[220:221], v[34:35], v[94:95] op_sel:[0,0,0] op_sel_hi:[0,1,1] neg_lo:[1,0,0] neg_hi:[1,0,0]
  v_pk_mul_f32 v[60:61], v[60:61], v[156:157] op_sel:[0,1] op_sel_hi:[1,1]
  v_pk_mul_f32 v[72:73], v[72:73], v[200:201] op_sel:[0,1] op_sel_hi:[1,1]
  v_pk_mul_f32 v[84:85], v[84:85], v[210:211] op_sel:[0,1] op_sel_hi:[1,1]
  v_pk_mul_f32 v[96:97], v[96:97], v[220:221] op_sel:[0,1] op_sel_hi:[1,1]
  buffer_load_dwordx4 v2, s[40:43], s6 offen offset:2048 sc1 lds
  v_pk_mul_f32 v[62:63], v[62:63], v[156:157] op_sel:[0,1] op_sel_hi:[1,1]
  s_waitcnt lgkmcnt(4)
  v_pk_fma_f32 v[64:65], v[148:149], v[22:23], v[64:65] op_sel:[0,0,0] op_sel_hi:[1,0,1] neg_lo:[1,0,0] neg_hi:[1,0,0]
  v_pk_fma_f32 v[108:109], v[166:167], v[36:37], v[108:109] op_sel:[0,0,0] op_sel_hi:[0,1,1] neg_lo:[1,0,0] neg_hi:[1,0,0]
  v_pk_fma_f32 v[112:113], v[158:159], v[22:23], v[112:113] op_sel:[0,0,0] op_sel_hi:[1,0,1] neg_lo:[1,0,0] neg_hi:[1,0,0]
  v_pk_mul_f32 v[74:75], v[74:75], v[200:201] op_sel:[0,1] op_sel_hi:[1,1]
  v_pk_fma_f32 v[76:77], v[192:193], v[22:23], v[76:77] op_sel:[0,0,0] op_sel_hi:[1,0,1] neg_lo:[1,0,0] neg_hi:[1,0,0]
  v_pk_mul_f32 v[86:87], v[86:87], v[210:211] op_sel:[0,1] op_sel_hi:[1,1]
  v_pk_fma_f32 v[88:89], v[202:203], v[22:23], v[88:89] op_sel:[0,0,0] op_sel_hi:[1,0,1] neg_lo:[1,0,0] neg_hi:[1,0,0]
  v_pk_mul_f32 v[98:99], v[98:99], v[220:221] op_sel:[0,1] op_sel_hi:[1,1]
  v_pk_fma_f32 v[100:101], v[212:213], v[22:23], v[100:101] op_sel:[0,0,0] op_sel_hi:[1,0,1] neg_lo:[1,0,0] neg_hi:[1,0,0]
  buffer_load_dwordx4 v2, s[40:43], s6 offen offset:3072 sc1 lds
  v_cvt_pk_bf16_f32 v116, v56, v57
  v_pk_fma_f32 v[66:67], v[150:151], v[22:23], v[66:67] op_sel:[0,0,0] op_sel_hi:[1,0,1] neg_lo:[1,0,0] neg_hi:[1,0,0]
  v_pk_fma_f32 v[110:111], v[166:167], v[38:39], v[110:111] op_sel:[0,0,0] op_sel_hi:[0,1,1] neg_lo:[1,0,0] neg_hi:[1,0,0]
  v_pk_fma_f32 v[114:115], v[160:161], v[22:23], v[114:115] op_sel:[0,0,0] op_sel_hi:[1,0,1] neg_lo:[1,0,0] neg_hi:[1,0,0]
  v_cvt_pk_bf16_f32 v118, v68, v69
  v_pk_fma_f32 v[78:79], v[194:195], v[22:23], v[78:79] op_sel:[0,0,0] op_sel_hi:[1,0,1] neg_lo:[1,0,0] neg_hi:[1,0,0]
  v_cvt_pk_bf16_f32 v120, v80, v81
  v_pk_fma_f32 v[90:91], v[204:205], v[22:23], v[90:91] op_sel:[0,0,0] op_sel_hi:[1,0,1] neg_lo:[1,0,0] neg_hi:[1,0,0]
  v_cvt_pk_bf16_f32 v122, v92, v93
  v_pk_fma_f32 v[102:103], v[214:215], v[22:23], v[102:103] op_sel:[0,0,0] op_sel_hi:[1,0,1] neg_lo:[1,0,0] neg_hi:[1,0,0]
  s_add_u32 m0, s55, 81920
  s_add_u32 s6, s60, 16384
  buffer_load_dwordx4 v2, s[40:43], s6 offen offset:0 sc1 lds
  v_cvt_pk_bf16_f32 v117, v58, v59
  v_pk_mul_f32 v[64:65], v[64:65], v[152:153] op_sel:[0,0] op_sel_hi:[1,1]
  v_pk_mul_f32 v[108:109], v[108:109], v[166:167] op_sel:[0,1] op_sel_hi:[1,1]
  s_waitcnt lgkmcnt(0)
  v_pk_mul_f32 v[112:113], v[112:113], v[162:163] op_sel:[0,0] op_sel_hi:[1,1]
  v_cvt_pk_bf16_f32 v119, v70, v71
  v_pk_mul_f32 v[76:77], v[76:77], v[196:197] op_sel:[0,0] op_sel_hi:[1,1]
  v_cvt_pk_bf16_f32 v121, v82, v83
  v_pk_mul_f32 v[88:89], v[88:89], v[206:207] op_sel:[0,0] op_sel_hi:[1,1]
  v_cvt_pk_bf16_f32 v123, v94, v95
  v_pk_mul_f32 v[100:101], v[100:101], v[216:217] op_sel:[0,0] op_sel_hi:[1,1]
  buffer_load_dwordx4 v2, s[40:43], s6 offen offset:1024 sc1 lds
  v_cvt_pk_bf16_f32 v126, v60, v61
  v_pk_mul_f32 v[66:67], v[66:67], v[154:155] op_sel:[0,0] op_sel_hi:[1,1]
  v_pk_mul_f32 v[110:111], v[110:111], v[166:167] op_sel:[0,1] op_sel_hi:[1,1]
  v_pk_mul_f32 v[114:115], v[114:115], v[164:165] op_sel:[0,0] op_sel_hi:[1,1]
  v_cvt_pk_bf16_f32 v128, v72, v73
  v_pk_mul_f32 v[78:79], v[78:79], v[198:199] op_sel:[0,0] op_sel_hi:[1,1]
  v_cvt_pk_bf16_f32 v130, v84, v85
  v_pk_mul_f32 v[90:91], v[90:91], v[208:209] op_sel:[0,0] op_sel_hi:[1,1]
  v_cvt_pk_bf16_f32 v132, v96, v97
  v_pk_mul_f32 v[102:103], v[102:103], v[218:219] op_sel:[0,0] op_sel_hi:[1,1]
  buffer_load_dwordx4 v2, s[40:43], s6 offen offset:2048 sc1 lds
  v_cvt_pk_bf16_f32 v127, v62, v63
  v_cvt_pk_bf16_f32 v136, v64, v65
  v_cvt_pk_bf16_f32 v124, v108, v109
  v_cvt_pk_bf16_f32 v134, v112, v113
  v_cvt_pk_bf16_f32 v129, v74, v75
  v_cvt_pk_bf16_f32 v138, v76, v77
  v_cvt_pk_bf16_f32 v131, v86, v87
  v_cvt_pk_bf16_f32 v140, v88, v89
  v_cvt_pk_bf16_f32 v133, v98, v99
  v_cvt_pk_bf16_f32 v142, v100, v101
  v_mov_b32 v7, L_p3_0-L_pc
  v_add_u32 v7, s39, v7
  global_load_dword v6, v7, s[90:91]
  v_mul_f32 v144, 0x3eb8aa3b, v157
  v_cvt_pk_bf16_f32 v137, v66, v67
  v_cvt_pk_bf16_f32 v125, v110, v111
  v_cvt_pk_bf16_f32 v135, v114, v115
  v_mul_f32 v145, 0x3eb8aa3b, v201
  v_cvt_pk_bf16_f32 v139, v78, v79
  v_mul_f32 v146, 0x3eb8aa3b, v211
  v_cvt_pk_bf16_f32 v141, v90, v91
  v_mul_f32 v147, 0x3eb8aa3b, v221
  v_cvt_pk_bf16_f32 v143, v102, v103
  s_barrier
  buffer_load_dwordx4 v2, s[40:43], s6 offen offset:3072 sc1 lds
  v_mfma_f32_16x16x16_bf16 v[56:59], v[126:127], v[116:117], 0
  v_mfma_f32_16x16x16_bf16 v[60:63], v[124:125], v[116:117], 0
  v_mfma_f32_16x16x16_bf16 v[148:151], v[128:129], v[118:119], 0
  s_nop 5
  v_cndmask_b32 v76, v56, v57, s[72:73]
  v_mfma_f32_16x16x16_bf16 v[192:195], v[130:131], v[120:121], 0
  v_cndmask_b32 v77, v58, v59, s[72:73]
  v_cndmask_b32 v78, v60, v61, s[72:73]
  v_mfma_f32_16x16x16_bf16 v[216:219], v[132:133], v[122:123], 0
  v_cndmask_b32 v79, v62, v63, s[72:73]
  v_min_f32 v78, s71, v78
  v_mfma_f32_16x16x16_bf16 v[152:155], v[126:127], v[118:119], 0
  v_cndmask_b32 v168, v148, v149, s[72:73]
  v_cndmask_b32 v169, v150, v151, s[72:73]
  v_mfma_f32_16x16x16_bf16 v[196:199], v[128:129], v[120:121], 0
  v_cndmask_b32 v212, v192, v193, s[72:73]
  v_cndmask_b32 v213, v194, v195, s[72:73]
  s_add_u32 m0, s55, 98304
  s_add_u32 s6, s60, 32768
  buffer_load_dwordx4 v2, s[40:43], s6 offen offset:0 sc1 lds
  v_mfma_f32_16x16x16_bf16 v[220:223], v[130:131], v[122:123], 0
  v_cndmask_b32 v236, v216, v217, s[72:73]
  v_cndmask_b32 v237, v218, v219, s[72:73]
  v_cndmask_b32 v170, v152, v153, s[72:73]
  v_min_f32 v79, s71, v79
  v_cndmask_b32 v171, v154, v155, s[72:73]
  v_cndmask_b32 v214, v196, v197, s[72:73]
  v_cndmask_b32 v215, v198, v199, s[72:73]
  v_cndmask_b32 v76, v78, v76, s[74:75]
  v_cndmask_b32 v168, v170, v168, s[74:75]
  v_cndmask_b32 v238, v220, v221, s[72:73]
  v_cndmask_b32 v239, v222, v223, s[72:73]
  v_cndmask_b32 v212, v214, v212, s[74:75]
  v_cndmask_b32 v236, v238, v236, s[74:75]
  v_cndmask_b32 v77, v79, v77, s[76:77]
  v_cndmask_b32 v169, v171, v169, s[76:77]
  buffer_load_dwordx4 v2, s[40:43], s6 offen offset:1024 sc1 lds
  v_cndmask_b32 v213, v215, v213, s[76:77]
  v_cndmask_b32 v237, v239, v237, s[76:77]
  v_max_f32 v78, v76, v77
  v_max_f32 v170, v168, v169
  v_max_f32 v214, v212, v213
  v_max_f32 v238, v236, v237
  v_max_f32 v79, v76, v77
  v_max_f32 v171, v168, v169
  v_max_f32 v215, v212, v213
  v_max_f32 v239, v236, v237
  v_permlane16_swap_b32 v78, v79
  v_permlane16_swap_b32 v170, v171
  v_permlane16_swap_b32 v214, v215
  v_permlane16_swap_b32 v238, v239
  v_max_f32 v56, v78, v79
  v_max_f32 v148, v170, v171
  buffer_load_dwordx4 v2, s[40:43], s6 offen offset:2048 sc1 lds
  v_max_f32 v192, v214, v215
  v_max_f32 v216, v238, v239
  v_max_f32 v79, v78, v79
  v_max_f32 v171, v170, v171
  v_max_f32 v215, v214, v215
  v_max_f32 v239, v238, v239
  v_permlane32_swap_b32 v56, v79
  v_permlane32_swap_b32 v148, v171
  v_permlane32_swap_b32 v192, v215
  v_permlane32_swap_b32 v216, v239
  v_max_f32 v78, v56, v79
  v_max_f32 v170, v148, v171
  v_max_f32 v214, v192, v215
  v_max_f32 v238, v216, v239
  v_pk_add_f32 v[76:77], v[76:77], v[78:79] op_sel:[0,0] op_sel_hi:[1,0] neg_lo:[0,1] neg_hi:[0,1]
  v_pk_add_f32 v[168:169], v[168:169], v[170:171] op_sel:[0,0] op_sel_hi:[1,0] neg_lo:[0,1] neg_hi:[0,1]
  v_pk_add_f32 v[212:213], v[212:213], v[214:215] op_sel:[0,0] op_sel_hi:[1,0] neg_lo:[0,1] neg_hi:[0,1]
  buffer_load_dwordx4 v2, s[40:43], s6 offen offset:3072 sc1 lds
  v_pk_add_f32 v[236:237], v[236:237], v[238:239] op_sel:[0,0] op_sel_hi:[1,0] neg_lo:[0,1] neg_hi:[0,1]
  v_pk_mul_f32 v[76:77], v[76:77], v[144:145] op_sel:[0,0] op_sel_hi:[1,0]
  v_pk_mul_f32 v[168:169], v[168:169], v[144:145] op_sel:[0,1] op_sel_hi:[1,1]
  v_pk_mul_f32 v[212:213], v[212:213], v[146:147] op_sel:[0,0] op_sel_hi:[1,0]
  v_pk_mul_f32 v[236:237], v[236:237], v[146:147] op_sel:[0,1] op_sel_hi:[1,1]
  v_exp_f32 v76, v76
  v_exp_f32 v168, v168
  v_exp_f32 v212, v212
  v_exp_f32 v236, v236
  v_exp_f32 v77, v77
  v_exp_f32 v169, v169
  v_exp_f32 v213, v213
  v_exp_f32 v237, v237
  v_cvt_pk_bf16_f32 v76, v76, v76
  v_cvt_pk_bf16_f32 v168, v168, v168
  v_cvt_pk_bf16_f32 v212, v212, v212
  s_add_u32 m0, s55, 114688
  s_add_u32 s6, s60, 49152
  buffer_load_dwordx4 v2, s[40:43], s6 offen offset:0 sc1 lds
  v_cvt_pk_bf16_f32 v236, v236, v236
  v_cvt_pk_bf16_f32 v77, v77, v77
  v_cvt_pk_bf16_f32 v169, v169, v169
  v_cvt_pk_bf16_f32 v213, v213, v213
  v_cvt_pk_bf16_f32 v237, v237, v237
  v_and_b32 v64, v76, v20
  v_and_b32 v156, v168, v20
  v_and_b32 v200, v212, v20
  v_and_b32 v224, v236, v20
  v_and_b32 v66, v76, v18
  v_and_b32 v158, v168, v18
  v_and_b32 v202, v212, v18
  v_and_b32 v226, v236, v18
  v_and_b32 v65, v77, v21
  v_and_b32 v157, v169, v21
  v_and_b32 v201, v213, v21
  buffer_load_dwordx4 v2, s[40:43], s6 offen offset:1024 sc1 lds
  v_and_b32 v225, v237, v21
  v_and_b32 v67, v77, v19
  v_and_b32 v159, v169, v19
  v_and_b32 v203, v213, v19
  v_and_b32 v227, v237, v19
  v_mfma_f32_16x16x32_bf16 v[72:75], v[28:31], v[64:67], 0
  v_mfma_f32_16x16x32_bf16 v[164:167], v[28:31], v[156:159], 0
  v_mfma_f32_16x16x32_bf16 v[208:211], v[28:31], v[200:203], 0
  v_mfma_f32_16x16x32_bf16 v[232:235], v[28:31], v[224:227], 0
  v_mfma_f32_16x16x32_bf16 v[68:71], v[134:137], v[64:67], 0
  s_nop 3
  v_rcp_f32 v76, v72
  v_mfma_f32_16x16x32_bf16 v[160:163], v[136:139], v[156:159], 0
  v_rcp_f32 v168, v164
  v_mfma_f32_16x16x32_bf16 v[204:207], v[138:141], v[200:203], 0
  v_rcp_f32 v212, v208
  v_mfma_f32_16x16x32_bf16 v[228:231], v[140:143], v[224:227], 0
  v_rcp_f32 v236, v232
  v_pk_mul_f32 v[68:69], v[68:69], v[76:77] op_sel:[0,0] op_sel_hi:[1,0]
  s_nop 1
  v_pk_mul_f32 v[160:161], v[160:161], v[168:169] op_sel:[0,0] op_sel_hi:[1,0]
  v_pk_mul_f32 v[70:71], v[70:71], v[76:77] op_sel:[0,0] op_sel_hi:[1,0]
  v_pk_mul_f32 v[204:205], v[204:205], v[212:213] op_sel:[0,0] op_sel_hi:[1,0]
  v_pk_mul_f32 v[162:163], v[162:163], v[168:169] op_sel:[0,0] op_sel_hi:[1,0]
  v_pk_mul_f32 v[206:207], v[206:207], v[212:213] op_sel:[0,0] op_sel_hi:[1,0]
  v_cvt_pk_bf16_f32 v68, v68, v69
  v_pk_mul_f32 v[228:229], v[228:229], v[236:237] op_sel:[0,0] op_sel_hi:[1,0]
  v_pk_mul_f32 v[230:231], v[230:231], v[236:237] op_sel:[0,0] op_sel_hi:[1,0]
  v_cvt_pk_bf16_f32 v160, v160, v161
  v_cvt_pk_bf16_f32 v204, v204, v205
  v_cvt_pk_bf16_f32 v228, v228, v229
  v_cvt_pk_bf16_f32 v69, v70, v71
  v_cvt_pk_bf16_f32 v161, v162, v163
  v_cvt_pk_bf16_f32 v205, v206, v207
  v_cvt_pk_bf16_f32 v229, v230, v231
  buffer_store_dwordx2 v[68:69], v14, s[40:43], s96 offen sc1
  buffer_store_dwordx2 v[160:161], v14, s[40:43], s97 offen sc1
  buffer_store_dwordx2 v[204:205], v14, s[40:43], s98 offen sc1
  buffer_store_dwordx2 v[228:229], v14, s[40:43], s99 offen sc1
  s_lshl_b32 s3, s89, 1
  s_add_u32 s3, s3, s83
  s_lshl_b32 s5, s50, 1
  s_add_u32 s5, s5, s84
  s_lshl_b32 s96, s3, 15
  s_lshl_b32 s4, s5, 10
  s_add_u32 s96, s96, s4
  s_add_u32 s96, s96, s54
  s_add_u32 s96, s96, 786432
  s_lshl_b32 s97, s3, 12
  s_lshl_b32 s4, s5, 8
  s_add_u32 s97, s97, s4
  s_add_u32 s97, s97, s54
  s_add_u32 s97, s97, 32768
  s_lshl_b32 s85, s3, 15
  s_lshl_b32 s4, s84, 13
  s_add_u32 s85, s85, s4
  s_add_u32 s85, s85, s54
  s_add_u32 s85, s85, 262144
  s_add_u32 s3, s55, 0
  v_add_u32 v184, s3, v2
  v_xor_b32 v185, 8192, v184
  v_and_b32 v116, 256, v10
  v_add_u32 v116, v116, v10
  buffer_load_dwordx4 v2, s[40:43], s6 offen offset:2048 sc1 lds
  v_add_u32 v186, 0, v8
  v_xor_b32 v187, 64, v186
  ds_read_b64_tr_b16 v[192:193], v186 offset:0
  ds_read_b64_tr_b16 v[194:195], v186 offset:512
  ds_read_b64_tr_b16 v[196:197], v187 offset:0
  ds_read_b64_tr_b16 v[198:199], v187 offset:512
  ds_read_b64_tr_b16 v[200:201], v186 offset:2048
  ds_read_b64_tr_b16 v[202:203], v186 offset:2560
  ds_read_b64_tr_b16 v[204:205], v187 offset:2048
  ds_read_b64_tr_b16 v[206:207], v187 offset:2560
  buffer_load_dwordx4 v2, s[40:43], s6 offen offset:3072 sc1 lds
  ds_read_b64_tr_b16 v[208:209], v186 offset:4096
  ds_read_b64_tr_b16 v[210:211], v186 offset:4608
  ds_read_b64_tr_b16 v[212:213], v187 offset:4096
  ds_read_b64_tr_b16 v[214:215], v187 offset:4608
  ds_read_b64_tr_b16 v[216:217], v186 offset:6144
  ds_read_b64_tr_b16 v[218:219], v186 offset:6656
  ds_read_b64_tr_b16 v[220:221], v187 offset:6144
  s_waitcnt lgkmcnt(10)
  ds_read_b64_tr_b16 v[222:223], v187 offset:6656
  v_add_u32 v188, 16384, v8
  v_xor_b32 v189, 64, v188
  ds_read_b64_tr_b16 v[224:225], v188 offset:0
  s_add_u32 m0, s55, 131072
  s_add_u32 s6, s60, 65536
  buffer_load_dwordx4 v2, s[40:43], s6 offen offset:0 sc1 lds
  ds_read_b64_tr_b16 v[226:227], v188 offset:512
  ds_read_b64_tr_b16 v[228:229], v189 offset:0
  ds_read_b64_tr_b16 v[230:231], v189 offset:512
  s_waitcnt lgkmcnt(10)
  ds_read_b64_tr_b16 v[232:233], v188 offset:2048
  ds_read_b64_tr_b16 v[234:235], v188 offset:2560
  ds_read_b64_tr_b16 v[236:237], v189 offset:2048
  ds_read_b64_tr_b16 v[238:239], v189 offset:2560
  ds_read_b64_tr_b16 v[240:241], v188 offset:4096
  s_waitcnt lgkmcnt(10)
  ds_read_b64_tr_b16 v[242:243], v188 offset:4608
  ds_read_b64_tr_b16 v[244:245], v189 offset:4096
  ds_read_b64_tr_b16 v[246:247], v189 offset:4608
  buffer_load_dwordx4 v2, s[40:43], s6 offen offset:1024 sc1 lds
  ds_read_b64_tr_b16 v[248:249], v188 offset:6144
  ds_read_b64_tr_b16 v[250:251], v188 offset:6656
  s_waitcnt lgkmcnt(10)
  ds_read_b64_tr_b16 v[252:253], v189 offset:6144
  ds_read_b64_tr_b16 v[254:255], v189 offset:6656
  v_add_u32 v186, 32768, v8
  v_xor_b32 v187, 64, v186
  ds_read_b64_tr_b16 a[192:193], v186 offset:0
  ds_read_b64_tr_b16 a[194:195], v186 offset:512
  ds_read_b64_tr_b16 a[196:197], v187 offset:0
  s_waitcnt lgkmcnt(10)
  ds_read_b64_tr_b16 a[198:199], v187 offset:512
  buffer_load_dwordx4 v2, s[40:43], s6 offen offset:2048 sc1 lds
  ds_read_b64_tr_b16 a[200:201], v186 offset:2048
  ds_read_b64_tr_b16 a[202:203], v186 offset:2560
  ds_read_b64_tr_b16 a[204:205], v187 offset:2048
  ds_read_b64_tr_b16 a[206:207], v187 offset:2560
  s_waitcnt lgkmcnt(10)
  ds_read_b64_tr_b16 a[208:209], v186 offset:4096
  ds_read_b64_tr_b16 a[210:211], v186 offset:4608
  ds_read_b64_tr_b16 a[212:213], v187 offset:4096
  ds_read_b64_tr_b16 a[214:215], v187 offset:4608
  ds_read_b64_tr_b16 a[216:217], v186 offset:6144
  s_waitcnt lgkmcnt(10)
  ds_read_b64_tr_b16 a[218:219], v186 offset:6656
  ds_read_b64_tr_b16 a[220:221], v187 offset:6144
  buffer_load_dwordx4 v2, s[40:43], s6 offen offset:3072 sc1 lds
  ds_read_b64_tr_b16 a[222:223], v187 offset:6656
  v_add_u32 v188, 49152, v8
  v_xor_b32 v189, 64, v188
  ds_read_b64_tr_b16 a[224:225], v188 offset:0
  ds_read_b64_tr_b16 a[226:227], v188 offset:512
  s_waitcnt lgkmcnt(10)
  ds_read_b64_tr_b16 a[228:229], v189 offset:0
  ds_read_b64_tr_b16 a[230:231], v189 offset:512
  ds_read_b64_tr_b16 a[232:233], v188 offset:2048
  ds_read_b64_tr_b16 a[234:235], v188 offset:2560
  ds_read_b64_tr_b16 a[236:237], v189 offset:2048
  s_waitcnt lgkmcnt(10)
  ds_read_b64_tr_b16 a[238:239], v189 offset:2560
  ds_read_b64_tr_b16 a[240:241], v188 offset:4096
  ds_read_b64_tr_b16 a[242:243], v188 offset:4608
  ds_read_b64_tr_b16 a[244:245], v189 offset:4096
  ds_read_b64_tr_b16 a[246:247], v189 offset:4608
  s_waitcnt lgkmcnt(10)
  ds_read_b64_tr_b16 a[248:249], v188 offset:6144
  ds_read_b64_tr_b16 a[250:251], v188 offset:6656
  ds_read_b64_tr_b16 a[252:253], v189 offset:6144
  ds_read_b64_tr_b16 a[254:255], v189 offset:6656
  s_add_u32 s38, s37, 1
  v_mov_b32 v26, s38
  s_waitcnt vmcnt(6)
  s_barrier
  buffer_store_dword v26, v9, s[40:43], s67 offen
  buffer_store_dword v26, v9, s[44:47], s67 offen offset:256 sc1
  s_mov_b32 s7, 0
  s_cmp_lg_u32 s53, 0
  s_cbranch_scc1 L_join_4
  s_mov_b64 exec, 0xff
  buffer_load_dword v1, v3, s[40:43], s64 offen sc1
  buffer_load_dword v12, v3, s[40:43], s64 offen sc1
  buffer_load_dword v15, v3, s[40:43], s64 offen sc1
L_ploop_5:
  s_waitcnt vmcnt(2)
  v_sub_u32 v27, v1, v26
  v_cmp_le_u32 vcc, 16, v27
  s_add_u32 s7, s7, 1
  s_cbranch_vccz L_join_4
  buffer_load_dword v1, v3, s[40:43], s64 offen sc1
  s_waitcnt vmcnt(2)
  v_sub_u32 v27, v12, v26
  v_cmp_le_u32 vcc, 16, v27
  s_add_u32 s7, s7, 1
  s_cbranch_vccz L_join_4
  buffer_load_dword v12, v3, s[40:43], s64 offen sc1
  s_waitcnt vmcnt(2)
  v_sub_u32 v27, v15, v26
  v_cmp_le_u32 vcc, 16, v27
  s_add_u32 s7, s7, 1
  s_cbranch_vccz L_join_4
  buffer_load_dword v15, v3, s[40:43], s64 offen sc1
  s_and_b32 s3, s7, s22
  s_cbranch_scc1 L_ploop_5
  buffer_load_dword v27, v3, s[40:43], s64 offen offset:256 sc1
  s_waitcnt vmcnt(0)
  v_sub_u32 v27, v27, v26
  v_cmp_le_u32 vcc, 16, v27
  s_cmp_lt_u32 s7, 0x80000
  s_cbranch_vccz L_join_4
  s_cbranch_scc1 L_ploop_5
L_join_4:
  s_mov_b64 exec, -1
  s_waitcnt lgkmcnt(0)
  s_barrier
  buffer_load_dwordx4 v[120:123], v10, s[40:43], s85 offen offset:0 sc1
  buffer_load_dwordx4 v[124:127], v10, s[40:43], s85 offen offset:512 sc1
  buffer_load_dwordx4 v[128:131], v10, s[40:43], s85 offen offset:1024 sc1
  buffer_load_dwordx4 v[132:135], v10, s[40:43], s85 offen offset:1536 sc1
  buffer_load_dwordx4 v[136:139], v10, s[40:43], s85 offen offset:2048 sc1
  buffer_load_dwordx4 v[140:143], v10, s[40:43], s85 offen offset:2560 sc1
  buffer_load_dwordx4 v[144:147], v10, s[40:43], s85 offen offset:3072 sc1
  buffer_load_dwordx4 v[148:151], v10, s[40:43], s85 offen offset:3584 sc1
  s_add_u32 s85, s85, 4096
  buffer_load_dwordx4 v[152:155], v10, s[40:43], s85 offen offset:0 sc1
  buffer_load_dwordx4 v[156:159], v10, s[40:43], s85 offen offset:512 sc1
  s_lshl_b32 s98, s52, 14
  s_add_u32 s98, s98, 327680
  v_lshlrev_b32 v117, 2, v0
  s_waitcnt vmcnt(9)
  v_mfma_f32_32x32x16_bf16 v[72:87], v[196:199], v[120:123], 0
  buffer_load_dwordx4 v[160:163], v10, s[40:43], s85 offen offset:1024 sc1
  v_mfma_f32_32x32x16_bf16 v[56:71], v[192:195], v[120:123], v[40:55]
  s_waitcnt vmcnt(9)
  v_mfma_f32_32x32x16_bf16 v[72:87], v[204:207], v[124:127], v[72:87]
  buffer_load_dwordx4 v[164:167], v10, s[40:43], s85 offen offset:1536 sc1
  v_mfma_f32_32x32x16_bf16 v[56:71], v[200:203], v[124:127], v[56:71]
  s_waitcnt vmcnt(9)
  v_mfma_f32_32x32x16_bf16 v[72:87], v[212:215], v[128:131], v[72:87]
  buffer_load_dwordx4 v[168:171], v10, s[40:43], s85 offen offset:2048 sc1
  v_mfma_f32_32x32x16_bf16 v[56:71], v[208:211], v[128:131], v[56:71]
  s_waitcnt vmcnt(9)
  v_mfma_f32_32x32x16_bf16 v[72:87], v[220:223], v[132:135], v[72:87]
  buffer_load_dwordx4 v[172:175], v10, s[40:43], s85 offen offset:2560 sc1
  v_mfma_f32_32x32x16_bf16 v[56:71], v[216:219], v[132:135], v[56:71]
  s_waitcnt vmcnt(9)
  v_mfma_f32_32x32x16_bf16 v[72:87], v[228:231], v[136:139], v[72:87]
  buffer_load_dwordx4 v[176:179], v10, s[40:43], s85 offen offset:3072 sc1
  v_mfma_f32_32x32x16_bf16 v[56:71], v[224:227], v[136:139], v[56:71]
  s_waitcnt vmcnt(9)
  v_mfma_f32_32x32x16_bf16 v[72:87], v[236:239], v[140:143], v[72:87]
  buffer_load_dwordx4 v[180:183], v10, s[40:43], s85 offen offset:3584 sc1
  v_mfma_f32_32x32x16_bf16 v[56:71], v[232:235], v[140:143], v[56:71]
  s_waitcnt vmcnt(9)
  v_mfma_f32_32x32x16_bf16 v[72:87], v[244:247], v[144:147], v[72:87]
  buffer_load_dword v120, v117, s[40:43], s98 offen offset:0 sc1
  s_add_u32 m0, s55, 16384
  s_add_u32 s6, s60, 81920
  buffer_load_dwordx4 v2, s[40:43], s6 offen offset:0 sc1 lds
  buffer_load_dword v121, v117, s[40:43], s98 offen offset:1024 sc1
  v_mfma_f32_32x32x16_bf16 v[56:71], v[240:243], v[144:147], v[56:71]
  s_waitcnt vmcnt(11)
  buffer_load_dword v122, v117, s[40:43], s98 offen offset:2048 sc1
  v_mfma_f32_32x32x16_bf16 v[72:87], v[252:255], v[148:151], v[72:87]
  buffer_load_dword v123, v117, s[40:43], s98 offen offset:3072 sc1
  v_mfma_f32_32x32x16_bf16 v[56:71], v[248:251], v[148:151], v[56:71]
  s_waitcnt vmcnt(12)
  s_add_u32 s98, s98, 4096
  buffer_load_dword v124, v117, s[40:43], s98 offen offset:0 sc1
  v_mfma_f32_32x32x16_bf16 v[72:87], a[196:199], v[152:155], v[72:87]
  buffer_load_dword v125, v117, s[40:43], s98 offen offset:1024 sc1
  buffer_load_dwordx4 v2, s[40:43], s6 offen offset:1024 sc1 lds
  buffer_load_dword v126, v117, s[40:43], s98 offen offset:2048 sc1
  v_mfma_f32_32x32x16_bf16 v[56:71], a[192:195], v[152:155], v[56:71]
  s_waitcnt vmcnt(15)
  buffer_load_dword v127, v117, s[40:43], s98 offen offset:3072 sc1
  v_mfma_f32_32x32x16_bf16 v[72:87], a[204:207], v[156:159], v[72:87]
  s_add_u32 s98, s98, 4096
  buffer_load_dword v128, v117, s[40:43], s98 offen offset:0 sc1
  v_mfma_f32_32x32x16_bf16 v[56:71], a[200:203], v[156:159], v[56:71]
  s_waitcnt vmcnt(16)
  buffer_load_dword v129, v117, s[40:43], s98 offen offset:1024 sc1
  v_mfma_f32_32x32x16_bf16 v[72:87], a[212:215], v[160:163], v[72:87]
  buffer_load_dword v130, v117, s[40:43], s98 offen offset:2048 sc1
  buffer_load_dwordx4 v2, s[40:43], s6 offen offset:2048 sc1 lds
  buffer_load_dword v131, v117, s[40:43], s98 offen offset:3072 sc1
  v_mfma_f32_32x32x16_bf16 v[56:71], a[208:211], v[160:163], v[56:71]
  s_waitcnt vmcnt(19)
  s_add_u32 s98, s98, 4096
  buffer_load_dword v132, v117, s[40:43], s98 offen offset:0 sc1
  v_mfma_f32_32x32x16_bf16 v[72:87], a[220:223], v[164:167], v[72:87]
  buffer_load_dword v133, v117, s[40:43], s98 offen offset:1024 sc1
  v_mfma_f32_32x32x16_bf16 v[56:71], a[216:219], v[164:167], v[56:71]
  s_waitcnt vmcnt(20)
  buffer_load_dword v134, v117, s[40:43], s98 offen offset:2048 sc1
  v_mfma_f32_32x32x16_bf16 v[72:87], a[228:231], v[168:171], v[72:87]
  buffer_load_dword v135, v117, s[40:43], s98 offen offset:3072 sc1
  buffer_load_dwordx4 v2, s[40:43], s6 offen offset:3072 sc1 lds
  v_mfma_f32_32x32x16_bf16 v[56:71], a[224:227], v[168:171], v[56:71]
  s_waitcnt vmcnt(22)
  v_mfma_f32_32x32x16_bf16 v[72:87], a[236:239], v[172:175], v[72:87]
  v_mfma_f32_32x32x16_bf16 v[56:71], a[232:235], v[172:175], v[56:71]
  s_waitcnt vmcnt(21)
  v_mfma_f32_32x32x16_bf16 v[72:87], a[244:247], v[176:179], v[72:87]
  s_add_u32 m0, s55, 32768
  s_add_u32 s6, s60, 98304
  buffer_load_dwordx4 v2, s[40:43], s6 offen offset:0 sc1 lds
  v_mfma_f32_32x32x16_bf16 v[56:71], a[240:243], v[176:179], v[56:71]
  s_waitcnt vmcnt(21)
  v_mfma_f32_32x32x16_bf16 v[72:87], a[252:255], v[180:183], v[72:87]
  v_mfma_f32_32x32x16_bf16 v[56:71], a[248:251], v[180:183], v[56:71]
  buffer_load_dwordx4 v2, s[40:43], s6 offen offset:1024 sc1 lds
  buffer_load_dwordx4 v2, s[40:43], s6 offen offset:2048 sc1 lds
  buffer_load_dwordx4 v2, s[40:43], s6 offen offset:3072 sc1 lds
  s_nop 7
  ds_write_b128 v184, v[72:75] offset:0
  ds_write_b128 v184, v[76:79] offset:1024
  ds_write_b128 v184, v[80:83] offset:2048
  ds_write_b128 v184, v[84:87] offset:3072
  s_waitcnt lgkmcnt(0)
  s_barrier
  ds_read_b128 v[88:91], v185 offset:0
  ds_read_b128 v[92:95], v185 offset:1024
  ds_read_b128 v[96:99], v185 offset:2048
  ds_read_b128 v[100:103], v185 offset:3072
  s_waitcnt lgkmcnt(3)
  v_pk_add_f32 v[56:57], v[56:57], v[88:89] op_sel:[0,0] op_sel_hi:[1,1]
  v_pk_add_f32 v[58:59], v[58:59], v[90:91] op_sel:[0,0] op_sel_hi:[1,1]
  s_waitcnt lgkmcnt(2)
  v_pk_add_f32 v[60:61], v[60:61], v[92:93] op_sel:[0,0] op_sel_hi:[1,1]
  v_pk_add_f32 v[62:63], v[62:63], v[94:95] op_sel:[0,0] op_sel_hi:[1,1]
  v_cvt_pk_bf16_f32 v104, v56, v57
  v_cvt_pk_bf16_f32 v105, v58, v59
  v_cvt_pk_bf16_f32 v106, v60, v61
  v_cvt_pk_bf16_f32 v107, v62, v63
  buffer_store_dwordx4 v[104:107], v116, s[40:43], s96 offen sc1
  s_waitcnt lgkmcnt(1)
  v_pk_add_f32 v[64:65], v[64:65], v[96:97] op_sel:[0,0] op_sel_hi:[1,1]
  v_pk_add_f32 v[66:67], v[66:67], v[98:99] op_sel:[0,0] op_sel_hi:[1,1]
  s_waitcnt lgkmcnt(0)
  v_pk_add_f32 v[68:69], v[68:69], v[100:101] op_sel:[0,0] op_sel_hi:[1,1]
  v_pk_add_f32 v[70:71], v[70:71], v[102:103] op_sel:[0,0] op_sel_hi:[1,1]
  v_cvt_pk_bf16_f32 v108, v64, v65
  v_cvt_pk_bf16_f32 v109, v66, v67
  v_cvt_pk_bf16_f32 v110, v68, v69
  v_cvt_pk_bf16_f32 v111, v70, v71
  buffer_store_dwordx4 v[108:111], v116, s[40:43], s96 offen offset:256 sc1
  v_dot2_f32_bf16 v114, v104, v28, 0
  v_dot2_f32_bf16 v115, v104, v104, 0
  v_dot2_f32_bf16 v112, v105, v28, 0
  v_dot2_f32_bf16 v113, v105, v105, 0
  v_dot2_f32_bf16 v114, v106, v28, v114
  v_dot2_f32_bf16 v115, v106, v106, v115
  v_dot2_f32_bf16 v112, v107, v28, v112
  v_dot2_f32_bf16 v113, v107, v107, v113
  v_dot2_f32_bf16 v114, v108, v28, v114
  v_dot2_f32_bf16 v115, v108, v108, v115
  v_dot2_f32_bf16 v112, v109, v28, v112
  v_dot2_f32_bf16 v113, v109, v109, v113
  v_dot2_f32_bf16 v114, v110, v28, v114
  v_dot2_f32_bf16 v115, v110, v110, v115
  v_dot2_f32_bf16 v112, v111, v28, v112
  v_dot2_f32_bf16 v113, v111, v111, v113
  s_nop 2
  v_pk_add_f32 v[112:113], v[112:113], v[114:115] op_sel:[0,0] op_sel_hi:[1,1]
  s_nop 1
  v_permlane32_swap_b32 v112, v113
  v_add_f32 v112, v112, v113
  buffer_store_dword v112, v3, s[40:43], s97 offen sc1
  s_add_u32 m0, s55, 49152
  s_add_u32 s6, s60, 114688
  buffer_load_dwordx4 v2, s[40:43], s6 offen offset:0 sc1 lds
  buffer_load_dwordx4 v2, s[40:43], s6 offen offset:1024 sc1 lds
  buffer_load_dwordx4 v2, s[40:43], s6 offen offset:2048 sc1 lds
  buffer_load_dwordx4 v2, s[40:43], s6 offen offset:3072 sc1 lds
  s_waitcnt vmcnt(28)
  v_add_f32 v120, v120, v121
  s_waitcnt vmcnt(26)
  v_add_f32 v122, v122, v123
  s_waitcnt vmcnt(24)
  v_add_f32 v124, v124, v125
  s_waitcnt vmcnt(21)
  v_add_f32 v126, v126, v127
  s_waitcnt vmcnt(19)
  v_add_f32 v128, v128, v129
  s_waitcnt vmcnt(16)
  v_add_f32 v130, v130, v131
  s_waitcnt vmcnt(14)
  v_add_f32 v132, v132, v133
  s_waitcnt vmcnt(12)
  v_add_f32 v134, v134, v135
  v_add_f32 v120, v120, v122
  v_add_f32 v124, v124, v126
  v_add_f32 v128, v128, v130
  v_add_f32 v132, v132, v134
  v_add_f32 v120, v120, v124
  v_add_f32 v128, v128, v132
  v_add_f32 v120, v120, v128
  v_cvt_pk_bf16_f32 v72, v120, v120
  v_and_b32 v75, 0xffff0000, v72
  v_sub_f32 v120, v120, v75
  v_cvt_pk_bf16_f32 v73, v120, v120
  v_and_b32 v75, 0xffff0000, v73
  v_sub_f32 v120, v120, v75
  v_cvt_pk_bf16_f32 v74, v120, v120
  v_mov_b32 v75, 0xffff
  v_bfi_b32 v76, v75, v72, v73
  v_mov_b32 v77, v76
  v_bfi_b32 v78, v75, v74, v72
  v_mov_b32 v79, 0
  v_lshlrev_b32 v80, 4, v0
  v_add_u32 v80, 151552, v80
  ds_write_b128 v80, v[76:79]
L_p3_0:
  s_and_b32 s3, s51, 1
  s_lshl_b32 s3, s3, 2
  s_add_u32 s3, s3, s53
  s_mov_b32 s5, s52
  s_lshl_b32 s97, s3, 15
  s_lshl_b32 s4, s5, 10
  s_add_u32 s97, s97, s4
  s_add_u32 s97, s97, s54
  s_add_u32 s97, s97, 786432
  s_and_b32 s3, s51, 1
  s_lshl_b32 s3, s3, 2
  s_add_u32 s3, s3, s53
  s_lshl_b32 s85, s3, 15
  s_add_u32 s85, s85, s54
  s_add_u32 s85, s85, 786432
  s_lshl_b32 s96, s3, 12
  s_add_u32 s96, s96, s54
  s_add_u32 s96, s96, 32768
  s_mul_i32 s86, s3, 114688
  s_lshr_b32 s4, s52, 3
  s_mul_i32 s4, s4, 26624
  s_add_u32 s86, s86, s4
  s_lshl_b32 s4, s52, 8
  s_add_u32 s86, s86, s4
  s_add_u32 s86, s86, s54
  s_add_u32 s86, s86, 1572864
  v_add_u32 v188, 65536, v2
  ds_read_b128 v[120:123], v188 offset:0
  ds_read_b128 v[124:127], v188 offset:1024
  ds_read_b128 v[128:131], v188 offset:2048
  ds_read_b128 v[132:135], v188 offset:3072
  ds_read_b128 v[136:139], v188 offset:4096
  ds_read_b128 v[140:143], v188 offset:5120
  ds_read_b128 v[144:147], v188 offset:6144
  ds_read_b128 v[148:151], v188 offset:7168
  s_add_u32 s38, s37, 2
  v_mov_b32 v26, s38
  s_waitcnt vmcnt(4)
  s_barrier
  buffer_store_dword v26, v9, s[40:43], s67 offen
  buffer_store_dword v26, v9, s[44:47], s67 offen offset:256 sc1
  s_mov_b32 s7, 0
  s_cmp_lg_u32 s53, 0
  s_cbranch_scc1 L_join_6
  s_mov_b64 exec, 0xffff
  buffer_load_dword v1, v3, s[40:43], s65 offen sc1
  buffer_load_dword v12, v3, s[40:43], s65 offen sc1
  buffer_load_dword v15, v3, s[40:43], s65 offen sc1
L_ploop_7:
  s_waitcnt vmcnt(2)
  v_sub_u32 v27, v1, v26
  v_cmp_le_u32 vcc, 16, v27
  s_add_u32 s7, s7, 1
  s_cbranch_vccz L_join_6
  buffer_load_dword v1, v3, s[40:43], s65 offen sc1
  s_waitcnt vmcnt(2)
  v_sub_u32 v27, v12, v26
  v_cmp_le_u32 vcc, 16, v27
  s_add_u32 s7, s7, 1
  s_cbranch_vccz L_join_6
  buffer_load_dword v12, v3, s[40:43], s65 offen sc1
  s_waitcnt vmcnt(2)
  v_sub_u32 v27, v15, v26
  v_cmp_le_u32 vcc, 16, v27
  s_add_u32 s7, s7, 1
  s_cbranch_vccz L_join_6
  buffer_load_dword v15, v3, s[40:43], s65 offen sc1
  s_and_b32 s3, s7, s22
  s_cbranch_scc1 L_ploop_7
  buffer_load_dword v27, v3, s[40:43], s65 offen offset:256 sc1
  s_waitcnt vmcnt(0)
  v_sub_u32 v27, v27, v26
  v_cmp_le_u32 vcc, 16, v27
  s_cmp_lt_u32 s7, 0x80000
  s_cbranch_vccz L_join_6
  s_cbranch_scc1 L_ploop_7
L_join_6:
  s_mov_b64 exec, -1
  s_waitcnt lgkmcnt(0)
  s_barrier
  buffer_load_dwordx4 v[192:195], v10, s[40:43], s85 offen offset:0 sc1
  buffer_load_dwordx4 v[196:199], v10, s[40:43], s85 offen offset:512 sc1
  buffer_load_dwordx4 v[200:203], v10, s[40:43], s85 offen offset:1024 sc1
  buffer_load_dwordx4 v[204:207], v10, s[40:43], s85 offen offset:1536 sc1
  buffer_load_dwordx4 v[208:211], v10, s[40:43], s85 offen offset:2048 sc1
  buffer_load_dwordx4 v[212:215], v10, s[40:43], s85 offen offset:2560 sc1
  buffer_load_dwordx4 v[216:219], v10, s[40:43], s85 offen offset:3072 sc1
  buffer_load_dwordx4 v[220:223], v10, s[40:43], s85 offen offset:3584 sc1
  s_add_u32 s85, s85, 4096
  buffer_load_dwordx4 v[224:227], v10, s[40:43], s85 offen offset:0 sc1
  buffer_load_dwordx4 v[228:231], v10, s[40:43], s85 offen offset:512 sc1
  v_add_u32 v27, 81920, v2
  s_waitcnt vmcnt(9)
  ds_read_b128 v[152:155], v188 offset:8192
  buffer_load_dwordx4 v[232:235], v10, s[40:43], s85 offen offset:1024 sc1
  v_mfma_f32_32x32x16_bf16 v[56:71], v[120:123], v[192:195], 0
  ds_read_b128 v[156:159], v188 offset:9216
  v_mfma_f32_32x32x16_bf16 v[72:87], v[124:127], v[192:195], 0
  ds_read_b128 v[120:123], v188 offset:10240
  v_mfma_f32_32x32x16_bf16 v[88:103], v[128:131], v[192:195], 0
  s_waitcnt vmcnt(9)
  ds_read_b128 v[124:127], v188 offset:11264
  buffer_load_dwordx4 v[236:239], v10, s[40:43], s85 offen offset:1536 sc1
  v_mfma_f32_32x32x16_bf16 v[56:71], v[132:135], v[196:199], v[56:71]
  ds_read_b128 v[128:131], v188 offset:12288
  v_mfma_f32_32x32x16_bf16 v[72:87], v[136:139], v[196:199], v[72:87]
  ds_read_b128 v[132:135], v188 offset:13312
  buffer_load_dwordx4 v[240:243], v10, s[40:43], s85 offen offset:2048 sc1
  v_mfma_f32_32x32x16_bf16 v[88:103], v[140:143], v[196:199], v[88:103]
  s_waitcnt vmcnt(10) lgkmcnt(4)
  ds_read_b128 v[136:139], v188 offset:14336
  v_mfma_f32_32x32x16_bf16 v[56:71], v[144:147], v[200:203], v[56:71]
  ds_read_b128 v[140:143], v188 offset:15360
  buffer_load_dwordx4 v[244:247], v10, s[40:43], s85 offen offset:2560 sc1
  v_mfma_f32_32x32x16_bf16 v[72:87], v[148:151], v[200:203], v[72:87]
  s_barrier
  ds_read_b128 v[144:147], v27 offset:0
  v_add_u32 v188, 98304, v2
  v_mfma_f32_32x32x16_bf16 v[88:103], v[152:155], v[200:203], v[88:103]
  s_waitcnt vmcnt(10) lgkmcnt(4)
  ds_read_b128 v[148:151], v27 offset:1024
  buffer_load_dwordx4 v[248:251], v10, s[40:43], s85 offen offset:3072 sc1
  v_mfma_f32_32x32x16_bf16 v[56:71], v[156:159], v[204:207], v[56:71]
  ds_read_b128 v[152:155], v27 offset:2048
  v_mfma_f32_32x32x16_bf16 v[72:87], v[120:123], v[204:207], v[72:87]
  ds_read_b128 v[156:159], v27 offset:3072
  buffer_load_dwordx4 v[252:255], v10, s[40:43], s85 offen offset:3584 sc1
  s_add_u32 s85, s85, 4096
  v_mfma_f32_32x32x16_bf16 v[88:103], v[124:127], v[204:207], v[88:103]
  s_waitcnt vmcnt(11) lgkmcnt(4)
  ds_read_b128 v[120:123], v27 offset:4096
  v_mfma_f32_32x32x16_bf16 v[56:71], v[128:131], v[208:211], v[56:71]
  ds_read_b128 v[124:127], v27 offset:5120
  buffer_load_dwordx4 a[192:195], v10, s[40:43], s85 offen offset:0 sc1
  v_mfma_f32_32x32x16_bf16 v[72:87], v[132:135], v[208:211], v[72:87]
  ds_read_b128 v[128:131], v27 offset:6144
  v_mfma_f32_32x32x16_bf16 v[88:103], v[136:139], v[208:211], v[88:103]
  s_waitcnt vmcnt(11) lgkmcnt(4)
  ds_read_b128 v[132:135], v27 offset:7168
  buffer_load_dword v104, v3, s[40:43], s96 offen offset:0 sc1
  buffer_load_dword v105, v3, s[40:43], s96 offen offset:256 sc1
  v_mfma_f32_32x32x16_bf16 v[56:71], v[140:143], v[212:215], v[56:71]
  ds_read_b128 v[136:139], v27 offset:8192
  buffer_load_dwordx4 a[196:199], v10, s[40:43], s85 offen offset:512 sc1
  v_mfma_f32_32x32x16_bf16 v[72:87], v[144:147], v[212:215], v[72:87]
  ds_read_b128 v[140:143], v27 offset:9216
  v_mfma_f32_32x32x16_bf16 v[88:103], v[148:151], v[212:215], v[88:103]
  s_waitcnt vmcnt(13) lgkmcnt(4)
  ds_read_b128 v[144:147], v27 offset:10240
  buffer_load_dword v106, v3, s[40:43], s96 offen offset:512 sc1
  buffer_load_dword v107, v3, s[40:43], s96 offen offset:768 sc1
  v_mfma_f32_32x32x16_bf16 v[56:71], v[152:155], v[216:219], v[56:71]
  ds_read_b128 v[148:151], v27 offset:11264
  buffer_load_dwordx4 a[200:203], v10, s[40:43], s85 offen offset:1024 sc1
  v_mfma_f32_32x32x16_bf16 v[72:87], v[156:159], v[216:219], v[72:87]
  ds_read_b128 v[152:155], v27 offset:12288
  v_mfma_f32_32x32x16_bf16 v[88:103], v[120:123], v[216:219], v[88:103]
  s_waitcnt vmcnt(15) lgkmcnt(4)
  ds_read_b128 v[156:159], v27 offset:13312
  buffer_load_dword v108, v3, s[40:43], s96 offen offset:1024 sc1
  buffer_load_dword v109, v3, s[40:43], s96 offen offset:1280 sc1
  v_mfma_f32_32x32x16_bf16 v[56:71], v[124:127], v[220:223], v[56:71]
  ds_read_b128 v[120:123], v27 offset:14336
  buffer_load_dwordx4 a[204:207], v10, s[40:43], s85 offen offset:1536 sc1
  v_mfma_f32_32x32x16_bf16 v[72:87], v[128:131], v[220:223], v[72:87]
  ds_read_b128 v[124:127], v27 offset:15360
  v_mfma_f32_32x32x16_bf16 v[88:103], v[132:135], v[220:223], v[88:103]
  s_waitcnt vmcnt(17) lgkmcnt(4)
  s_barrier
  ds_read_b128 v[128:131], v188 offset:0
  v_add_u32 v27, 114688, v2
  v_mfma_f32_32x32x16_bf16 v[56:71], v[136:139], v[224:227], v[56:71]
  ds_read_b128 v[132:135], v188 offset:1024
  buffer_load_dword v110, v3, s[40:43], s96 offen offset:1536 sc1
  buffer_load_dword v111, v3, s[40:43], s96 offen offset:1792 sc1
  v_mfma_f32_32x32x16_bf16 v[72:87], v[140:143], v[224:227], v[72:87]
  ds_read_b128 v[136:139], v188 offset:2048
  buffer_load_dwordx4 a[208:211], v10, s[40:43], s85 offen offset:2048 sc1
  v_mfma_f32_32x32x16_bf16 v[88:103], v[144:147], v[224:227], v[88:103]
  s_waitcnt vmcnt(19) lgkmcnt(4)
  ds_read_b128 v[140:143], v188 offset:3072
  v_mfma_f32_32x32x16_bf16 v[56:71], v[148:151], v[228:231], v[56:71]
  ds_read_b128 v[144:147], v188 offset:4096
  buffer_load_dword v112, v3, s[40:43], s96 offen offset:2048 sc1
  buffer_load_dword v113, v3, s[40:43], s96 offen offset:2304 sc1
  v_mfma_f32_32x32x16_bf16 v[72:87], v[152:155], v[228:231], v[72:87]
  ds_read_b128 v[148:151], v188 offset:5120
  buffer_load_dwordx4 a[212:215], v10, s[40:43], s85 offen offset:2560 sc1
  v_mfma_f32_32x32x16_bf16 v[88:103], v[156:159], v[228:231], v[88:103]
  s_waitcnt vmcnt(21) lgkmcnt(4)
  ds_read_b128 v[152:155], v188 offset:6144
  v_mfma_f32_32x32x16_bf16 v[56:71], v[120:123], v[232:235], v[56:71]
  ds_read_b128 v[156:159], v188 offset:7168
  buffer_load_dword v114, v3, s[40:43], s96 offen offset:2560 sc1
  buffer_load_dword v115, v3, s[40:43], s96 offen offset:2816 sc1
  v_mfma_f32_32x32x16_bf16 v[72:87], v[124:127], v[232:235], v[72:87]
  ds_read_b128 v[120:123], v188 offset:8192
  buffer_load_dwordx4 a[216:219], v10, s[40:43], s85 offen offset:3072 sc1
  v_mfma_f32_32x32x16_bf16 v[88:103], v[128:131], v[232:235], v[88:103]
  s_waitcnt vmcnt(23) lgkmcnt(4)
  ds_read_b128 v[124:127], v188 offset:9216
  v_mfma_f32_32x32x16_bf16 v[56:71], v[132:135], v[236:239], v[56:71]
  ds_read_b128 v[128:131], v188 offset:10240
  buffer_load_dword v116, v3, s[40:43], s96 offen offset:3072 sc1
  buffer_load_dword v117, v3, s[40:43], s96 offen offset:3328 sc1
  v_mfma_f32_32x32x16_bf16 v[72:87], v[136:139], v[236:239], v[72:87]
  ds_read_b128 v[132:135], v188 offset:11264
  buffer_load_dwordx4 a[220:223], v10, s[40:43], s85 offen offset:3584 sc1
  v_mfma_f32_32x32x16_bf16 v[88:103], v[140:143], v[236:239], v[88:103]
  s_waitcnt vmcnt(25) lgkmcnt(4)
  ds_read_b128 v[136:139], v188 offset:12288
  v_mfma_f32_32x32x16_bf16 v[56:71], v[144:147], v[240:243], v[56:71]
  ds_read_b128 v[140:143], v188 offset:13312
  buffer_load_dword v118, v3, s[40:43], s96 offen offset:3584 sc1
  buffer_load_dword v119, v3, s[40:43], s96 offen offset:3840 sc1
  s_add_u32 s85, s85, 4096
  v_mfma_f32_32x32x16_bf16 v[72:87], v[148:151], v[240:243], v[72:87]
  ds_read_b128 v[144:147], v188 offset:14336
  buffer_load_dwordx4 a[224:227], v10, s[40:43], s85 offen offset:0 sc1
  v_mfma_f32_32x32x16_bf16 v[88:103], v[152:155], v[240:243], v[88:103]
  s_waitcnt vmcnt(27) lgkmcnt(4)
  ds_read_b128 v[148:151], v188 offset:15360
  v_mfma_f32_32x32x16_bf16 v[56:71], v[156:159], v[244:247], v[56:71]
  s_barrier
  ds_read_b128 v[152:155], v27 offset:0
  v_add_u32 v188, 131072, v2
  v_mfma_f32_32x32x16_bf16 v[72:87], v[120:123], v[244:247], v[72:87]
  ds_read_b128 v[156:159], v27 offset:1024
  buffer_load_dwordx4 a[228:231], v10, s[40:43], s85 offen offset:512 sc1
  v_mfma_f32_32x32x16_bf16 v[88:103], v[124:127], v[244:247], v[88:103]
  s_waitcnt vmcnt(27) lgkmcnt(4)
  ds_read_b128 v[120:123], v27 offset:2048
  v_mfma_f32_32x32x16_bf16 v[56:71], v[128:131], v[248:251], v[56:71]
  ds_read_b128 v[124:127], v27 offset:3072
  buffer_load_dwordx4 a[232:235], v10, s[40:43], s85 offen offset:1024 sc1
  v_mfma_f32_32x32x16_bf16 v[72:87], v[132:135], v[248:251], v[72:87]
  ds_read_b128 v[128:131], v27 offset:4096
  v_mfma_f32_32x32x16_bf16 v[88:103], v[136:139], v[248:251], v[88:103]
  s_waitcnt vmcnt(27) lgkmcnt(4)
  ds_read_b128 v[132:135], v27 offset:5120
  buffer_load_dwordx4 a[236:239], v10, s[40:43], s85 offen offset:1536 sc1
  v_mfma_f32_32x32x16_bf16 v[56:71], v[140:143], v[252:255], v[56:71]
  ds_read_b128 v[136:139], v27 offset:6144
  v_mfma_f32_32x32x16_bf16 v[72:87], v[144:147], v[252:255], v[72:87]
  ds_read_b128 v[140:143], v27 offset:7168
  buffer_load_dwordx4 a[240:243], v10, s[40:43], s85 offen offset:2048 sc1
  v_mfma_f32_32x32x16_bf16 v[88:103], v[148:151], v[252:255], v[88:103]
  s_waitcnt vmcnt(28) lgkmcnt(4)
  ds_read_b128 v[144:147], v27 offset:8192
  v_mfma_f32_32x32x16_bf16 v[56:71], v[152:155], a[192:195], v[56:71]
  ds_read_b128 v[148:151], v27 offset:9216
  buffer_load_dwordx4 a[244:247], v10, s[40:43], s85 offen offset:2560 sc1
  v_mfma_f32_32x32x16_bf16 v[72:87], v[156:159], a[192:195], v[72:87]
  ds_read_b128 v[152:155], v27 offset:10240
  v_mfma_f32_32x32x16_bf16 v[88:103], v[120:123], a[192:195], v[88:103]
  s_waitcnt vmcnt(26) lgkmcnt(4)
  ds_read_b128 v[156:159], v27 offset:11264
  buffer_load_dwordx4 a[248:251], v10, s[40:43], s85 offen offset:3072 sc1
  v_mfma_f32_32x32x16_bf16 v[56:71], v[124:127], a[196:199], v[56:71]
  ds_read_b128 v[120:123], v27 offset:12288
  v_mfma_f32_32x32x16_bf16 v[72:87], v[128:131], a[196:199], v[72:87]
  ds_read_b128 v[124:127], v27 offset:13312
  buffer_load_dwordx4 a[252:255], v10, s[40:43], s85 offen offset:3584 sc1
  v_mfma_f32_32x32x16_bf16 v[88:103], v[132:135], a[196:199], v[88:103]
  s_waitcnt vmcnt(25) lgkmcnt(4)
  ds_read_b128 v[128:131], v27 offset:14336
  v_mfma_f32_32x32x16_bf16 v[56:71], v[136:139], a[200:203], v[56:71]
  ds_read_b128 v[132:135], v27 offset:15360
  v_and_b32 v1, 256, v10
  v_add_u32 v1, v1, v10
  buffer_load_dwordx4 v[48:51], v1, s[40:43], s97 offen sc1
  v_mfma_f32_32x32x16_bf16 v[72:87], v[140:143], a[200:203], v[72:87]
  s_barrier
  ds_read_b128 v[136:139], v188 offset:0
  v_add_u32 v27, 16384, v2
  v_mfma_f32_32x32x16_bf16 v[88:103], v[144:147], a[200:203], v[88:103]
  s_waitcnt vmcnt(23) lgkmcnt(4)
  ds_read_b128 v[140:143], v188 offset:1024
  buffer_load_dwordx4 v[52:55], v1, s[40:43], s97 offen offset:256 sc1
  s_add_u32 m0, s55, 0
  s_add_u32 s6, s60, 131072
  v_mfma_f32_32x32x16_bf16 v[56:71], v[148:151], a[204:207], v[56:71]
  ds_read_b128 v[144:147], v188 offset:2048
  v_mfma_f32_32x32x16_bf16 v[72:87], v[152:155], a[204:207], v[72:87]
  ds_read_b128 v[148:151], v188 offset:3072
  buffer_load_dwordx4 v2, s[40:43], s6 offen offset:0 sc1 lds
  v_mfma_f32_32x32x16_bf16 v[88:103], v[156:159], a[204:207], v[88:103]
  s_waitcnt vmcnt(22) lgkmcnt(4)
  ds_read_b128 v[152:155], v188 offset:4096
  v_mfma_f32_32x32x16_bf16 v[56:71], v[120:123], a[208:211], v[56:71]
  ds_read_b128 v[156:159], v188 offset:5120
  v_add_f32 v104, v104, v105
  v_add_f32 v106, v106, v107
  v_add_f32 v108, v108, v109
  v_add_f32 v110, v110, v111
  s_waitcnt vmcnt(20) lgkmcnt(4)
  v_add_f32 v112, v112, v113
  v_mfma_f32_32x32x16_bf16 v[72:87], v[124:127], a[208:211], v[72:87]
  ds_read_b128 v[120:123], v188 offset:6144
  s_waitcnt vmcnt(17)
  v_add_f32 v114, v114, v115
  v_mfma_f32_32x32x16_bf16 v[88:103], v[128:131], a[208:211], v[88:103]
  ds_read_b128 v[124:127], v188 offset:7168
  buffer_load_dwordx4 v2, s[40:43], s6 offen offset:1024 sc1 lds
  s_waitcnt vmcnt(15) lgkmcnt(4)
  v_add_f32 v116, v116, v117
  v_mfma_f32_32x32x16_bf16 v[56:71], v[132:135], a[212:215], v[56:71]
  ds_read_b128 v[128:131], v188 offset:8192
  v_mfma_f32_32x32x16_bf16 v[72:87], v[136:139], a[212:215], v[72:87]
  ds_read_b128 v[132:135], v188 offset:9216
  v_mfma_f32_32x32x16_bf16 v[88:103], v[140:143], a[212:215], v[88:103]
  ds_read_b128 v[136:139], v188 offset:10240
  s_waitcnt vmcnt(12) lgkmcnt(5)
  v_add_f32 v118, v118, v119
  v_add_f32 v104, v104, v106
  v_add_f32 v108, v108, v110
  v_add_f32 v112, v112, v114
  v_add_f32 v116, v116, v118
  v_mfma_f32_32x32x16_bf16 v[56:71], v[144:147], a[216:219], v[56:71]
  ds_read_b128 v[140:143], v188 offset:11264
  buffer_load_dwordx4 v2, s[40:43], s6 offen offset:2048 sc1 lds
  v_add_f32 v104, v104, v108
  v_add_f32 v112, v112, v116
  v_mfma_f32_32x32x16_bf16 v[72:87], v[148:151], a[216:219], v[72:87]
  ds_read_b128 v[144:147], v188 offset:12288
  v_add_f32 v104, v104, v112
  v_mfma_f32_32x32x16_bf16 v[88:103], v[152:155], a[216:219], v[88:103]
  ds_read_b128 v[148:151], v188 offset:13312
  v_mov_b32 v105, v104
  v_mfma_f32_32x32x16_bf16 v[56:71], v[156:159], a[220:223], v[56:71]
  s_waitcnt lgkmcnt(4)
  ds_read_b128 v[152:155], v188 offset:14336
  v_permlane32_swap_b32 v104, v105
  v_mfma_f32_32x32x16_bf16 v[72:87], v[120:123], a[220:223], v[72:87]
  ds_read_b128 v[156:159], v188 offset:15360
  buffer_load_dwordx4 v2, s[40:43], s6 offen offset:3072 sc1 lds
  v_mul_f32 v106, 0x3b000000, v104
  v_mul_f32 v105, 0x3b000000, v105
  v_mfma_f32_32x32x16_bf16 v[88:103], v[124:127], a[220:223], v[88:103]
  s_waitcnt vmcnt(13) lgkmcnt(4)
  s_barrier
  ds_read_b128 v[120:123], v27 offset:0
  v_add_u32 v188, 32768, v2
  v_fma_f32 v105, -v106, v106, v105
  v_mfma_f32_32x32x16_bf16 v[56:71], v[128:131], a[224:227], v[56:71]
  ds_read_b128 v[124:127], v27 offset:1024
  v_max_f32 v105, 0, v105
  v_mfma_f32_32x32x16_bf16 v[72:87], v[132:135], a[224:227], v[72:87]
  ds_read_b128 v[128:131], v27 offset:2048
  v_add_f32 v191, 0x3727c5ac, v105
  v_mfma_f32_32x32x16_bf16 v[88:103], v[136:139], a[224:227], v[88:103]
  s_waitcnt vmcnt(12) lgkmcnt(4)
  ds_read_b128 v[132:135], v27 offset:3072
  v_mov_b32 v7, L_p3_0+2048-L_pc
  v_add_u32 v7, s39, v7
  global_load_dword v6, v7, s[90:91]
  s_add_u32 m0, s55, 65536
  s_add_u32 s6, s60, 147456
  v_mfma_f32_32x32x16_bf16 v[56:71], v[140:143], a[228:231], v[56:71]
  ds_read_b128 v[136:139], v27 offset:4096
  buffer_load_dwordx4 v2, s[40:43], s6 offen offset:0 sc1 lds
  v_rsq_f32 v107, v191
  v_sub_f32 v106, 0, v106
  v_mfma_f32_32x32x16_bf16 v[72:87], v[144:147], a[228:231], v[72:87]
  ds_read_b128 v[140:143], v27 offset:5120
  v_mul_f32 v189, 0xc0135761, v107
  v_cndmask_b32 v106, v106, 0, s[78:79]
  v_mul_f32 v105, v107, v107
  v_mov_b32 v110, 0xffff
  v_mul_f32 v105, 0x3d372713, v105
  v_mfma_f32_32x32x16_bf16 v[88:103], v[148:151], a[228:231], v[88:103]
  s_waitcnt vmcnt(13) lgkmcnt(4)
  ds_read_b128 v[144:147], v27 offset:6144
  v_mov_b32 v163, 0
  v_mul_f32 v190, v189, v105
  v_cvt_pk_bf16_f32 v160, v106, v106
  v_mfma_f32_32x32x16_bf16 v[56:71], v[152:155], a[232:235], v[56:71]
  ds_read_b128 v[148:151], v27 offset:7168
  v_and_b32 v109, 0xffff0000, v160
  v_mfma_f32_32x32x16_bf16 v[72:87], v[156:159], a[232:235], v[72:87]
  ds_read_b128 v[152:155], v27 offset:8192
  buffer_load_dwordx4 v2, s[40:43], s6 offen offset:1024 sc1 lds
  v_sub_f32 v106, v106, v109
  v_mfma_f32_32x32x16_bf16 v[88:103], v[120:123], a[232:235], v[88:103]
  s_waitcnt vmcnt(13) lgkmcnt(4)
  ds_read_b128 v[156:159], v27 offset:9216
  v_cvt_pk_bf16_f32 v161, v106, v106
  v_mfma_f32_32x32x16_bf16 v[56:71], v[124:127], a[236:239], v[56:71]
  ds_read_b128 v[120:123], v27 offset:10240
  v_and_b32 v109, 0xffff0000, v161
  v_mfma_f32_32x32x16_bf16 v[72:87], v[128:131], a[236:239], v[72:87]
  ds_read_b128 v[124:127], v27 offset:11264
  v_sub_f32 v106, v106, v109
  v_mfma_f32_32x32x16_bf16 v[88:103], v[132:135], a[236:239], v[88:103]
  s_waitcnt vmcnt(12) lgkmcnt(4)
  ds_read_b128 v[128:131], v27 offset:12288
  buffer_load_dwordx4 v2, s[40:43], s6 offen offset:2048 sc1 lds
  v_cvt_pk_bf16_f32 v108, v106, v106
  v_mfma_f32_32x32x16_bf16 v[56:71], v[136:139], a[240:243], v[56:71]
  ds_read_b128 v[132:135], v27 offset:13312
  v_bfi_b32 v162, v110, v160, v108
  v_and_b32 v105, 256, v10
  v_mfma_f32_32x32x16_bf16 v[72:87], v[140:143], a[240:243], v[72:87]
  ds_read_b128 v[136:139], v27 offset:14336
  v_mad_u32_u24 v15, v105, 7, v11
  s_waitcnt vmcnt(9) lgkmcnt(4)
  v_lshlrev_b32 v40, 16, v48
  v_and_b32 v41, 0xffff0000, v48
  v_lshlrev_b32 v42, 16, v49
  v_and_b32 v43, 0xffff0000, v49
  v_mfma_f32_32x32x16_bf16 v[88:103], v[144:147], a[240:243], v[88:103]
  ds_read_b128 v[140:143], v27 offset:15360
  v_lshlrev_b32 v44, 16, v50
  v_and_b32 v45, 0xffff0000, v50
  v_lshlrev_b32 v46, 16, v51
  v_and_b32 v47, 0xffff0000, v51
  s_waitcnt vmcnt(8) lgkmcnt(4)
  v_lshlrev_b32 v48, 16, v52
  v_mfma_f32_32x32x16_bf16 v[56:71], v[148:151], a[244:247], v[56:71]
  ds_read_b128 v[144:147], v13 offset:0
  buffer_load_dwordx4 v2, s[40:43], s6 offen offset:3072 sc1 lds
  s_add_u32 m0, s55, 81920
  s_add_u32 s6, s60, 163840
  v_and_b32 v49, 0xffff0000, v52
  v_mfma_f32_32x32x16_bf16 v[72:87], v[152:155], a[244:247], v[72:87]
  ds_read_b128 v[148:151], v13 offset:512
  v_lshlrev_b32 v50, 16, v53
  v_and_b32 v51, 0xffff0000, v53
  v_lshlrev_b32 v52, 16, v54
  v_and_b32 v53, 0xffff0000, v54
  v_lshlrev_b32 v54, 16, v55
  v_mfma_f32_32x32x16_bf16 v[88:103], v[156:159], a[244:247], v[88:103]
  ds_read_b128 v[152:155], v13 offset:1024
  v_and_b32 v55, 0xffff0000, v55
  v_mfma_f32_32x32x16_bf16 v[56:71], v[120:123], a[248:251], v[56:71]
  ds_read_b128 v[156:159], v13 offset:1536
  v_mfma_f32_32x32x16_bf16 v[72:87], v[124:127], a[248:251], v[72:87]
  s_waitcnt lgkmcnt(4)
  s_barrier
  ds_read_b128 v[120:123], v188 offset:0
  v_add_u32 v27, 49152, v2
  v_mfma_f32_32x32x16_bf16 v[88:103], v[128:131], a[248:251], v[88:103]
  ds_read_b128 v[124:127], v188 offset:1024
  buffer_load_dwordx4 v2, s[40:43], s6 offen offset:0 sc1 lds
  v_mfma_f32_32x32x16_bf16 v[56:71], v[132:135], a[252:255], v[56:71]
  ds_read_b128 v[128:131], v188 offset:2048
  v_mfma_f32_32x32x16_bf16 v[72:87], v[136:139], a[252:255], v[72:87]
  ds_read_b128 v[132:135], v188 offset:3072
  v_mfma_f32_32x32x16_bf16 v[88:103], v[140:143], a[252:255], v[88:103]
  s_waitcnt lgkmcnt(4)
  ds_read_b128 v[136:139], v188 offset:4096
  v_mfma_f32_32x32x16_bf16 v[56:71], v[144:147], v[160:163], v[56:71]
  ds_read_b128 v[140:143], v188 offset:5120
  buffer_load_dwordx4 v2, s[40:43], s6 offen offset:1024 sc1 lds
  v_mfma_f32_32x32x16_bf16 v[72:87], v[148:151], v[160:163], v[72:87]
  ds_read_b128 v[144:147], v188 offset:6144
  v_mfma_f32_32x32x16_bf16 v[88:103], v[152:155], v[160:163], v[88:103]
  ds_read_b128 v[148:151], v188 offset:7168
  v_mfma_f32_32x32x16_bf16 v[104:119], v[156:159], v[160:163], 0
  s_waitcnt lgkmcnt(4)
  ds_read_b128 v[152:155], v188 offset:8192
  s_nop 2
  v_mul_f32 v164, v56, v56
  v_mul_f32 v165, v57, v57
  v_mul_f32 v166, v58, v58
  v_mul_f32 v167, v59, v59
  v_fma_f32 v164, v164, v190, v189
  v_fma_f32 v165, v165, v190, v189
  v_fma_f32 v166, v166, v190, v189
  v_fma_f32 v167, v167, v190, v189
  v_mul_f32 v164, v164, v56
  v_mul_f32 v165, v165, v57
  v_mfma_f32_32x32x16_bf16 v[104:119], v[120:123], v[192:195], v[104:119]
  ds_read_b128 v[156:159], v188 offset:9216
  buffer_load_dwordx4 v2, s[40:43], s6 offen offset:2048 sc1 lds
  v_mul_f32 v166, v166, v58
  v_mul_f32 v167, v167, v59
  v_exp_f32 v164, v164
  v_mul_f32 v64, v64, v56
  v_exp_f32 v165, v165
  v_mul_f32 v65, v65, v57
  v_mfma_f32_32x32x16_bf16 v[104:119], v[124:127], v[196:199], v[104:119]
  ds_read_b128 v[120:123], v188 offset:10240
  v_exp_f32 v166, v166
  v_mul_f32 v66, v66, v58
  v_exp_f32 v167, v167
  v_mul_f32 v67, v67, v59
  v_fma_f32 v164, v164, v191, v191
  v_fma_f32 v165, v165, v191, v191
  v_fma_f32 v166, v166, v191, v191
  v_fma_f32 v167, v167, v191, v191
  v_mfma_f32_32x32x16_bf16 v[104:119], v[128:131], v[200:203], v[104:119]
  ds_read_b128 v[124:127], v188 offset:11264
  v_rcp_f32 v164, v164
  v_rcp_f32 v165, v165
  v_mul_f32 v172, v72, v72
  v_mul_f32 v173, v73, v73
  v_mul_f32 v174, v74, v74
  v_mul_f32 v175, v75, v75
  v_fma_f32 v172, v172, v190, v189
  v_fma_f32 v173, v173, v190, v189
  v_mfma_f32_32x32x16_bf16 v[104:119], v[132:135], v[204:207], v[104:119]
  s_waitcnt lgkmcnt(2)
  ds_read_b128 v[128:131], v188 offset:12288
  buffer_load_dwordx4 v2, s[40:43], s6 offen offset:3072 sc1 lds
  s_add_u32 m0, s55, 98304
  s_add_u32 s6, s60, 180224
  v_rcp_f32 v166, v166
  v_fma_f32 v174, v174, v190, v189
  v_fma_f32 v175, v175, v190, v189
  v_mul_f32 v172, v172, v72
  v_mul_f32 v173, v173, v73
  v_mfma_f32_32x32x16_bf16 v[104:119], v[136:139], v[208:211], v[104:119]
  ds_read_b128 v[132:135], v188 offset:13312
  v_rcp_f32 v167, v167
  v_mul_f32 v174, v174, v74
  v_mul_f32 v175, v175, v75
  v_exp_f32 v172, v172
  v_mfma_f32_32x32x16_bf16 v[104:119], v[140:143], v[212:215], v[104:119]
  ds_read_b128 v[136:139], v188 offset:14336
  v_mul_f32 v64, v64, v164
  v_mul_f32 v80, v80, v72
  v_mul_f32 v65, v65, v165
  v_mul_f32 v66, v66, v166
  v_mul_f32 v67, v67, v167
  v_mfma_f32_32x32x16_bf16 v[104:119], v[144:147], v[216:219], v[104:119]
  ds_read_b128 v[140:143], v188 offset:15360
  buffer_load_dwordx4 v2, s[40:43], s6 offen offset:0 sc1 lds
  v_exp_f32 v173, v173
  v_cvt_pk_bf16_f32 v180, v64, v65
  v_mfma_f32_32x32x16_bf16 v[104:119], v[148:151], v[220:223], v[104:119]
  s_barrier
  ds_read_b128 v[144:147], v27 offset:0
  v_add_u32 v188, 0, v2
  v_mul_f32 v81, v81, v73
  v_exp_f32 v174, v174
  v_mfma_f32_32x32x16_bf16 v[104:119], v[152:155], v[224:227], v[104:119]
  ds_read_b128 v[148:151], v27 offset:1024
  v_cvt_pk_bf16_f32 v181, v66, v67
  v_mul_f32 v168, v60, v60
  v_mul_f32 v82, v82, v74
  v_mul_f32 v169, v61, v61
  v_mul_f32 v170, v62, v62
  v_mfma_f32_32x32x16_bf16 v[104:119], v[156:159], v[228:231], v[104:119]
  s_waitcnt lgkmcnt(4)
  ds_read_b128 v[152:155], v27 offset:2048
  v_exp_f32 v175, v175
  v_mul_f32 v171, v63, v63
  v_fma_f32 v168, v168, v190, v189
  v_fma_f32 v169, v169, v190, v189
  v_mfma_f32_32x32x16_bf16 v[104:119], v[120:123], v[232:235], v[104:119]
  ds_read_b128 v[156:159], v27 offset:3072
  buffer_load_dwordx4 v2, s[40:43], s6 offen offset:1024 sc1 lds
  v_mul_f32 v83, v83, v75
  v_fma_f32 v172, v172, v191, v191
  v_fma_f32 v170, v170, v190, v189
  v_mfma_f32_32x32x16_bf16 v[104:119], v[124:127], v[236:239], v[104:119]
  ds_read_b128 v[120:123], v27 offset:4096
  v_fma_f32 v173, v173, v191, v191
  v_fma_f32 v174, v174, v191, v191
  v_fma_f32 v171, v171, v190, v189
  v_mul_f32 v168, v168, v60
  v_mul_f32 v169, v169, v61
  v_mfma_f32_32x32x16_bf16 v[104:119], v[128:131], v[240:243], v[104:119]
  ds_read_b128 v[124:127], v27 offset:5120
  v_fma_f32 v175, v175, v191, v191
  v_rcp_f32 v172, v172
  v_mul_f32 v170, v170, v62
  v_mul_f32 v171, v171, v63
  v_mfma_f32_32x32x16_bf16 v[104:119], v[132:135], v[244:247], v[104:119]
  s_waitcnt lgkmcnt(4)
  ds_read_b128 v[128:131], v27 offset:6144
  v_rcp_f32 v173, v173
  v_exp_f32 v168, v168
  v_mul_f32 v68, v68, v60
  v_mfma_f32_32x32x16_bf16 v[104:119], v[136:139], v[248:251], v[104:119]
  ds_read_b128 v[132:135], v27 offset:7168
  buffer_load_dwordx4 v2, s[40:43], s6 offen offset:2048 sc1 lds
  v_rcp_f32 v174, v174
  v_mfma_f32_32x32x16_bf16 v[104:119], v[140:143], v[252:255], v[104:119]
  ds_read_b128 v[136:139], v27 offset:8192
  v_rcp_f32 v175, v175
  v_exp_f32 v169, v169
  v_mul_f32 v69, v69, v61
  v_mfma_f32_32x32x16_bf16 v[104:119], v[144:147], a[192:195], v[104:119]
  ds_read_b128 v[140:143], v27 offset:9216
  v_mul_f32 v80, v80, v172
  v_exp_f32 v170, v170
  v_mul_f32 v70, v70, v62
  v_mul_f32 v81, v81, v173
  v_mfma_f32_32x32x16_bf16 v[104:119], v[148:151], a[196:199], v[104:119]
  s_waitcnt lgkmcnt(4)
  ds_read_b128 v[144:147], v27 offset:10240
  v_mul_f32 v82, v82, v174
  v_exp_f32 v171, v171
  v_mul_f32 v71, v71, v63
  v_fma_f32 v168, v168, v191, v191
  v_mfma_f32_32x32x16_bf16 v[104:119], v[152:155], a[200:203], v[104:119]
  ds_read_b128 v[148:151], v27 offset:11264
  buffer_load_dwordx4 v2, s[40:43], s6 offen offset:3072 sc1 lds
  s_add_u32 m0, s55, 114688
  s_add_u32 s6, s60, 196608
  v_mul_f32 v83, v83, v175
  v_cvt_pk_bf16_f32 v184, v80, v81
  v_mfma_f32_32x32x16_bf16 v[104:119], v[156:159], a[204:207], v[104:119]
  ds_read_b128 v[152:155], v27 offset:12288
  v_cvt_pk_bf16_f32 v185, v82, v83
  v_mul_f32 v176, v76, v76
  v_fma_f32 v169, v169, v191, v191
  v_fma_f32 v170, v170, v191, v191
  v_fma_f32 v171, v171, v191, v191
  v_mfma_f32_32x32x16_bf16 v[104:119], v[120:123], a[208:211], v[104:119]
  ds_read_b128 v[156:159], v27 offset:13312
  v_mul_f32 v177, v77, v77
  v_mul_f32 v178, v78, v78
  v_rcp_f32 v168, v168
  v_mul_f32 v179, v79, v79
  v_mfma_f32_32x32x16_bf16 v[104:119], v[124:127], a[212:215], v[104:119]
  s_waitcnt lgkmcnt(4)
  ds_read_b128 v[120:123], v27 offset:14336
  v_fma_f32 v176, v176, v190, v189
  v_rcp_f32 v169, v169
  v_rcp_f32 v170, v170
  v_mfma_f32_32x32x16_bf16 v[104:119], v[128:131], a[216:219], v[104:119]
  ds_read_b128 v[124:127], v27 offset:15360
  buffer_load_dwordx4 v2, s[40:43], s6 offen offset:0 sc1 lds
  v_fma_f32 v177, v177, v190, v189
  v_fma_f32 v178, v178, v190, v189
  v_fma_f32 v179, v179, v190, v189
  v_mfma_f32_32x32x16_bf16 v[104:119], v[132:135], a[220:223], v[104:119]
  ds_read_b128 v[128:131], v13 offset:2048
  v_mul_f32 v176, v176, v76
  v_rcp_f32 v171, v171
  v_mul_f32 v68, v68, v168
  v_mul_f32 v69, v69, v169
  v_mfma_f32_32x32x16_bf16 v[104:119], v[136:139], a[224:227], v[104:119]
  s_waitcnt vmcnt(14)
  s_barrier
  ds_read_b128 v[132:135], v188 offset:0
  v_add_u32 v27, 65536, v2
  v_mul_f32 v177, v177, v77
  v_mul_f32 v178, v178, v78
  v_mfma_f32_32x32x16_bf16 v[104:119], v[140:143], a[228:231], v[104:119]
  s_waitcnt lgkmcnt(4)
  ds_read_b128 v[136:139], v188 offset:1024
  v_mul_f32 v179, v179, v79
  v_exp_f32 v176, v176
  v_mul_f32 v70, v70, v170
  v_mul_f32 v71, v71, v171
  v_mfma_f32_32x32x16_bf16 v[104:119], v[144:147], a[232:235], v[104:119]
  ds_read_b128 v[140:143], v188 offset:2048
  buffer_load_dwordx4 v2, s[40:43], s6 offen offset:1024 sc1 lds
  v_mul_f32 v84, v84, v76
  v_cvt_pk_bf16_f32 v182, v68, v69
  v_cvt_pk_bf16_f32 v183, v70, v71
  v_mfma_f32_32x32x16_bf16 v[104:119], v[148:151], a[236:239], v[104:119]
  ds_read_b128 v[144:147], v188 offset:3072
  s_add_u32 s26, s86, 0
  buffer_store_dwordx4 v[180:183], v15, s[40:43], s26 offen sc1
  v_exp_f32 v177, v177
  v_mfma_f32_32x32x16_bf16 v[104:119], v[152:155], a[240:243], v[104:119]
  ds_read_b128 v[148:151], v188 offset:4096
  v_mul_f32 v85, v85, v77
  v_exp_f32 v178, v178
  v_mul_f32 v164, v88, v88
  v_mul_f32 v165, v89, v89
  v_mfma_f32_32x32x16_bf16 v[104:119], v[156:159], a[244:247], v[104:119]
  s_waitcnt lgkmcnt(4)
  ds_read_b128 v[152:155], v188 offset:5120
  v_mul_f32 v86, v86, v78
  v_mul_f32 v166, v90, v90
  v_mul_f32 v167, v91, v91
  v_fma_f32 v164, v164, v190, v189
  v_fma_f32 v165, v165, v190, v189
  v_mfma_f32_32x32x16_bf16 v[104:119], v[120:123], a[248:251], v[104:119]
  ds_read_b128 v[156:159], v188 offset:6144
  buffer_load_dwordx4 v2, s[40:43], s6 offen offset:2048 sc1 lds
  v_exp_f32 v179, v179
  v_fma_f32 v166, v166, v190, v189
  v_mfma_f32_32x32x16_bf16 v[104:119], v[124:127], a[252:255], v[104:119]
  ds_read_b128 v[120:123], v188 offset:7168
  v_mul_f32 v87, v87, v79
  v_fma_f32 v176, v176, v191, v191
  v_fma_f32 v167, v167, v190, v189
  v_mul_f32 v164, v164, v88
  v_mul_f32 v165, v165, v89
  v_mfma_f32_32x32x16_bf16 v[56:71], v[128:131], v[160:163], 0
  ds_read_b128 v[124:127], v188 offset:8192
  v_fma_f32 v177, v177, v191, v191
  v_fma_f32 v178, v178, v191, v191
  v_mul_f32 v166, v166, v90
  v_mul_f32 v167, v167, v91
  v_fma_f32 v179, v179, v191, v191
  v_mfma_f32_32x32x16_bf16 v[56:71], v[132:135], v[192:195], v[56:71]
  s_waitcnt lgkmcnt(4)
  ds_read_b128 v[128:131], v188 offset:9216
  v_rcp_f32 v176, v176
  v_exp_f32 v164, v164
  v_mul_f32 v96, v96, v88
  v_mfma_f32_32x32x16_bf16 v[56:71], v[136:139], v[196:199], v[56:71]
  ds_read_b128 v[132:135], v188 offset:10240
  buffer_load_dwordx4 v2, s[40:43], s6 offen offset:3072 sc1 lds
  s_add_u32 m0, s55, 131072
  s_add_u32 s6, s60, 212992
  v_rcp_f32 v177, v177
  v_mfma_f32_32x32x16_bf16 v[56:71], v[140:143], v[200:203], v[56:71]
  ds_read_b128 v[136:139], v188 offset:11264
  v_rcp_f32 v178, v178
  v_exp_f32 v165, v165
  v_mul_f32 v97, v97, v89
  v_mfma_f32_32x32x16_bf16 v[56:71], v[144:147], v[204:207], v[56:71]
  ds_read_b128 v[140:143], v188 offset:12288
  v_rcp_f32 v179, v179
  v_exp_f32 v166, v166
  v_mul_f32 v98, v98, v90
  v_mfma_f32_32x32x16_bf16 v[56:71], v[148:151], v[208:211], v[56:71]
  s_waitcnt lgkmcnt(4)
  ds_read_b128 v[144:147], v188 offset:13312
  v_mul_f32 v84, v84, v176
  v_exp_f32 v167, v167
  v_mul_f32 v99, v99, v91
  v_fma_f32 v164, v164, v191, v191
  v_mfma_f32_32x32x16_bf16 v[56:71], v[152:155], v[212:215], v[56:71]
  ds_read_b128 v[148:151], v188 offset:14336
  buffer_load_dwordx4 v2, s[40:43], s6 offen offset:0 sc1 lds
  v_mul_f32 v85, v85, v177
  v_mul_f32 v86, v86, v178
  v_fma_f32 v165, v165, v191, v191
  v_mfma_f32_32x32x16_bf16 v[56:71], v[156:159], v[216:219], v[56:71]
  ds_read_b128 v[152:155], v188 offset:15360
  v_mul_f32 v87, v87, v179
  v_cvt_pk_bf16_f32 v186, v84, v85
  v_fma_f32 v166, v166, v191, v191
  v_fma_f32 v167, v167, v191, v191
  v_cvt_pk_bf16_f32 v187, v86, v87
  v_mfma_f32_32x32x16_bf16 v[56:71], v[120:123], v[220:223], v[56:71]
  s_waitcnt vmcnt(14)
  s_barrier
  ds_read_b128 v[156:159], v27 offset:0
  v_add_u32 v188, 81920, v2
  v_rcp_f32 v164, v164
  v_mfma_f32_32x32x16_bf16 v[56:71], v[124:127], v[224:227], v[56:71]
  s_waitcnt lgkmcnt(4)
  ds_read_b128 v[120:123], v27 offset:1024
  s_add_u32 s26, s86, 4096
  buffer_store_dwordx4 v[184:187], v15, s[40:43], s26 offen sc1
  v_rcp_f32 v165, v165
  v_mfma_f32_32x32x16_bf16 v[56:71], v[128:131], v[228:231], v[56:71]
  ds_read_b128 v[124:127], v27 offset:2048
  buffer_load_dwordx4 v2, s[40:43], s6 offen offset:1024 sc1 lds
  v_mul_f32 v172, v104, v104
  v_mul_f32 v173, v105, v105
  v_mul_f32 v174, v106, v106
  v_mfma_f32_32x32x16_bf16 v[56:71], v[132:135], v[232:235], v[56:71]
  ds_read_b128 v[128:131], v27 offset:3072
  v_mul_f32 v175, v107, v107
  v_rcp_f32 v166, v166
  v_rcp_f32 v167, v167
  v_mfma_f32_32x32x16_bf16 v[56:71], v[136:139], v[236:239], v[56:71]
  ds_read_b128 v[132:135], v27 offset:4096
  v_fma_f32 v172, v172, v190, v189
  v_fma_f32 v173, v173, v190, v189
  v_mul_f32 v96, v96, v164
  v_mul_f32 v97, v97, v165
  v_mul_f32 v98, v98, v166
  v_mfma_f32_32x32x16_bf16 v[56:71], v[140:143], v[240:243], v[56:71]
  s_waitcnt lgkmcnt(4)
  ds_read_b128 v[136:139], v27 offset:5120
  v_fma_f32 v174, v174, v190, v189
  v_fma_f32 v175, v175, v190, v189
  v_mul_f32 v99, v99, v167
  v_cvt_pk_bf16_f32 v180, v96, v97
  v_cvt_pk_bf16_f32 v181, v98, v99
  v_mfma_f32_32x32x16_bf16 v[56:71], v[144:147], v[244:247], v[56:71]
  ds_read_b128 v[140:143], v27 offset:6144
  buffer_load_dwordx4 v2, s[40:43], s6 offen offset:2048 sc1 lds
  v_mul_f32 v172, v172, v104
  v_mul_f32 v173, v173, v105
  v_mul_f32 v168, v92, v92
  v_mfma_f32_32x32x16_bf16 v[56:71], v[148:151], v[248:251], v[56:71]
  ds_read_b128 v[144:147], v27 offset:7168
  v_mul_f32 v174, v174, v106
  v_mul_f32 v175, v175, v107
  v_mul_f32 v169, v93, v93
  v_mul_f32 v170, v94, v94
  v_mul_f32 v171, v95, v95
  v_mfma_f32_32x32x16_bf16 v[56:71], v[152:155], v[252:255], v[56:71]
  ds_read_b128 v[148:151], v27 offset:8192
  v_exp_f32 v172, v172
  v_fma_f32 v168, v168, v190, v189
  v_fma_f32 v169, v169, v190, v189
  v_fma_f32 v170, v170, v190, v189
  v_mfma_f32_32x32x16_bf16 v[56:71], v[156:159], a[192:195], v[56:71]
  s_waitcnt lgkmcnt(4)
  ds_read_b128 v[152:155], v27 offset:9216
  v_mul_f32 v112, v112, v104
  v_exp_f32 v173, v173
  v_fma_f32 v171, v171, v190, v189
  v_mul_f32 v168, v168, v92
  v_mfma_f32_32x32x16_bf16 v[56:71], v[120:123], a[196:199], v[56:71]
  ds_read_b128 v[156:159], v27 offset:10240
  buffer_load_dwordx4 v2, s[40:43], s6 offen offset:3072 sc1 lds
  s_add_u32 m0, s55, 16384
  s_add_u32 s6, s57, 0
  v_mul_f32 v113, v113, v105
  v_mfma_f32_32x32x16_bf16 v[56:71], v[124:127], a[200:203], v[56:71]
  ds_read_b128 v[120:123], v27 offset:11264
  v_exp_f32 v174, v174
  v_mul_f32 v169, v169, v93
  v_mul_f32 v170, v170, v94
  v_mul_f32 v171, v171, v95
  v_mfma_f32_32x32x16_bf16 v[56:71], v[128:131], a[204:207], v[56:71]
  ds_read_b128 v[124:127], v27 offset:12288
  v_mul_f32 v114, v114, v106
  v_exp_f32 v175, v175
  v_exp_f32 v168, v168
  v_mfma_f32_32x32x16_bf16 v[56:71], v[132:135], a[208:211], v[56:71]
  s_waitcnt lgkmcnt(4)
  ds_read_b128 v[128:131], v27 offset:13312
  v_mul_f32 v115, v115, v107
  v_mul_f32 v100, v100, v92
  v_exp_f32 v169, v169
  v_mul_f32 v101, v101, v93
  v_mfma_f32_32x32x16_bf16 v[56:71], v[136:139], a[212:215], v[56:71]
  ds_read_b128 v[132:135], v27 offset:14336
  buffer_load_dwordx4 v2, s[40:43], s6 offen offset:0 sc1 lds
  v_fma_f32 v172, v172, v191, v191
  v_fma_f32 v173, v173, v191, v191
  v_fma_f32 v174, v174, v191, v191
  v_mfma_f32_32x32x16_bf16 v[56:71], v[140:143], a[216:219], v[56:71]
  ds_read_b128 v[136:139], v27 offset:15360
  v_fma_f32 v175, v175, v191, v191
  v_exp_f32 v170, v170
  v_mul_f32 v102, v102, v94
  v_mfma_f32_32x32x16_bf16 v[56:71], v[144:147], a[220:223], v[56:71]
  ds_read_b128 v[140:143], v13 offset:2560
  v_rcp_f32 v172, v172
  v_exp_f32 v171, v171
  v_mul_f32 v103, v103, v95
  v_mfma_f32_32x32x16_bf16 v[56:71], v[148:151], a[224:227], v[56:71]
  s_waitcnt lgkmcnt(4)
  s_waitcnt vmcnt(15)
  s_barrier
  ds_read_b128 v[144:147], v188 offset:0
  v_add_u32 v27, 98304, v2
  v_rcp_f32 v173, v173
  v_mfma_f32_32x32x16_bf16 v[56:71], v[152:155], a[228:231], v[56:71]
  ds_read_b128 v[148:151], v188 offset:1024
  buffer_load_dwordx4 v2, s[40:43], s6 offen offset:1024 sc1 lds
  v_rcp_f32 v174, v174
  v_fma_f32 v168, v168, v191, v191
  v_mfma_f32_32x32x16_bf16 v[56:71], v[156:159], a[232:235], v[56:71]
  ds_read_b128 v[152:155], v188 offset:2048
  v_rcp_f32 v175, v175
  v_fma_f32 v169, v169, v191, v191
  v_fma_f32 v170, v170, v191, v191
  v_fma_f32 v171, v171, v191, v191
  v_mfma_f32_32x32x16_bf16 v[56:71], v[120:123], a[236:239], v[56:71]
  ds_read_b128 v[156:159], v188 offset:3072
  v_mul_f32 v112, v112, v172
  v_mul_f32 v113, v113, v173
  v_rcp_f32 v168, v168
  v_mul_f32 v114, v114, v174
  v_mfma_f32_32x32x16_bf16 v[56:71], v[124:127], a[240:243], v[56:71]
  s_waitcnt lgkmcnt(4)
  ds_read_b128 v[120:123], v188 offset:4096
  v_mul_f32 v115, v115, v175
  v_rcp_f32 v169, v169
  v_rcp_f32 v170, v170
  v_mfma_f32_32x32x16_bf16 v[56:71], v[128:131], a[244:247], v[56:71]
  ds_read_b128 v[124:127], v188 offset:5120
  buffer_load_dwordx4 v2, s[40:43], s6 offen offset:2048 sc1 lds
  v_cvt_pk_bf16_f32 v184, v112, v113
  v_cvt_pk_bf16_f32 v185, v114, v115
  v_mul_f32 v176, v108, v108
  v_mfma_f32_32x32x16_bf16 v[56:71], v[132:135], a[248:251], v[56:71]
  ds_read_b128 v[128:131], v188 offset:6144
  v_mul_f32 v177, v109, v109
  v_rcp_f32 v171, v171
  v_mul_f32 v100, v100, v168
  v_mul_f32 v101, v101, v169
  v_mfma_f32_32x32x16_bf16 v[56:71], v[136:139], a[252:255], v[56:71]
  ds_read_b128 v[132:135], v188 offset:7168
  v_mul_f32 v178, v110, v110
  v_mul_f32 v179, v111, v111
  v_mul_f32 v102, v102, v170
  v_mul_f32 v103, v103, v171
  v_cvt_pk_bf16_f32 v182, v100, v101
  v_mfma_f32_32x32x16_bf16 v[72:87], v[140:143], v[160:163], 0
  s_waitcnt lgkmcnt(4)
  ds_read_b128 v[136:139], v188 offset:8192
  v_fma_f32 v176, v176, v190, v189
  v_fma_f32 v177, v177, v190, v189
  v_cvt_pk_bf16_f32 v183, v102, v103
  v_fma_f32 v178, v178, v190, v189
  v_fma_f32 v179, v179, v190, v189
  v_mfma_f32_32x32x16_bf16 v[72:87], v[144:147], v[192:195], v[72:87]
  ds_read_b128 v[140:143], v188 offset:9216
  buffer_load_dwordx4 v2, s[40:43], s6 offen offset:3072 sc1 lds
  s_add_u32 s26, s86, 8192
  buffer_store_dwordx4 v[180:183], v15, s[40:43], s26 offen sc1
  v_mfma_f32_32x32x16_bf16 v[72:87], v[148:151], v[196:199], v[72:87]
  ds_read_b128 v[144:147], v188 offset:10240
  v_mul_f32 v176, v176, v108
  v_mul_f32 v177, v177, v109
  v_mul_f32 v164, v56, v56
  v_mul_f32 v165, v57, v57
  v_mul_f32 v166, v58, v58
  v_mfma_f32_32x32x16_bf16 v[72:87], v[152:155], v[200:203], v[72:87]
  ds_read_b128 v[148:151], v188 offset:11264
  v_mul_f32 v178, v178, v110
  v_mul_f32 v179, v179, v111
  v_mul_f32 v167, v59, v59
  v_fma_f32 v164, v164, v190, v189
  v_fma_f32 v165, v165, v190, v189
  v_mfma_f32_32x32x16_bf16 v[72:87], v[156:159], v[204:207], v[72:87]
  s_waitcnt lgkmcnt(4)
  ds_read_b128 v[152:155], v188 offset:12288
  v_exp_f32 v176, v176
  v_fma_f32 v166, v166, v190, v189
  v_fma_f32 v167, v167, v190, v189
  v_mul_f32 v164, v164, v56
  v_mfma_f32_32x32x16_bf16 v[72:87], v[120:123], v[208:211], v[72:87]
  ds_read_b128 v[156:159], v188 offset:13312
  v_mov_b32 v7, L_p3_0+6144-L_pc
  v_add_u32 v7, s39, v7
  global_load_dword v6, v7, s[90:91]
  s_add_u32 m0, s55, 32768
  s_add_u32 s6, s57, 16384
  v_mul_f32 v116, v116, v108
  v_exp_f32 v177, v177
  v_mfma_f32_32x32x16_bf16 v[72:87], v[124:127], v[212:215], v[72:87]
  ds_read_b128 v[120:123], v188 offset:14336
  buffer_load_dwordx4 v2, s[40:43], s6 offen offset:0 sc1 lds
  v_mul_f32 v117, v117, v109
  v_mul_f32 v165, v165, v57
  v_mul_f32 v166, v166, v58
  v_mfma_f32_32x32x16_bf16 v[72:87], v[128:131], v[216:219], v[72:87]
  ds_read_b128 v[124:127], v188 offset:15360
  v_exp_f32 v178, v178
  v_mul_f32 v167, v167, v59
  v_exp_f32 v164, v164
  v_mfma_f32_32x32x16_bf16 v[72:87], v[132:135], v[220:223], v[72:87]
  s_waitcnt lgkmcnt(3)
  s_waitcnt vmcnt(17)
  s_barrier
  ds_read_b128 v[128:131], v27 offset:0
  v_add_u32 v188, 114688, v2
  v_mul_f32 v118, v118, v110
  v_exp_f32 v179, v179
  v_mfma_f32_32x32x16_bf16 v[72:87], v[136:139], v[224:227], v[72:87]
  ds_read_b128 v[132:135], v27 offset:1024
  v_mul_f32 v119, v119, v111
  v_mul_f32 v64, v64, v56
  v_exp_f32 v165, v165
  v_mul_f32 v65, v65, v57
  v_mfma_f32_32x32x16_bf16 v[72:87], v[140:143], v[228:231], v[72:87]
  ds_read_b128 v[136:139], v27 offset:2048
  buffer_load_dwordx4 v2, s[40:43], s6 offen offset:1024 sc1 lds
  v_fma_f32 v176, v176, v191, v191
  v_fma_f32 v177, v177, v191, v191
  v_fma_f32 v178, v178, v191, v191
  v_mfma_f32_32x32x16_bf16 v[72:87], v[144:147], v[232:235], v[72:87]
  ds_read_b128 v[140:143], v27 offset:3072
  v_fma_f32 v179, v179, v191, v191
  v_exp_f32 v166, v166
  v_mul_f32 v66, v66, v58
  v_mfma_f32_32x32x16_bf16 v[72:87], v[148:151], v[236:239], v[72:87]
  ds_read_b128 v[144:147], v27 offset:4096
  v_rcp_f32 v176, v176
  v_exp_f32 v167, v167
  v_mul_f32 v67, v67, v59
  v_mfma_f32_32x32x16_bf16 v[72:87], v[152:155], v[240:243], v[72:87]
  s_waitcnt lgkmcnt(4)
  ds_read_b128 v[148:151], v27 offset:5120
  v_rcp_f32 v177, v177
  v_fma_f32 v164, v164, v191, v191
  v_fma_f32 v165, v165, v191, v191
  v_fma_f32 v166, v166, v191, v191
  v_mfma_f32_32x32x16_bf16 v[72:87], v[156:159], v[244:247], v[72:87]
  ds_read_b128 v[152:155], v27 offset:6144
  buffer_load_dwordx4 v2, s[40:43], s6 offen offset:2048 sc1 lds
  v_rcp_f32 v178, v178
  v_fma_f32 v167, v167, v191, v191
  v_mfma_f32_32x32x16_bf16 v[72:87], v[120:123], v[248:251], v[72:87]
  ds_read_b128 v[156:159], v27 offset:7168
  v_rcp_f32 v179, v179
  v_rcp_f32 v164, v164
  v_mul_f32 v116, v116, v176
  v_mfma_f32_32x32x16_bf16 v[72:87], v[124:127], v[252:255], v[72:87]
  ds_read_b128 v[120:123], v27 offset:8192
  v_mul_f32 v117, v117, v177
  v_rcp_f32 v165, v165
  v_rcp_f32 v166, v166
  v_mfma_f32_32x32x16_bf16 v[72:87], v[128:131], a[192:195], v[72:87]
  s_waitcnt lgkmcnt(4)
  ds_read_b128 v[124:127], v27 offset:9216
  v_mul_f32 v118, v118, v178
  v_mul_f32 v119, v119, v179
  v_rcp_f32 v167, v167
  v_mul_f32 v64, v64, v164
  v_mfma_f32_32x32x16_bf16 v[72:87], v[132:135], a[196:199], v[72:87]
  ds_read_b128 v[128:131], v27 offset:10240
  buffer_load_dwordx4 v2, s[40:43], s6 offen offset:3072 sc1 lds
  s_add_u32 m0, s55, 49152
  s_add_u32 s6, s57, 32768
  v_cvt_pk_bf16_f32 v186, v116, v117
  v_cvt_pk_bf16_f32 v187, v118, v119
  v_mfma_f32_32x32x16_bf16 v[72:87], v[136:139], a[200:203], v[72:87]
  ds_read_b128 v[132:135], v27 offset:11264
  s_add_u32 s26, s86, 12288
  buffer_store_dwordx4 v[184:187], v15, s[40:43], s26 offen sc1
  v_mul_f32 v65, v65, v165
  v_mul_f32 v66, v66, v166
  v_mfma_f32_32x32x16_bf16 v[72:87], v[140:143], a[204:207], v[72:87]
  ds_read_b128 v[136:139], v27 offset:12288
  v_mul_f32 v67, v67, v167
  v_cvt_pk_bf16_f32 v180, v64, v65
  v_cvt_pk_bf16_f32 v181, v66, v67
  v_mul_f32 v168, v60, v60
  v_mul_f32 v169, v61, v61
  v_mfma_f32_32x32x16_bf16 v[72:87], v[144:147], a[208:211], v[72:87]
  s_waitcnt lgkmcnt(4)
  ds_read_b128 v[140:143], v27 offset:13312
  v_mul_f32 v170, v62, v62
  v_mul_f32 v171, v63, v63
  v_fma_f32 v168, v168, v190, v189
  v_fma_f32 v169, v169, v190, v189
  v_fma_f32 v170, v170, v190, v189
  v_mfma_f32_32x32x16_bf16 v[72:87], v[148:151], a[212:215], v[72:87]
  ds_read_b128 v[144:147], v27 offset:14336
  buffer_load_dwordx4 v2, s[40:43], s6 offen offset:0 sc1 lds
  v_fma_f32 v171, v171, v190, v189
  v_mul_f32 v168, v168, v60
  v_mul_f32 v169, v169, v61
  v_mfma_f32_32x32x16_bf16 v[72:87], v[152:155], a[216:219], v[72:87]
  ds_read_b128 v[148:151], v27 offset:15360
  v_mul_f32 v170, v170, v62
  v_mul_f32 v171, v171, v63
  v_exp_f32 v168, v168
  v_mul_f32 v68, v68, v60
  v_mfma_f32_32x32x16_bf16 v[72:87], v[156:159], a[220:223], v[72:87]
  ds_read_b128 v[152:155], v13 offset:3072
  v_exp_f32 v169, v169
  v_mul_f32 v69, v69, v61
  v_exp_f32 v170, v170
  v_mfma_f32_32x32x16_bf16 v[72:87], v[120:123], a[224:227], v[72:87]
  s_waitcnt lgkmcnt(4)
  s_waitcnt vmcnt(17)
  s_barrier
  ds_read_b128 v[156:159], v188 offset:0
  v_add_u32 v27, 131072, v2
  v_mul_f32 v70, v70, v62
  v_mfma_f32_32x32x16_bf16 v[72:87], v[124:127], a[228:231], v[72:87]
  ds_read_b128 v[120:123], v188 offset:1024
  buffer_load_dwordx4 v2, s[40:43], s6 offen offset:1024 sc1 lds
  v_exp_f32 v171, v171
  v_mul_f32 v71, v71, v63
  s_and_b32 s3, s51, 1
  s_lshl_b32 s3, s3, 2
  s_add_u32 s3, s3, s53
  s_mul_i32 s85, s3, 114688
  s_and_b32 s4, s52, 1
  s_mul_i32 s4, s4, 28672
  s_add_u32 s85, s85, s4
  s_add_u32 s85, s85, s54
  s_add_u32 s85, s85, 1572864
  v_mfma_f32_32x32x16_bf16 v[72:87], v[128:131], a[232:235], v[72:87]
  ds_read_b128 v[124:127], v188 offset:2048
  v_fma_f32 v168, v168, v191, v191
  v_fma_f32 v169, v169, v191, v191
  v_fma_f32 v170, v170, v191, v191
  v_fma_f32 v171, v171, v191, v191
  v_mfma_f32_32x32x16_bf16 v[72:87], v[132:135], a[236:239], v[72:87]
  ds_read_b128 v[128:131], v188 offset:3072
  v_rcp_f32 v168, v168
  v_rcp_f32 v169, v169
  v_mfma_f32_32x32x16_bf16 v[72:87], v[136:139], a[240:243], v[72:87]
  s_waitcnt lgkmcnt(3)
  ds_read_b128 v[132:135], v188 offset:4096
  buffer_load_dwordx4 v2, s[40:43], s6 offen offset:2048 sc1 lds
  v_rcp_f32 v170, v170
  v_mfma_f32_32x32x16_bf16 v[72:87], v[140:143], a[244:247], v[72:87]
  ds_read_b128 v[136:139], v188 offset:5120
  v_rcp_f32 v171, v171
  v_mul_f32 v68, v68, v168
  v_mul_f32 v69, v69, v169
  v_mul_f32 v70, v70, v170
  v_mfma_f32_32x32x16_bf16 v[72:87], v[144:147], a[248:251], v[72:87]
  ds_read_b128 v[140:143], v188 offset:6144
  v_mul_f32 v71, v71, v171
  v_cvt_pk_bf16_f32 v182, v68, v69
  v_cvt_pk_bf16_f32 v183, v70, v71
  v_mfma_f32_32x32x16_bf16 v[72:87], v[148:151], a[252:255], v[72:87]
  ds_read_b128 v[144:147], v188 offset:7168
  s_add_u32 s26, s86, 16384
  buffer_store_dwordx4 v[180:183], v15, s[40:43], s26 offen sc1
  v_mfma_f32_32x32x16_bf16 v[88:103], v[152:155], v[160:163], 0
  ds_read_b128 v[148:151], v188 offset:8192
  buffer_load_dwordx4 v2, s[40:43], s6 offen offset:3072 sc1 lds
  s_add_u32 m0, s55, 0
  s_add_u32 s6, s57, 49152
  v_mfma_f32_32x32x16_bf16 v[88:103], v[156:159], v[192:195], v[88:103]
  s_waitcnt lgkmcnt(4)
  ds_read_b128 v[152:155], v188 offset:9216
  v_mfma_f32_32x32x16_bf16 v[88:103], v[120:123], v[196:199], v[88:103]
  ds_read_b128 v[156:159], v188 offset:10240
  v_mul_f32 v172, v72, v72
  v_mul_f32 v173, v73, v73
  v_mul_f32 v174, v74, v74
  v_mul_f32 v175, v75, v75
  v_fma_f32 v172, v172, v190, v189
  v_fma_f32 v173, v173, v190, v189
  v_fma_f32 v174, v174, v190, v189
  v_fma_f32 v175, v175, v190, v189
  v_mul_f32 v172, v172, v72
  v_mul_f32 v173, v173, v73
  v_mfma_f32_32x32x16_bf16 v[88:103], v[124:127], v[200:203], v[88:103]
  ds_read_b128 v[120:123], v188 offset:11264
  buffer_load_dwordx4 v2, s[40:43], s6 offen offset:0 sc1 lds
  v_mul_f32 v174, v174, v74
  v_mul_f32 v175, v175, v75
  v_exp_f32 v172, v172
  v_mul_f32 v80, v80, v72
  v_exp_f32 v173, v173
  v_mul_f32 v81, v81, v73
  v_mfma_f32_32x32x16_bf16 v[88:103], v[128:131], v[204:207], v[88:103]
  ds_read_b128 v[124:127], v188 offset:12288
  v_exp_f32 v174, v174
  v_mul_f32 v82, v82, v74
  v_exp_f32 v175, v175
  v_mul_f32 v83, v83, v75
  v_fma_f32 v172, v172, v191, v191
  v_fma_f32 v173, v173, v191, v191
  v_fma_f32 v174, v174, v191, v191
  v_fma_f32 v175, v175, v191, v191
  v_mfma_f32_32x32x16_bf16 v[88:103], v[132:135], v[208:211], v[88:103]
  s_waitcnt lgkmcnt(2)
  ds_read_b128 v[128:131], v188 offset:13312
  v_rcp_f32 v172, v172
  v_rcp_f32 v173, v173
  v_rcp_f32 v174, v174
  v_rcp_f32 v175, v175
  v_mul_f32 v80, v80, v172
  v_mfma_f32_32x32x16_bf16 v[88:103], v[136:139], v[212:215], v[88:103]
  ds_read_b128 v[132:135], v188 offset:14336
  buffer_load_dwordx4 v2, s[40:43], s6 offen offset:1024 sc1 lds
  v_mul_f32 v81, v81, v173
  v_mul_f32 v82, v82, v174
  v_mul_f32 v83, v83, v175
  v_mfma_f32_32x32x16_bf16 v[88:103], v[140:143], v[216:219], v[88:103]
  ds_read_b128 v[136:139], v188 offset:15360
  v_cvt_pk_bf16_f32 v184, v80, v81
  v_cvt_pk_bf16_f32 v185, v82, v83
  v_mul_f32 v176, v76, v76
  v_mul_f32 v177, v77, v77
  v_mul_f32 v178, v78, v78
  v_mfma_f32_32x32x16_bf16 v[88:103], v[144:147], v[220:223], v[88:103]
  s_waitcnt vmcnt(7)
  s_barrier
  ds_read_b128 v[140:143], v27 offset:0
  v_mul_f32 v179, v79, v79
  v_fma_f32 v176, v176, v190, v189
  v_fma_f32 v177, v177, v190, v189
  v_mfma_f32_32x32x16_bf16 v[88:103], v[148:151], v[224:227], v[88:103]
  ds_read_b128 v[144:147], v27 offset:1024
  s_add_u32 s38, s37, 4
  v_mov_b32 v26, s38
  buffer_store_dword v26, v9, s[40:43], s67 offen
  buffer_store_dword v26, v9, s[44:47], s67 offen offset:256 sc1
  v_mfma_f32_32x32x16_bf16 v[88:103], v[152:155], v[228:231], v[88:103]
  ds_read_b128 v[148:151], v27 offset:2048
  buffer_load_dwordx4 v2, s[40:43], s6 offen offset:2048 sc1 lds
  v_fma_f32 v178, v178, v190, v189
  v_fma_f32 v179, v179, v190, v189
  v_mul_f32 v176, v176, v76
  v_mfma_f32_32x32x16_bf16 v[88:103], v[156:159], v[232:235], v[88:103]
  s_waitcnt lgkmcnt(4)
  ds_read_b128 v[152:155], v27 offset:3072
  v_mul_f32 v177, v177, v77
  v_mul_f32 v178, v178, v78
  v_mul_f32 v179, v179, v79
  v_exp_f32 v176, v176
  v_mfma_f32_32x32x16_bf16 v[88:103], v[120:123], v[236:239], v[88:103]
  ds_read_b128 v[156:159], v27 offset:4096
  v_mul_f32 v84, v84, v76
  v_exp_f32 v177, v177
  v_mul_f32 v85, v85, v77
  v_mfma_f32_32x32x16_bf16 v[88:103], v[124:127], v[240:243], v[88:103]
  ds_read_b128 v[120:123], v27 offset:5120
  v_exp_f32 v178, v178
  v_mul_f32 v86, v86, v78
  v_exp_f32 v179, v179
  v_mfma_f32_32x32x16_bf16 v[88:103], v[128:131], v[244:247], v[88:103]
  ds_read_b128 v[124:127], v27 offset:6144
  buffer_load_dwordx4 v2, s[40:43], s6 offen offset:3072 sc1 lds
  s_add_u32 m0, s55, 65536
  s_add_u32 s6, s57, 65536
  v_mul_f32 v87, v87, v79
  v_mfma_f32_32x32x16_bf16 v[88:103], v[132:135], v[248:251], v[88:103]
  s_waitcnt lgkmcnt(4)
  ds_read_b128 v[128:131], v27 offset:7168
  v_fma_f32 v176, v176, v191, v191
  v_fma_f32 v177, v177, v191, v191
  v_fma_f32 v178, v178, v191, v191
  v_fma_f32 v179, v179, v191, v191
  v_mfma_f32_32x32x16_bf16 v[88:103], v[136:139], v[252:255], v[88:103]
  ds_read_b128 v[132:135], v27 offset:8192
  v_rcp_f32 v176, v176
  v_rcp_f32 v177, v177
  v_mfma_f32_32x32x16_bf16 v[88:103], v[140:143], a[192:195], v[88:103]
  ds_read_b128 v[136:139], v27 offset:9216
  v_rcp_f32 v178, v178
  v_rcp_f32 v179, v179
  v_mul_f32 v84, v84, v176
  v_mfma_f32_32x32x16_bf16 v[88:103], v[144:147], a[196:199], v[88:103]
  ds_read_b128 v[140:143], v27 offset:10240
  buffer_load_dwordx4 v2, s[40:43], s6 offen offset:0 sc1 lds
  v_mul_f32 v85, v85, v177
  v_mul_f32 v86, v86, v178
  v_mul_f32 v87, v87, v179
  v_mfma_f32_32x32x16_bf16 v[88:103], v[148:151], a[200:203], v[88:103]
  s_waitcnt lgkmcnt(4)
  ds_read_b128 v[144:147], v27 offset:11264
  buffer_load_dword v1, v17, s[40:43], s65 offen sc1
  v_cvt_pk_bf16_f32 v186, v84, v85
  v_cvt_pk_bf16_f32 v187, v86, v87
  v_mfma_f32_32x32x16_bf16 v[88:103], v[152:155], a[204:207], v[88:103]
  ds_read_b128 v[148:151], v27 offset:12288
  s_add_u32 s26, s86, 20480
  buffer_store_dwordx4 v[184:187], v15, s[40:43], s26 offen sc1
  v_mfma_f32_32x32x16_bf16 v[88:103], v[156:159], a[208:211], v[88:103]
  ds_read_b128 v[152:155], v27 offset:13312
  v_mfma_f32_32x32x16_bf16 v[88:103], v[120:123], a[212:215], v[88:103]
  ds_read_b128 v[156:159], v27 offset:14336
  buffer_load_dwordx4 v2, s[40:43], s6 offen offset:1024 sc1 lds
  v_mfma_f32_32x32x16_bf16 v[88:103], v[124:127], a[216:219], v[88:103]
  s_waitcnt lgkmcnt(4)
  ds_read_b128 v[120:123], v27 offset:15360
  v_mfma_f32_32x32x16_bf16 v[88:103], v[128:131], a[220:223], v[88:103]
  v_mfma_f32_32x32x16_bf16 v[88:103], v[132:135], a[224:227], v[88:103]
  v_mfma_f32_32x32x16_bf16 v[88:103], v[136:139], a[228:231], v[88:103]
  buffer_load_dwordx4 v2, s[40:43], s6 offen offset:2048 sc1 lds
  v_mfma_f32_32x32x16_bf16 v[88:103], v[140:143], a[232:235], v[88:103]
  s_waitcnt lgkmcnt(1)
  v_mfma_f32_32x32x16_bf16 v[88:103], v[144:147], a[236:239], v[88:103]
  v_mfma_f32_32x32x16_bf16 v[88:103], v[148:151], a[240:243], v[88:103]
  v_mfma_f32_32x32x16_bf16 v[88:103], v[152:155], a[244:247], v[88:103]
  buffer_load_dwordx4 v2, s[40:43], s6 offen offset:3072 sc1 lds
  v_mfma_f32_32x32x16_bf16 v[88:103], v[156:159], a[248:251], v[88:103]
  s_waitcnt lgkmcnt(0)
  v_mfma_f32_32x32x16_bf16 v[88:103], v[120:123], a[252:255], v[88:103]
L_p4_0:
  s_barrier
  v_add_u32 v172, 0, v5
  v_xor_b32 v173, 1024, v172
  v_add_u32 v174, 65536, v5
  v_xor_b32 v175, 1024, v174
  v_add_u32 v176, 131072, v5
  v_xor_b32 v177, 1024, v176
  ds_read_b128 v[120:123], v173 offset:16384
  ds_read_b128 v[124:127], v172 offset:16384
  ds_read_b128 v[128:131], v173 offset:18432
  ds_read_b128 v[132:135], v172 offset:18432
  ds_read_b128 v[136:139], v173 offset:20480
  ds_read_b128 v[140:143], v172 offset:20480
  ds_read_b128 v[144:147], v173 offset:22528
  ds_read_b128 v[148:151], v172 offset:22528
  s_and_b32 s3, s48, 31
  s_lshl_b32 s3, s3, 2
  s_add_u32 s3, s3, s53
  s_lshl_b32 s20, s3, 11
  s_add_u32 s20, s20, s54
  s_add_u32 s20, s20, 786432
  s_xor_b32 s21, s20, 8192
  s_lshl_b32 s98, s3, 2
  s_add_u32 s98, s98, s54
  s_xor_b32 s99, s98, 16
  v_pk_mul_f32 v[164:165], v[88:89], v[88:89] op_sel:[0,0] op_sel_hi:[1,1]
  v_pk_mul_f32 v[166:167], v[90:91], v[90:91] op_sel:[0,0] op_sel_hi:[1,1]
  s_add_u32 s27, s37, 4
  s_waitcnt vmcnt(4)
  v_subrev_u32 v1, s27, v1
  v_cmp_le_u32 vcc, 16, v1
  s_mov_b32 s7, 0
  s_cbranch_vccz L_ckd_11
L_ck_10:
  buffer_load_dword v1, v17, s[40:43], s65 offen sc1
  s_add_u32 s7, s7, 1
  s_waitcnt vmcnt(0)
  v_subrev_u32 v1, s27, v1
  v_cmp_le_u32 vcc, 16, v1
  s_and_b32 s5, s7, s22
  s_cbranch_vccz L_ckd_11
  s_cbranch_scc1 L_ck_10
  buffer_load_dword v12, v17, s[40:43], s65 offen offset:256 sc1
  s_waitcnt vmcnt(0)
  v_subrev_u32 v12, s27, v12
  v_cmp_le_u32 vcc, 16, v12
  s_cmp_lt_u32 s7, 0x40000
  s_cbranch_vccz L_ckd_11
  s_cbranch_scc1 L_ck_10
L_ckd_11:
  buffer_load_dwordx4 v[192:195], v11, s[40:43], s85 offen offset:0 sc1
  v_pk_mul_f32 v[168:169], v[92:93], v[92:93] op_sel:[0,0] op_sel_hi:[1,1]
  v_pk_mul_f32 v[170:171], v[94:95], v[94:95] op_sel:[0,0] op_sel_hi:[1,1]
  buffer_load_dwordx4 v[196:199], v11, s[40:43], s85 offen offset:512 sc1
  v_pk_fma_f32 v[164:165], v[164:165], v[190:191], v[188:189] op_sel:[0,0,1] op_sel_hi:[1,0,1]
  v_pk_fma_f32 v[166:167], v[166:167], v[190:191], v[188:189] op_sel:[0,0,1] op_sel_hi:[1,0,1]
  v_pk_fma_f32 v[168:169], v[168:169], v[190:191], v[188:189] op_sel:[0,0,1] op_sel_hi:[1,0,1]
  buffer_load_dwordx4 v[200:203], v11, s[40:43], s85 offen offset:1024 sc1
  v_pk_fma_f32 v[170:171], v[170:171], v[190:191], v[188:189] op_sel:[0,0,1] op_sel_hi:[1,0,1]
  v_pk_mul_f32 v[164:165], v[164:165], v[88:89] op_sel:[0,0] op_sel_hi:[1,1]
  v_pk_mul_f32 v[166:167], v[166:167], v[90:91] op_sel:[0,0] op_sel_hi:[1,1]
  buffer_load_dwordx4 v[204:207], v11, s[40:43], s85 offen offset:1536 sc1
  v_pk_mul_f32 v[168:169], v[168:169], v[92:93] op_sel:[0,0] op_sel_hi:[1,1]
  v_pk_mul_f32 v[170:171], v[170:171], v[94:95] op_sel:[0,0] op_sel_hi:[1,1]
  v_exp_f32 v164, v164
  buffer_load_dwordx4 v[208:211], v11, s[40:43], s85 offen offset:2048 sc1
  v_exp_f32 v165, v165
  v_pk_mul_f32 v[96:97], v[96:97], v[88:89] op_sel:[0,0] op_sel_hi:[1,1]
  v_exp_f32 v166, v166
  buffer_load_dwordx4 v[212:215], v11, s[40:43], s85 offen offset:2560 sc1
  v_exp_f32 v167, v167
  v_pk_mul_f32 v[98:99], v[98:99], v[90:91] op_sel:[0,0] op_sel_hi:[1,1]
  v_exp_f32 v168, v168
  buffer_load_dwordx4 v[216:219], v11, s[40:43], s85 offen offset:3072 sc1
  v_exp_f32 v169, v169
  v_pk_mul_f32 v[100:101], v[100:101], v[92:93] op_sel:[0,0] op_sel_hi:[1,1]
  v_exp_f32 v170, v170
  buffer_load_dwordx4 v[220:223], v11, s[40:43], s85 offen offset:3584 sc1
  v_exp_f32 v171, v171
  v_pk_mul_f32 v[102:103], v[102:103], v[94:95] op_sel:[0,0] op_sel_hi:[1,1]
  s_add_u32 s85, s85, 4096
  buffer_load_dwordx4 v[224:227], v11, s[40:43], s85 offen offset:0 sc1
  v_pk_fma_f32 v[164:165], v[164:165], v[190:191], v[190:191] op_sel:[0,1,1] op_sel_hi:[1,1,1]
  v_pk_fma_f32 v[166:167], v[166:167], v[190:191], v[190:191] op_sel:[0,1,1] op_sel_hi:[1,1,1]
  v_pk_fma_f32 v[168:169], v[168:169], v[190:191], v[190:191] op_sel:[0,1,1] op_sel_hi:[1,1,1]
  buffer_load_dwordx4 v[228:231], v11, s[40:43], s85 offen offset:512 sc1
  v_pk_fma_f32 v[170:171], v[170:171], v[190:191], v[190:191] op_sel:[0,1,1] op_sel_hi:[1,1,1]
  v_rcp_f32 v164, v164
  v_rcp_f32 v165, v165
  buffer_load_dwordx4 v[232:235], v11, s[40:43], s85 offen offset:1024 sc1
  v_rcp_f32 v166, v166
  v_rcp_f32 v167, v167
  v_rcp_f32 v168, v168
  buffer_load_dwordx4 v[236:239], v11, s[40:43], s85 offen offset:1536 sc1
  v_rcp_f32 v169, v169
  v_rcp_f32 v170, v170
  v_rcp_f32 v171, v171
  buffer_load_dwordx4 v[240:243], v11, s[40:43], s85 offen offset:2048 sc1
  v_pk_mul_f32 v[96:97], v[96:97], v[164:165] op_sel:[0,0] op_sel_hi:[1,1]
  v_pk_mul_f32 v[98:99], v[98:99], v[166:167] op_sel:[0,0] op_sel_hi:[1,1]
  v_pk_mul_f32 v[100:101], v[100:101], v[168:169] op_sel:[0,0] op_sel_hi:[1,1]
  buffer_load_dwordx4 v[244:247], v11, s[40:43], s85 offen offset:2560 sc1
  v_pk_mul_f32 v[102:103], v[102:103], v[170:171] op_sel:[0,0] op_sel_hi:[1,1]
  v_cvt_pk_bf16_f32 v180, v96, v97
  v_cvt_pk_bf16_f32 v181, v98, v99
  v_cvt_pk_bf16_f32 v182, v100, v101
  v_cvt_pk_bf16_f32 v183, v102, v103
  s_add_u32 s26, s86, 24576
  buffer_store_dwordx4 v[180:183], v15, s[40:43], s26 offen sc1
  s_and_b32 s3, s51, 1
  s_lshl_b32 s3, s3, 2
  s_add_u32 s3, s3, s53
  s_mov_b32 s5, s52
  s_lshl_b32 s96, s3, 15
  s_lshl_b32 s4, s5, 10
  s_add_u32 s96, s96, s4
  s_add_u32 s96, s96, s54
  s_add_u32 s96, s96, 262144
  s_lshl_b32 s97, s3, 12
  s_lshl_b32 s4, s5, 8
  s_add_u32 s97, s97, s4
  s_add_u32 s97, s97, s54
  s_add_u32 s97, s97, 32768
  v_and_b32 v116, 256, v10
  v_add_u32 v116, v116, v10
  s_waitcnt vmcnt(14) lgkmcnt(0)
  ds_read_b128 v[152:155], v173 offset:24576
  buffer_load_dwordx4 v[248:251], v11, s[40:43], s85 offen offset:3072 sc1
  s_add_u32 m0, s55, 81920
  s_add_u32 s6, s57, 81920
  buffer_load_dwordx4 v2, s[40:43], s6 offen offset:0 sc1 lds
  v_mfma_f32_32x32x16_bf16 v[72:87], v[120:123], v[192:195], 0
  ds_read_b128 v[156:159], v172 offset:24576
  v_mfma_f32_32x32x16_bf16 v[56:71], v[124:127], v[192:195], v[40:55]
  s_waitcnt vmcnt(15)
  ds_read_b128 v[120:123], v173 offset:26624
  buffer_load_dwordx4 v[252:255], v11, s[40:43], s85 offen offset:3584 sc1
  v_mfma_f32_32x32x16_bf16 v[72:87], v[128:131], v[196:199], v[72:87]
  ds_read_b128 v[124:127], v172 offset:26624
  v_mfma_f32_32x32x16_bf16 v[56:71], v[132:135], v[196:199], v[56:71]
  s_waitcnt vmcnt(15)
  ds_read_b128 v[128:131], v173 offset:28672
  s_add_u32 s85, s85, 4096
  buffer_load_dwordx4 a[192:195], v11, s[40:43], s85 offen offset:0 sc1
  buffer_load_dwordx4 v2, s[40:43], s6 offen offset:1024 sc1 lds
  v_mfma_f32_32x32x16_bf16 v[72:87], v[136:139], v[200:203], v[72:87]
  ds_read_b128 v[132:135], v172 offset:28672
  v_mfma_f32_32x32x16_bf16 v[56:71], v[140:143], v[200:203], v[56:71]
  s_waitcnt vmcnt(16) lgkmcnt(4)
  ds_read_b128 v[136:139], v173 offset:30720
  buffer_load_dwordx4 a[196:199], v11, s[40:43], s85 offen offset:512 sc1
  v_mfma_f32_32x32x16_bf16 v[72:87], v[144:147], v[204:207], v[72:87]
  ds_read_b128 v[140:143], v172 offset:30720
  v_mfma_f32_32x32x16_bf16 v[56:71], v[148:151], v[204:207], v[56:71]
  s_waitcnt vmcnt(16) lgkmcnt(4)
  ds_read_b128 v[144:147], v173 offset:32768
  buffer_load_dwordx4 a[200:203], v11, s[40:43], s85 offen offset:1024 sc1
  buffer_load_dwordx4 v2, s[40:43], s6 offen offset:2048 sc1 lds
  v_mfma_f32_32x32x16_bf16 v[72:87], v[152:155], v[208:211], v[72:87]
  ds_read_b128 v[148:151], v172 offset:32768
  v_mfma_f32_32x32x16_bf16 v[56:71], v[156:159], v[208:211], v[56:71]
  s_waitcnt vmcnt(17) lgkmcnt(4)
  ds_read_b128 v[152:155], v173 offset:34816
  buffer_load_dwordx4 a[204:207], v11, s[40:43], s85 offen offset:1536 sc1
  v_mfma_f32_32x32x16_bf16 v[72:87], v[120:123], v[212:215], v[72:87]
  ds_read_b128 v[156:159], v172 offset:34816
  v_mfma_f32_32x32x16_bf16 v[56:71], v[124:127], v[212:215], v[56:71]
  s_waitcnt vmcnt(17) lgkmcnt(4)
  s_waitcnt vmcnt(9)
  s_barrier
  s_add_u32 s38, s37, 5
  v_mov_b32 v26, s38
  buffer_store_dword v26, v9, s[40:43], s67 offen
  buffer_store_dword v26, v9, s[44:47], s67 offen offset:256 sc1
  ds_read_b128 v[120:123], v173 offset:36864
  v_mfma_f32_32x32x16_bf16 v[72:87], v[128:131], v[216:219], v[72:87]
  ds_read_b128 v[124:127], v172 offset:36864
  buffer_load_dwordx4 a[208:211], v11, s[40:43], s85 offen offset:2048 sc1
  buffer_load_dwordx4 v2, s[40:43], s6 offen offset:3072 sc1 lds
  s_add_u32 m0, s55, 98304
  v_mfma_f32_32x32x16_bf16 v[56:71], v[132:135], v[216:219], v[56:71]
  ds_read_b128 v[128:131], v173 offset:38912
  s_add_u32 s6, s57, 98304
  v_mfma_f32_32x32x16_bf16 v[72:87], v[136:139], v[220:223], v[72:87]
  ds_read_b128 v[132:135], v172 offset:38912
  buffer_load_dwordx4 a[212:215], v11, s[40:43], s85 offen offset:2560 sc1
  v_mfma_f32_32x32x16_bf16 v[56:71], v[140:143], v[220:223], v[56:71]
  s_waitcnt lgkmcnt(4)
  ds_read_b128 v[136:139], v173 offset:40960
  v_mfma_f32_32x32x16_bf16 v[72:87], v[144:147], v[224:227], v[72:87]
  ds_read_b128 v[140:143], v172 offset:40960
  buffer_load_dwordx4 a[216:219], v11, s[40:43], s85 offen offset:3072 sc1
  buffer_load_dwordx4 v2, s[40:43], s6 offen offset:0 sc1 lds
  v_mfma_f32_32x32x16_bf16 v[56:71], v[148:151], v[224:227], v[56:71]
  ds_read_b128 v[144:147], v173 offset:43008
  v_mfma_f32_32x32x16_bf16 v[72:87], v[152:155], v[228:231], v[72:87]
  ds_read_b128 v[148:151], v172 offset:43008
  buffer_load_dwordx4 a[220:223], v11, s[40:43], s85 offen offset:3584 sc1
  v_mfma_f32_32x32x16_bf16 v[56:71], v[156:159], v[228:231], v[56:71]
  s_waitcnt lgkmcnt(4)
  ds_read_b128 v[152:155], v173 offset:45056
  v_mfma_f32_32x32x16_bf16 v[72:87], v[120:123], v[232:235], v[72:87]
  ds_read_b128 v[156:159], v172 offset:45056
  s_add_u32 s85, s85, 4096
  buffer_load_dwordx4 a[224:227], v11, s[40:43], s85 offen offset:0 sc1
  buffer_load_dwordx4 v2, s[40:43], s6 offen offset:1024 sc1 lds
  v_mfma_f32_32x32x16_bf16 v[56:71], v[124:127], v[232:235], v[56:71]
  buffer_load_dword v1, v17, s[40:43], s65 offen sc1
  ds_read_b128 v[120:123], v173 offset:47104
  v_mfma_f32_32x32x16_bf16 v[72:87], v[128:131], v[236:239], v[72:87]
  ds_read_b128 v[124:127], v172 offset:47104
  buffer_load_dwordx4 a[228:231], v11, s[40:43], s85 offen offset:512 sc1
  v_mfma_f32_32x32x16_bf16 v[56:71], v[132:135], v[236:239], v[56:71]
  s_waitcnt lgkmcnt(4)
  ds_read_b128 v[128:131], v173 offset:49152
  v_mfma_f32_32x32x16_bf16 v[72:87], v[136:139], v[240:243], v[72:87]
  ds_read_b128 v[132:135], v172 offset:49152
  buffer_load_dwordx4 a[232:235], v11, s[40:43], s85 offen offset:1024 sc1
  buffer_load_dwordx4 v2, s[40:43], s6 offen offset:2048 sc1 lds
  v_mfma_f32_32x32x16_bf16 v[56:71], v[140:143], v[240:243], v[56:71]
  ds_read_b128 v[136:139], v173 offset:51200
  v_mfma_f32_32x32x16_bf16 v[72:87], v[144:147], v[244:247], v[72:87]
  ds_read_b128 v[140:143], v172 offset:51200
  buffer_load_dwordx4 a[236:239], v11, s[40:43], s85 offen offset:1536 sc1
  v_mfma_f32_32x32x16_bf16 v[56:71], v[148:151], v[244:247], v[56:71]
  s_waitcnt vmcnt(23) lgkmcnt(4)
  ds_read_b128 v[144:147], v173 offset:53248
  v_mfma_f32_32x32x16_bf16 v[72:87], v[152:155], v[248:251], v[72:87]
  ds_read_b128 v[148:151], v172 offset:53248
  buffer_load_dwordx4 a[240:243], v11, s[40:43], s85 offen offset:2048 sc1
  buffer_load_dwordx4 v2, s[40:43], s6 offen offset:3072 sc1 lds
  v_mfma_f32_32x32x16_bf16 v[56:71], v[156:159], v[248:251], v[56:71]
  s_waitcnt vmcnt(23) lgkmcnt(4)
  ds_read_b128 v[152:155], v173 offset:55296
  v_mfma_f32_32x32x16_bf16 v[72:87], v[120:123], v[252:255], v[72:87]
  ds_read_b128 v[156:159], v172 offset:55296
  buffer_load_dwordx4 a[244:247], v11, s[40:43], s85 offen offset:2560 sc1
  v_mfma_f32_32x32x16_bf16 v[56:71], v[124:127], v[252:255], v[56:71]
  s_waitcnt vmcnt(23) lgkmcnt(4)
  ds_read_b128 v[120:123], v173 offset:57344
  v_mfma_f32_32x32x16_bf16 v[72:87], v[128:131], a[192:195], v[72:87]
  ds_read_b128 v[124:127], v172 offset:57344
  buffer_load_dwordx4 a[248:251], v11, s[40:43], s85 offen offset:3072 sc1
  v_mfma_f32_32x32x16_bf16 v[56:71], v[132:135], a[192:195], v[56:71]
  s_waitcnt vmcnt(22) lgkmcnt(4)
  s_barrier
  ds_read_b128 v[128:131], v173 offset:59392
  v_mfma_f32_32x32x16_bf16 v[72:87], v[136:139], a[196:199], v[72:87]
  ds_read_b128 v[132:135], v172 offset:59392
  buffer_load_dwordx4 a[252:255], v11, s[40:43], s85 offen offset:3584 sc1
  v_mfma_f32_32x32x16_bf16 v[56:71], v[140:143], a[196:199], v[56:71]
  s_waitcnt vmcnt(22) lgkmcnt(4)
  ds_read_b128 v[136:139], v173 offset:61440
  v_mfma_f32_32x32x16_bf16 v[72:87], v[144:147], a[200:203], v[72:87]
  ds_read_b128 v[140:143], v172 offset:61440
  s_add_u32 s27, s37, 5
  s_waitcnt vmcnt(9) lgkmcnt(4)
  v_subrev_u32 v1, s27, v1
  v_cmp_le_u32 vcc, 16, v1
  s_mov_b32 s7, 0
  s_cbranch_vccz L_ckd_13
L_ck_12:
  buffer_load_dword v1, v17, s[40:43], s65 offen sc1
  s_add_u32 s7, s7, 1
  s_waitcnt vmcnt(0)
  v_subrev_u32 v1, s27, v1
  v_cmp_le_u32 vcc, 16, v1
  s_and_b32 s5, s7, s22
  s_cbranch_vccz L_ckd_13
  s_cbranch_scc1 L_ck_12
  buffer_load_dword v12, v17, s[40:43], s65 offen offset:256 sc1
  s_waitcnt vmcnt(0)
  v_subrev_u32 v12, s27, v12
  v_cmp_le_u32 vcc, 16, v12
  s_cmp_lt_u32 s7, 0x40000
  s_cbranch_vccz L_ckd_13
  s_cbranch_scc1 L_ck_12
L_ckd_13:
  s_add_u32 s85, s85, 4096
  buffer_load_dwordx4 v[192:195], v11, s[40:43], s85 offen offset:0 sc1
  v_mfma_f32_32x32x16_bf16 v[56:71], v[148:151], a[200:203], v[56:71]
  ds_read_b128 v[144:147], v173 offset:63488
  v_mfma_f32_32x32x16_bf16 v[72:87], v[152:155], a[204:207], v[72:87]
  ds_read_b128 v[148:151], v172 offset:63488
  buffer_load_dwordx4 v[196:199], v11, s[40:43], s85 offen offset:512 sc1
  v_mfma_f32_32x32x16_bf16 v[56:71], v[156:159], a[204:207], v[56:71]
  ds_read_b128 v[152:155], v173 offset:0
  v_mfma_f32_32x32x16_bf16 v[72:87], v[120:123], a[208:211], v[72:87]
  ds_read_b128 v[156:159], v172 offset:0
  buffer_load_dwordx4 v[200:203], v11, s[40:43], s85 offen offset:1024 sc1
  buffer_load_dword v6, v16, s[40:43], s20 offen sc1
  s_add_u32 s6, s24, 262144
  v_mfma_f32_32x32x16_bf16 v[56:71], v[124:127], a[208:211], v[56:71]
  s_waitcnt lgkmcnt(4)
  ds_read_b128 v[120:123], v173 offset:2048
  buffer_load_dword v6, v16, s[40:43], s6 offen sc1
  s_add_u32 s6, s25, 32768
  v_mfma_f32_32x32x16_bf16 v[72:87], v[128:131], a[212:215], v[72:87]
  ds_read_b128 v[124:127], v172 offset:2048
  buffer_load_dwordx4 v[204:207], v11, s[40:43], s85 offen offset:1536 sc1
  buffer_load_dword v6, v3, s[40:43], s6 offen sc1
  v_mfma_f32_32x32x16_bf16 v[56:71], v[132:135], a[212:215], v[56:71]
  ds_read_b128 v[128:131], v173 offset:4096
  v_mov_b32 v7, L_p4_0+2048-L_pc
  v_add_u32 v7, s39, v7
  global_load_dword v6, v7, s[90:91]
  v_mfma_f32_32x32x16_bf16 v[72:87], v[136:139], a[216:219], v[72:87]
  ds_read_b128 v[132:135], v172 offset:4096
  buffer_load_dwordx4 v[208:211], v11, s[40:43], s85 offen offset:2048 sc1
  v_mfma_f32_32x32x16_bf16 v[56:71], v[140:143], a[216:219], v[56:71]
  s_waitcnt lgkmcnt(4)
  ds_read_b128 v[136:139], v173 offset:6144
  v_mfma_f32_32x32x16_bf16 v[72:87], v[144:147], a[220:223], v[72:87]
  ds_read_b128 v[140:143], v172 offset:6144
  buffer_load_dwordx4 v[212:215], v11, s[40:43], s85 offen offset:2560 sc1
  v_mfma_f32_32x32x16_bf16 v[56:71], v[148:151], a[220:223], v[56:71]
  ds_read_b128 v[144:147], v173 offset:8192
  v_mfma_f32_32x32x16_bf16 v[72:87], v[152:155], a[224:227], v[72:87]
  ds_read_b128 v[148:151], v172 offset:8192
  buffer_load_dwordx4 v[216:219], v11, s[40:43], s85 offen offset:3072 sc1
  v_mfma_f32_32x32x16_bf16 v[56:71], v[156:159], a[224:227], v[56:71]
  s_waitcnt vmcnt(19) lgkmcnt(4)
  ds_read_b128 v[152:155], v173 offset:10240
  v_mfma_f32_32x32x16_bf16 v[72:87], v[120:123], a[228:231], v[72:87]
  ds_read_b128 v[156:159], v172 offset:10240
  buffer_load_dwordx4 v[220:223], v11, s[40:43], s85 offen offset:3584 sc1
  v_mfma_f32_32x32x16_bf16 v[56:71], v[124:127], a[228:231], v[56:71]
  s_waitcnt vmcnt(19) lgkmcnt(4)
  ds_read_b128 v[120:123], v173 offset:12288
  v_mfma_f32_32x32x16_bf16 v[72:87], v[128:131], a[232:235], v[72:87]
  ds_read_b128 v[124:127], v172 offset:12288
  s_add_u32 s85, s85, 4096
  buffer_load_dwordx4 v[224:227], v11, s[40:43], s85 offen offset:0 sc1
  v_mfma_f32_32x32x16_bf16 v[56:71], v[132:135], a[232:235], v[56:71]
  s_waitcnt vmcnt(18) lgkmcnt(4)
  ds_read_b128 v[128:131], v173 offset:14336
  v_mfma_f32_32x32x16_bf16 v[72:87], v[136:139], a[236:239], v[72:87]
  ds_read_b128 v[132:135], v172 offset:14336
  buffer_load_dwordx4 v[228:231], v11, s[40:43], s85 offen offset:512 sc1
  v_mfma_f32_32x32x16_bf16 v[56:71], v[140:143], a[236:239], v[56:71]
  s_waitcnt vmcnt(18) lgkmcnt(4)
  ds_read_b128 v[136:139], v175 offset:0
  v_mfma_f32_32x32x16_bf16 v[72:87], v[144:147], a[240:243], v[72:87]
  ds_read_b128 v[140:143], v174 offset:0
  buffer_load_dwordx4 v[232:235], v11, s[40:43], s85 offen offset:1024 sc1
  v_mfma_f32_32x32x16_bf16 v[56:71], v[148:151], a[240:243], v[56:71]
  s_waitcnt vmcnt(17) lgkmcnt(4)
  ds_read_b128 v[144:147], v175 offset:2048
  v_mfma_f32_32x32x16_bf16 v[72:87], v[152:155], a[244:247], v[72:87]
  ds_read_b128 v[148:151], v174 offset:2048
  buffer_load_dwordx4 v[236:239], v11, s[40:43], s85 offen offset:1536 sc1
  v_mfma_f32_32x32x16_bf16 v[56:71], v[156:159], a[244:247], v[56:71]
  s_waitcnt vmcnt(17) lgkmcnt(4)
  ds_read_b128 v[152:155], v175 offset:4096
  v_mfma_f32_32x32x16_bf16 v[72:87], v[120:123], a[248:251], v[72:87]
  ds_read_b128 v[156:159], v174 offset:4096
  buffer_load_dwordx4 v[240:243], v11, s[40:43], s85 offen offset:2048 sc1
  v_mfma_f32_32x32x16_bf16 v[56:71], v[124:127], a[248:251], v[56:71]
  s_waitcnt vmcnt(17) lgkmcnt(4)
  ds_read_b128 v[120:123], v175 offset:6144
  v_mfma_f32_32x32x16_bf16 v[72:87], v[128:131], a[252:255], v[72:87]
  ds_read_b128 v[124:127], v174 offset:6144
  buffer_load_dwordx4 v[244:247], v11, s[40:43], s85 offen offset:2560 sc1
  v_mfma_f32_32x32x16_bf16 v[56:71], v[132:135], a[252:255], v[56:71]
  s_waitcnt vmcnt(17) lgkmcnt(4)
  ds_read_b128 v[128:131], v175 offset:8192
  v_mfma_f32_32x32x16_bf16 v[72:87], v[136:139], v[192:195], v[72:87]
  ds_read_b128 v[132:135], v174 offset:8192
  buffer_load_dwordx4 v[248:251], v11, s[40:43], s85 offen offset:3072 sc1
  v_mfma_f32_32x32x16_bf16 v[56:71], v[140:143], v[192:195], v[56:71]
  s_waitcnt vmcnt(17) lgkmcnt(4)
  ds_read_b128 v[136:139], v175 offset:10240
  v_mfma_f32_32x32x16_bf16 v[72:87], v[144:147], v[196:199], v[72:87]
  ds_read_b128 v[140:143], v174 offset:10240
  buffer_load_dwordx4 v[252:255], v11, s[40:43], s85 offen offset:3584 sc1
  v_mfma_f32_32x32x16_bf16 v[56:71], v[148:151], v[196:199], v[56:71]
  s_waitcnt vmcnt(17) lgkmcnt(4)
  ds_read_b128 v[144:147], v175 offset:12288
  v_mfma_f32_32x32x16_bf16 v[72:87], v[152:155], v[200:203], v[72:87]
  ds_read_b128 v[148:151], v174 offset:12288
  s_add_u32 s85, s85, 4096
  buffer_load_dwordx4 a[192:195], v11, s[40:43], s85 offen offset:0 sc1
  v_mfma_f32_32x32x16_bf16 v[56:71], v[156:159], v[200:203], v[56:71]
  s_waitcnt vmcnt(15) lgkmcnt(4)
  ds_read_b128 v[152:155], v175 offset:14336
  v_mfma_f32_32x32x16_bf16 v[72:87], v[120:123], v[204:207], v[72:87]
  ds_read_b128 v[156:159], v174 offset:14336
  buffer_load_dwordx4 a[196:199], v11, s[40:43], s85 offen offset:512 sc1
  v_mfma_f32_32x32x16_bf16 v[56:71], v[124:127], v[204:207], v[56:71]
  s_waitcnt vmcnt(13) lgkmcnt(4)
  s_barrier
  ds_read_b128 v[120:123], v175 offset:16384
  v_mfma_f32_32x32x16_bf16 v[72:87], v[128:131], v[208:211], v[72:87]
  ds_read_b128 v[124:127], v174 offset:16384
  buffer_load_dwordx4 a[200:203], v11, s[40:43], s85 offen offset:1024 sc1
  v_mfma_f32_32x32x16_bf16 v[56:71], v[132:135], v[208:211], v[56:71]
  s_waitcnt vmcnt(13) lgkmcnt(4)
  ds_read_b128 v[128:131], v175 offset:18432
  v_mfma_f32_32x32x16_bf16 v[72:87], v[136:139], v[212:215], v[72:87]
  ds_read_b128 v[132:135], v174 offset:18432
  buffer_load_dwordx4 a[204:207], v11, s[40:43], s85 offen offset:1536 sc1
  v_mfma_f32_32x32x16_bf16 v[56:71], v[140:143], v[212:215], v[56:71]
  s_waitcnt vmcnt(13) lgkmcnt(4)
  ds_read_b128 v[136:139], v175 offset:20480
  v_mfma_f32_32x32x16_bf16 v[72:87], v[144:147], v[216:219], v[72:87]
  ds_read_b128 v[140:143], v174 offset:20480
  buffer_load_dwordx4 a[208:211], v11, s[40:43], s85 offen offset:2048 sc1
  v_mfma_f32_32x32x16_bf16 v[56:71], v[148:151], v[216:219], v[56:71]
  s_waitcnt vmcnt(13) lgkmcnt(4)
  ds_read_b128 v[144:147], v175 offset:22528
  v_mfma_f32_32x32x16_bf16 v[72:87], v[152:155], v[220:223], v[72:87]
  ds_read_b128 v[148:151], v174 offset:22528
  buffer_load_dwordx4 a[212:215], v11, s[40:43], s85 offen offset:2560 sc1
  v_mfma_f32_32x32x16_bf16 v[56:71], v[156:159], v[220:223], v[56:71]
  s_waitcnt vmcnt(13) lgkmcnt(4)
  ds_read_b128 v[152:155], v175 offset:24576
  v_mfma_f32_32x32x16_bf16 v[72:87], v[120:123], v[224:227], v[72:87]
  ds_read_b128 v[156:159], v175 offset:26624
  buffer_load_dwordx4 a[216:219], v11, s[40:43], s85 offen offset:3072 sc1
  v_mfma_f32_32x32x16_bf16 v[56:71], v[124:127], v[224:227], v[56:71]
  s_waitcnt vmcnt(13) lgkmcnt(4)
  ds_read_b128 v[120:123], v175 offset:28672
  v_mfma_f32_32x32x16_bf16 v[72:87], v[128:131], v[228:231], v[72:87]
  ds_read_b128 v[124:127], v175 offset:30720
  buffer_load_dwordx4 a[220:223], v11, s[40:43], s85 offen offset:3584 sc1
  v_mfma_f32_32x32x16_bf16 v[56:71], v[132:135], v[228:231], v[56:71]
  s_waitcnt vmcnt(13) lgkmcnt(4)
  ds_read_b128 v[128:131], v175 offset:32768
  v_mfma_f32_32x32x16_bf16 v[72:87], v[136:139], v[232:235], v[72:87]
  ds_read_b128 v[132:135], v175 offset:34816
  s_add_u32 m0, s55, 114688
  s_add_u32 s6, s56, 0
  buffer_load_dwordx4 v4, s[16:19], s6 offen offset:0 lds
  s_add_u32 s6, s56, 7168
  v_mfma_f32_32x32x16_bf16 v[56:71], v[140:143], v[232:235], v[56:71]
  s_waitcnt vmcnt(13) lgkmcnt(4)
  ds_read_b128 v[136:139], v175 offset:36864
  v_mfma_f32_32x32x16_bf16 v[72:87], v[144:147], v[236:239], v[72:87]
  ds_read_b128 v[140:143], v175 offset:38912
  v_mfma_f32_32x32x16_bf16 v[56:71], v[148:151], v[236:239], v[56:71]
  s_waitcnt vmcnt(12) lgkmcnt(4)
  ds_read_b128 v[144:147], v175 offset:40960
  buffer_load_dwordx4 v4, s[16:19], s6 offen offset:1024 lds
  s_add_u32 s6, s56, 14336
  v_mfma_f32_32x32x16_bf16 v[72:87], v[152:155], v[240:243], v[72:87]
  s_waitcnt vmcnt(12) lgkmcnt(4)
  ds_read_b128 v[148:151], v175 offset:43008
  v_mfma_f32_32x32x16_bf16 v[72:87], v[156:159], v[244:247], v[72:87]
  s_waitcnt vmcnt(11) lgkmcnt(4)
  ds_read_b128 v[152:155], v175 offset:45056
  buffer_load_dwordx4 v4, s[16:19], s6 offen offset:2048 lds
  s_add_u32 s6, s56, 21504
  v_mfma_f32_32x32x16_bf16 v[72:87], v[120:123], v[248:251], v[72:87]
  s_waitcnt vmcnt(11) lgkmcnt(4)
  ds_read_b128 v[156:159], v175 offset:47104
  v_mfma_f32_32x32x16_bf16 v[72:87], v[124:127], v[252:255], v[72:87]
  s_waitcnt vmcnt(10) lgkmcnt(4)
  ds_read_b128 v[120:123], v174 offset:24576
  buffer_load_dwordx4 v4, s[16:19], s6 offen offset:3072 lds
  s_add_u32 m0, s55, 131072
  s_add_u32 s6, s56, 65536
  v_mfma_f32_32x32x16_bf16 v[72:87], v[128:131], a[192:195], v[72:87]
  s_waitcnt vmcnt(10) lgkmcnt(4)
  ds_read_b128 v[124:127], v174 offset:26624
  v_mfma_f32_32x32x16_bf16 v[72:87], v[132:135], a[196:199], v[72:87]
  s_waitcnt vmcnt(9) lgkmcnt(4)
  ds_read_b128 v[128:131], v174 offset:28672
  buffer_load_dwordx4 v4, s[16:19], s6 offen offset:0 lds
  s_add_u32 s6, s56, 72704
  v_mfma_f32_32x32x16_bf16 v[72:87], v[136:139], a[200:203], v[72:87]
  s_waitcnt vmcnt(9) lgkmcnt(4)
  ds_read_b128 v[132:135], v174 offset:30720
  v_mfma_f32_32x32x16_bf16 v[72:87], v[140:143], a[204:207], v[72:87]
  s_waitcnt vmcnt(8) lgkmcnt(4)
  ds_read_b128 v[136:139], v174 offset:32768
  buffer_load_dwordx4 v4, s[16:19], s6 offen offset:1024 lds
  s_add_u32 s6, s56, 79872
  v_mfma_f32_32x32x16_bf16 v[72:87], v[144:147], a[208:211], v[72:87]
  s_waitcnt vmcnt(8) lgkmcnt(4)
  ds_read_b128 v[140:143], v174 offset:34816
  v_mfma_f32_32x32x16_bf16 v[72:87], v[148:151], a[212:215], v[72:87]
  s_waitcnt vmcnt(7) lgkmcnt(4)
  ds_read_b128 v[144:147], v174 offset:36864
  buffer_load_dwordx4 v4, s[16:19], s6 offen offset:2048 lds
  s_add_u32 s6, s56, 87040
  v_mfma_f32_32x32x16_bf16 v[72:87], v[152:155], a[216:219], v[72:87]
  s_waitcnt vmcnt(7) lgkmcnt(4)
  ds_read_b128 v[148:151], v174 offset:38912
  v_mfma_f32_32x32x16_bf16 v[72:87], v[156:159], a[220:223], v[72:87]
  ds_read_b128 v[152:155], v174 offset:40960
  buffer_load_dwordx4 v4, s[16:19], s6 offen offset:3072 lds
  v_mfma_f32_32x32x16_bf16 v[56:71], v[120:123], v[240:243], v[56:71]
  ds_read_b128 v[156:159], v174 offset:43008
  v_mfma_f32_32x32x16_bf16 v[56:71], v[124:127], v[244:247], v[56:71]
  ds_read_b128 v[120:123], v174 offset:45056
  v_mfma_f32_32x32x16_bf16 v[56:71], v[128:131], v[248:251], v[56:71]
  s_waitcnt lgkmcnt(4)
  ds_read_b128 v[124:127], v174 offset:47104
  s_nop 2
  v_cvt_pk_bf16_f32 v104, v72, v73
  v_cvt_pk_bf16_f32 v105, v74, v75
  v_cvt_pk_bf16_f32 v106, v76, v77
  v_cvt_pk_bf16_f32 v107, v78, v79
  v_mfma_f32_32x32x16_bf16 v[56:71], v[132:135], v[252:255], v[56:71]
  buffer_store_dwordx4 v[104:107], v2, s[12:15], s20 offen
  v_cvt_pk_bf16_f32 v108, v80, v81
  v_cvt_pk_bf16_f32 v109, v82, v83
  v_cvt_pk_bf16_f32 v110, v84, v85
  v_cvt_pk_bf16_f32 v111, v86, v87
  v_mfma_f32_32x32x16_bf16 v[56:71], v[136:139], a[192:195], v[56:71]
  buffer_store_dwordx4 v[108:111], v2, s[12:15], s20 offen offset:1024
  s_cmp_lg_u32 s23, 0
  s_cbranch_scc1 L_sl_14
  buffer_store_dwordx4 v[104:107], v2, s[44:47], s20 offen sc1
  buffer_store_dwordx4 v[108:111], v2, s[44:47], s20 offen offset:1024 sc1
L_sl_14:
  v_mfma_f32_32x32x16_bf16 v[56:71], v[140:143], a[196:199], v[56:71]
  v_mfma_f32_32x32x16_bf16 v[56:71], v[144:147], a[200:203], v[56:71]
  s_waitcnt lgkmcnt(1)
  v_mfma_f32_32x32x16_bf16 v[56:71], v[148:151], a[204:207], v[56:71]
  v_mfma_f32_32x32x16_bf16 v[56:71], v[152:155], a[208:211], v[56:71]
  v_mfma_f32_32x32x16_bf16 v[56:71], v[156:159], a[212:215], v[56:71]
  s_add_u32 s27, s37, 1
  v_mov_b32 v27, s27
  s_waitcnt vmcnt(0)
  buffer_store_dword v27, off, s[40:43], s98 offset:1024
  buffer_store_dword v27, off, s[44:47], s98 offset:1536 sc1
  v_mfma_f32_32x32x16_bf16 v[56:71], v[120:123], a[216:219], v[56:71]
  s_waitcnt lgkmcnt(0)
  buffer_load_dword v1, off, s[40:43], s99 offset:1024 sc1
  v_mfma_f32_32x32x16_bf16 v[56:71], v[124:127], a[220:223], v[56:71]
  s_waitcnt vmcnt(0)
  v_cmp_ne_u32 vcc, v1, v27
  s_mov_b32 s7, 0
  s_cbranch_vccz L_exd_16
L_ex_15:
  buffer_load_dword v1, off, s[40:43], s99 offset:1024 sc1
  s_add_u32 s7, s7, 1
  s_waitcnt vmcnt(0)
  v_cmp_ne_u32 vcc, v1, v27
  s_and_b32 s5, s7, s22
  s_cbranch_vccz L_exd_16
  s_cbranch_scc1 L_ex_15
  buffer_load_dword v1, off, s[40:43], s99 offset:1536 sc1
  s_waitcnt vmcnt(0)
  v_cmp_ne_u32 vcc, v1, v27
  s_cmp_lt_u32 s7, 0x40000
  s_cbranch_vccz L_exd_16
  s_cbranch_scc1 L_ex_15
L_exd_16:
  buffer_load_dwordx4 v[96:99], v2, s[40:43], s21 offen sc1
  buffer_load_dwordx4 v[100:103], v2, s[40:43], s21 offen offset:1024 sc1
  s_waitcnt vmcnt(1)
  v_lshlrev_b32 v88, 16, v96
  v_and_b32 v89, 0xffff0000, v96
  v_lshlrev_b32 v90, 16, v97
  v_and_b32 v91, 0xffff0000, v97
  v_lshlrev_b32 v92, 16, v98
  v_and_b32 v93, 0xffff0000, v98
  v_lshlrev_b32 v94, 16, v99
  v_and_b32 v95, 0xffff0000, v99
  s_waitcnt vmcnt(0)
  v_lshlrev_b32 v96, 16, v100
  v_and_b32 v97, 0xffff0000, v100
  v_lshlrev_b32 v98, 16, v101
  v_and_b32 v99, 0xffff0000, v101
  v_lshlrev_b32 v100, 16, v102
  v_and_b32 v101, 0xffff0000, v102
  v_lshlrev_b32 v102, 16, v103
  v_and_b32 v103, 0xffff0000, v103
  v_pk_add_f32 v[56:57], v[56:57], v[88:89] op_sel:[0,0] op_sel_hi:[1,1]
  v_pk_add_f32 v[58:59], v[58:59], v[90:91] op_sel:[0,0] op_sel_hi:[1,1]
  v_pk_add_f32 v[60:61], v[60:61], v[92:93] op_sel:[0,0] op_sel_hi:[1,1]
  v_pk_add_f32 v[62:63], v[62:63], v[94:95] op_sel:[0,0] op_sel_hi:[1,1]
  v_cvt_pk_bf16_f32 v104, v56, v57
  v_cvt_pk_bf16_f32 v105, v58, v59
  v_cvt_pk_bf16_f32 v106, v60, v61
  v_cvt_pk_bf16_f32 v107, v62, v63
  buffer_store_dwordx4 v[104:107], v116, s[12:15], s96 offen
  v_pk_add_f32 v[64:65], v[64:65], v[96:97] op_sel:[0,0] op_sel_hi:[1,1]
  v_pk_add_f32 v[66:67], v[66:67], v[98:99] op_sel:[0,0] op_sel_hi:[1,1]
  v_pk_add_f32 v[68:69], v[68:69], v[100:101] op_sel:[0,0] op_sel_hi:[1,1]
  v_pk_add_f32 v[70:71], v[70:71], v[102:103] op_sel:[0,0] op_sel_hi:[1,1]
  v_cvt_pk_bf16_f32 v108, v64, v65
  v_cvt_pk_bf16_f32 v109, v66, v67
  v_cvt_pk_bf16_f32 v110, v68, v69
  v_cvt_pk_bf16_f32 v111, v70, v71
  buffer_store_dwordx4 v[108:111], v116, s[12:15], s96 offen offset:256
  v_dot2_f32_bf16 v114, v104, v28, 0
  v_dot2_f32_bf16 v115, v104, v104, 0
  v_dot2_f32_bf16 v112, v105, v28, 0
  v_dot2_f32_bf16 v113, v105, v105, 0
  v_dot2_f32_bf16 v114, v106, v28, v114
  v_dot2_f32_bf16 v115, v106, v106, v115
  v_dot2_f32_bf16 v112, v107, v28, v112
  v_dot2_f32_bf16 v113, v107, v107, v113
  v_dot2_f32_bf16 v114, v108, v28, v114
  v_dot2_f32_bf16 v115, v108, v108, v115
  v_dot2_f32_bf16 v112, v109, v28, v112
  v_dot2_f32_bf16 v113, v109, v109, v113
  v_dot2_f32_bf16 v114, v110, v28, v114
  v_dot2_f32_bf16 v115, v110, v110, v115
  v_dot2_f32_bf16 v112, v111, v28, v112
  v_dot2_f32_bf16 v113, v111, v111, v113
  s_nop 2
  v_pk_add_f32 v[112:113], v[112:113], v[114:115] op_sel:[0,0] op_sel_hi:[1,1]
  s_nop 1
  v_permlane32_swap_b32 v112, v113
  v_add_f32 v112, v112, v113
  buffer_store_dword v112, v3, s[12:15], s97 offen
  s_cmp_lg_u32 s23, 0
  s_cbranch_scc1 L_sl_17
  buffer_store_dwordx4 v[104:107], v116, s[44:47], s96 offen sc1
  buffer_store_dwordx4 v[108:111], v116, s[44:47], s96 offen offset:256 sc1
  buffer_store_dword v112, v3, s[44:47], s97 offen sc1
L_sl_17:
  s_add_u32 s20, s96, 1048576
  s_add_u32 s21, s97, 32768
  s_add_u32 s38, s37, 6
  v_mov_b32 v26, s38
  s_waitcnt vmcnt(0)
  s_barrier
  buffer_store_dword v26, v9, s[40:43], s67 offen
  buffer_store_dword v26, v9, s[44:47], s67 offen offset:256 sc1
  s_cmp_eq_u32 s83, 0
  s_cbranch_scc1 L_hc_18
  s_mov_b32 exec_lo, 0xffff0000
  s_mov_b32 exec_hi, 0xffff0000
  buffer_store_dwordx4 v[104:107], v116, s[40:43], s20 offen sc1
  buffer_store_dwordx4 v[108:111], v116, s[40:43], s20 offen offset:256 sc1
  s_mov_b64 exec, -1
  buffer_store_dword v112, v3, s[40:43], s21 offen sc1
L_hc_18:
  s_lshl_b32 s96, s68, 14
  s_add_u32 s96, s96, s54
  s_lshl_b32 s3, s50, 11
  s_add_u32 s96, s96, s3
  s_lshl_b32 s3, s53, 9
  s_add_u32 s96, s96, s3
  s_add_u32 s96, s96, 786432
  s_add_u32 s97, s96, 16384
  s_add_u32 s98, s96, 32768
  s_add_u32 s99, s96, 49152
  s_lshl_b32 s3, s89, 1
  s_add_u32 s3, s3, s83
  s_lshl_b32 s5, s50, 1
  s_add_u32 s5, s5, s84
  s_lshl_b32 s86, s3, 15
  s_lshl_b32 s4, s5, 10
  s_add_u32 s86, s86, s4
  s_add_u32 s86, s86, s54
  s_add_u32 s86, s86, 262144
  s_lshl_b32 s85, s68, 11
  s_lshl_b32 s4, s84, 12
  s_add_u32 s85, s85, s4
  s_lshl_b32 s4, s83, 6
  s_add_u32 s85, s85, s4
  s_add_u32 s85, s85, s54
  s_add_u32 s85, s85, 32768
  s_lshl_b32 s3, s84, 8
  s_add_u32 s3, s3, s4
  s_add_u32 s3, s3, 147456
  v_and_b32 v161, 0xffffffbf, v3
  v_add_u32 v162, s3, v161
  v_and_b32 v160, 64, v3
  v_lshl_add_u32 v160, v160, 2, v161
  v_add_u32 v190, 49152, v2
  v_add_u32 v191, 0, v2
  v_add_u32 v150, 114688, v8
  v_xor_b32 v151, 64, v150
  ds_read_b64_tr_b16 v[192:193], v150 offset:0
  ds_read_b64_tr_b16 v[194:195], v150 offset:512
  ds_read_b64_tr_b16 v[196:197], v151 offset:0
  ds_read_b64_tr_b16 v[198:199], v151 offset:512
  ds_read_b64_tr_b16 v[200:201], v150 offset:2048
  ds_read_b64_tr_b16 v[202:203], v150 offset:2560
  ds_read_b64_tr_b16 v[204:205], v151 offset:2048
  ds_read_b64_tr_b16 v[206:207], v151 offset:2560
  ds_read_b64_tr_b16 v[208:209], v150 offset:4096
  ds_read_b64_tr_b16 v[210:211], v150 offset:4608
  ds_read_b64_tr_b16 v[212:213], v151 offset:4096
  ds_read_b64_tr_b16 v[214:215], v151 offset:4608
  ds_read_b64_tr_b16 v[216:217], v150 offset:6144
  ds_read_b64_tr_b16 v[218:219], v150 offset:6656
  ds_read_b64_tr_b16 v[220:221], v151 offset:6144
  s_waitcnt lgkmcnt(10)
  ds_read_b64_tr_b16 v[222:223], v151 offset:6656
  v_add_u32 v152, 131072, v8
  v_xor_b32 v153, 64, v152
  ds_read_b64_tr_b16 v[224:225], v152 offset:0
  ds_read_b64_tr_b16 v[226:227], v152 offset:512
  ds_read_b64_tr_b16 v[228:229], v153 offset:0
  ds_read_b64_tr_b16 v[230:231], v153 offset:512
  s_waitcnt lgkmcnt(10)
  ds_read_b64_tr_b16 v[232:233], v152 offset:2048
  ds_read_b64_tr_b16 v[234:235], v152 offset:2560
  ds_read_b64_tr_b16 v[236:237], v153 offset:2048
  ds_read_b64_tr_b16 v[238:239], v153 offset:2560
  ds_read_b64_tr_b16 v[240:241], v152 offset:4096
  s_waitcnt lgkmcnt(10)
  ds_read_b64_tr_b16 v[242:243], v152 offset:4608
  ds_read_b64_tr_b16 v[244:245], v153 offset:4096
  ds_read_b64_tr_b16 v[246:247], v153 offset:4608
  ds_read_b64_tr_b16 v[248:249], v152 offset:6144
  ds_read_b64_tr_b16 v[250:251], v152 offset:6656
  s_waitcnt lgkmcnt(10)
  ds_read_b64_tr_b16 v[252:253], v153 offset:6144
  ds_read_b64_tr_b16 v[254:255], v153 offset:6656
  s_mov_b32 s7, 0
  s_cmp_lg_u32 s53, 0
  s_cbranch_scc1 L_join_19
  s_mov_b64 exec, 0xffff
  buffer_load_dword v1, v3, s[40:43], s65 offen sc1
  buffer_load_dword v12, v3, s[40:43], s65 offen sc1
  buffer_load_dword v15, v3, s[40:43], s65 offen sc1
L_ploop_20:
  s_waitcnt vmcnt(2)
  v_sub_u32 v27, v1, v26
  v_cmp_le_u32 vcc, 16, v27
  s_add_u32 s7, s7, 1
  s_cbranch_vccz L_join_19
  buffer_load_dword v1, v3, s[40:43], s65 offen sc1
  s_waitcnt vmcnt(2)
  v_sub_u32 v27, v12, v26
  v_cmp_le_u32 vcc, 16, v27
  s_add_u32 s7, s7, 1
  s_cbranch_vccz L_join_19
  buffer_load_dword v12, v3, s[40:43], s65 offen sc1
  s_waitcnt vmcnt(2)
  v_sub_u32 v27, v15, v26
  v_cmp_le_u32 vcc, 16, v27
  s_add_u32 s7, s7, 1
  s_cbranch_vccz L_join_19
  buffer_load_dword v15, v3, s[40:43], s65 offen sc1
  s_and_b32 s3, s7, s22
  s_cbranch_scc1 L_ploop_20
  buffer_load_dword v27, v3, s[40:43], s65 offen offset:256 sc1
  s_waitcnt vmcnt(0)
  v_sub_u32 v27, v27, v26
  v_cmp_le_u32 vcc, 16, v27
  s_cmp_lt_u32 s7, 0x80000
  s_cbranch_vccz L_join_19
  s_cbranch_scc1 L_ploop_20
L_join_19:
  s_mov_b64 exec, -1
  s_waitcnt lgkmcnt(0)
  s_barrier
  s_add_u32 m0, s55, 49152
  s_add_u32 s6, s61, 0
  buffer_load_dwordx4 v2, s[40:43], s6 offen offset:0 sc1 lds
  buffer_load_dwordx4 v2, s[40:43], s6 offen offset:1024 sc1 lds
  buffer_load_dwordx4 v2, s[40:43], s6 offen offset:2048 sc1 lds
  buffer_load_dwordx4 v2, s[40:43], s6 offen offset:3072 sc1 lds
  s_add_u32 m0, s55, 0
  s_add_u32 s6, s61, 16384
  buffer_load_dwordx4 v2, s[40:43], s6 offen offset:0 sc1 lds
  buffer_load_dwordx4 v2, s[40:43], s6 offen offset:1024 sc1 lds
  buffer_load_dwordx4 v2, s[40:43], s6 offen offset:2048 sc1 lds
  buffer_load_dwordx4 v2, s[40:43], s6 offen offset:3072 sc1 lds
  buffer_load_dword v166, v160, s[40:43], s85 offen offset:0 sc1
  buffer_load_dword v167, v160, s[40:43], s85 offen offset:512 sc1
  buffer_load_dword v168, v160, s[40:43], s85 offen offset:1024 sc1
  buffer_load_dword v169, v160, s[40:43], s85 offen offset:1536 sc1
  buffer_load_dword v170, v160, s[40:43], s85 offen offset:2048 sc1
  buffer_load_dword v171, v160, s[40:43], s85 offen offset:2560 sc1
  buffer_load_dword v172, v160, s[40:43], s85 offen offset:3072 sc1
  buffer_load_dword v173, v160, s[40:43], s85 offen offset:3584 sc1
  s_waitcnt vmcnt(12)
  s_barrier
  s_sub_u32 s3, s67, s54
  s_lshl_b32 s3, s3, 5
  s_add_u32 s3, s3, s54
  s_add_u32 s3, s3, 4096
  buffer_store_dword v26, v9, s[40:43], s3 offen sc1
  ds_read_b128 v[112:115], v190 offset:0
  ds_read_b128 v[116:119], v190 offset:1024
  ds_read_b128 v[120:123], v190 offset:2048
  ds_read_b128 v[124:127], v190 offset:3072
  ds_read_b128 v[128:131], v190 offset:4096
  s_waitcnt lgkmcnt(4)
  s_add_u32 m0, s55, 65536
  s_add_u32 s6, s61, 32768
  buffer_load_dwordx4 v2, s[40:43], s6 offen offset:0 sc1 lds
  v_mfma_f32_16x16x32_bf16 v[56:59], a[0:3], v[112:115], 0
  ds_read_b128 v[132:135], v190 offset:5120
  v_mfma_f32_16x16x32_bf16 v[60:63], a[4:7], v[112:115], 0
  v_mfma_f32_16x16x32_bf16 v[64:67], v[112:115], a[8:11], 0
  s_waitcnt lgkmcnt(4)
  v_mfma_f32_16x16x32_bf16 v[56:59], a[12:15], v[116:119], v[56:59]
  ds_read_b128 v[136:139], v190 offset:6144
  buffer_load_dwordx4 v2, s[40:43], s6 offen offset:1024 sc1 lds
  v_mfma_f32_16x16x32_bf16 v[60:63], a[16:19], v[116:119], v[60:63]
  v_mfma_f32_16x16x32_bf16 v[64:67], v[116:119], a[20:23], v[64:67]
  s_waitcnt lgkmcnt(4)
  v_mfma_f32_16x16x32_bf16 v[56:59], a[24:27], v[120:123], v[56:59]
  ds_read_b128 v[112:115], v190 offset:7168
  v_mfma_f32_16x16x32_bf16 v[60:63], a[28:31], v[120:123], v[60:63]
  buffer_load_dwordx4 v2, s[40:43], s6 offen offset:2048 sc1 lds
  v_mfma_f32_16x16x32_bf16 v[64:67], v[120:123], a[32:35], v[64:67]
  s_waitcnt lgkmcnt(3)
  v_mfma_f32_16x16x32_bf16 v[56:59], a[36:39], v[124:127], v[56:59]
  ds_read_b128 v[116:119], v190 offset:8192
  v_mfma_f32_16x16x32_bf16 v[60:63], a[40:43], v[124:127], v[60:63]
  v_mfma_f32_16x16x32_bf16 v[64:67], v[124:127], a[44:47], v[64:67]
  buffer_load_dwordx4 v2, s[40:43], s6 offen offset:3072 sc1 lds
  v_mfma_f32_16x16x32_bf16 v[56:59], a[48:51], v[128:131], v[56:59]
  ds_read_b128 v[120:123], v190 offset:9216
  s_add_u32 m0, s55, 16384
  v_mfma_f32_16x16x32_bf16 v[60:63], a[52:55], v[128:131], v[60:63]
  s_add_u32 s6, s56, 131072
  v_mfma_f32_16x16x32_bf16 v[64:67], v[128:131], a[56:59], v[64:67]
  s_waitcnt lgkmcnt(3)
  v_mfma_f32_16x16x32_bf16 v[56:59], a[60:63], v[132:135], v[56:59]
  ds_read_b128 v[124:127], v190 offset:10240
  buffer_load_dwordx4 v4, s[16:19], s6 offen offset:0 lds
  v_mfma_f32_16x16x32_bf16 v[60:63], a[64:67], v[132:135], v[60:63]
  s_add_u32 s6, s56, 138240
  v_mfma_f32_16x16x32_bf16 v[64:67], v[132:135], a[68:71], v[64:67]
  v_mfma_f32_16x16x32_bf16 v[56:59], a[72:75], v[136:139], v[56:59]
  ds_read_b128 v[128:131], v190 offset:11264
  s_waitcnt vmcnt(12) lgkmcnt(3)
  v_add_f32 v166, v166, v167
  v_mfma_f32_16x16x32_bf16 v[60:63], a[76:79], v[136:139], v[60:63]
  buffer_load_dwordx4 v4, s[16:19], s6 offen offset:1024 lds
  v_mfma_f32_16x16x32_bf16 v[64:67], v[136:139], a[80:83], v[64:67]
  s_add_u32 s6, s56, 145408
  s_waitcnt vmcnt(11) lgkmcnt(2)
  v_add_f32 v168, v168, v169
  v_mfma_f32_16x16x32_bf16 v[56:59], a[84:87], v[112:115], v[56:59]
  ds_read_b128 v[132:135], v190 offset:12288
  s_waitcnt vmcnt(9)
  v_add_f32 v170, v170, v171
  v_mfma_f32_16x16x32_bf16 v[60:63], a[88:91], v[112:115], v[60:63]
  s_waitcnt vmcnt(7)
  v_add_f32 v172, v172, v173
  v_add_f32 v166, v166, v168
  v_mfma_f32_16x16x32_bf16 v[64:67], v[112:115], a[92:95], v[64:67]
  buffer_load_dwordx4 v4, s[16:19], s6 offen offset:2048 lds
  v_mfma_f32_16x16x32_bf16 v[56:59], a[96:99], v[116:119], v[56:59]
  ds_read_b128 v[136:139], v190 offset:13312
  s_add_u32 s6, s56, 152576
  v_mfma_f32_16x16x32_bf16 v[60:63], a[100:103], v[116:119], v[60:63]
  v_add_f32 v170, v170, v172
  v_mfma_f32_16x16x32_bf16 v[64:67], v[116:119], a[104:107], v[64:67]
  v_add_f32 v166, v166, v170
  v_mfma_f32_16x16x32_bf16 v[56:59], a[108:111], v[120:123], v[56:59]
  ds_read_b128 v[112:115], v190 offset:14336
  buffer_load_dwordx4 v4, s[16:19], s6 offen offset:3072 lds
  v_mfma_f32_16x16x32_bf16 v[60:63], a[112:115], v[120:123], v[60:63]
  s_add_u32 m0, s55, 32768
  s_add_u32 s6, s56, 196608
  v_mfma_f32_16x16x32_bf16 v[64:67], v[120:123], a[116:119], v[64:67]
  s_waitcnt lgkmcnt(3)
  v_mov_b32 v167, v166
  v_mfma_f32_16x16x32_bf16 v[56:59], a[120:123], v[124:127], v[56:59]
  ds_read_b128 v[116:119], v190 offset:15360
  v_permlane16_swap_b32 v166, v167
  v_mfma_f32_16x16x32_bf16 v[60:63], a[124:127], v[124:127], v[60:63]
  buffer_load_dwordx4 v4, s[16:19], s6 offen offset:0 lds
  v_mfma_f32_16x16x32_bf16 v[64:67], v[124:127], a[128:131], v[64:67]
  s_barrier
  v_mfma_f32_16x16x32_bf16 v[56:59], a[132:135], v[128:131], v[56:59]
  ds_read_b128 v[120:123], v191 offset:0
  s_add_u32 s6, s56, 203776
  v_add_f32 v166, v166, v167
  v_mfma_f32_16x16x32_bf16 v[60:63], a[136:139], v[128:131], v[60:63]
  v_mov_b32 v167, v166
  v_mfma_f32_16x16x32_bf16 v[64:67], v[128:131], a[140:143], v[64:67]
  s_waitcnt lgkmcnt(2)
  v_add_u32 v190, 65536, v2
  v_permlane32_swap_b32 v166, v167
  v_mfma_f32_16x16x32_bf16 v[56:59], a[144:147], v[132:135], v[56:59]
  ds_read_b128 v[124:127], v191 offset:1024
  buffer_load_dwordx4 v4, s[16:19], s6 offen offset:1024 lds
  v_mul_f32 v168, 0x3b000000, v166
  v_mul_f32 v167, 0x3b000000, v167
  v_mfma_f32_16x16x32_bf16 v[60:63], a[148:151], v[132:135], v[60:63]
  s_add_u32 s6, s56, 210944
  v_fma_f32 v167, -v168, v168, v167
  v_mfma_f32_16x16x32_bf16 v[64:67], v[132:135], a[152:155], v[64:67]
  v_max_f32 v167, 0, v167
  v_mfma_f32_16x16x32_bf16 v[56:59], a[156:159], v[136:139], v[56:59]
  ds_read_b128 v[128:131], v191 offset:2048
  v_add_f32 v169, 0x3727c5ac, v167
  v_mfma_f32_16x16x32_bf16 v[60:63], a[160:163], v[136:139], v[60:63]
  buffer_load_dwordx4 v4, s[16:19], s6 offen offset:2048 lds
  v_rsq_f32 v170, v169
  v_mfma_f32_16x16x32_bf16 v[64:67], v[136:139], a[164:167], v[64:67]
  v_cndmask_b32 v168, v168, v170, s[78:79]
  ds_write_b32 v162, v168
  s_add_u32 s6, s56, 218112
  v_mfma_f32_16x16x32_bf16 v[56:59], a[168:171], v[112:115], v[56:59]
  ds_read_b128 v[132:135], v191 offset:3072
  v_mfma_f32_16x16x32_bf16 v[60:63], a[172:175], v[112:115], v[60:63]
  v_mfma_f32_16x16x32_bf16 v[64:67], v[112:115], a[176:179], v[64:67]
  s_waitcnt lgkmcnt(3)
  buffer_load_dwordx4 v4, s[16:19], s6 offen offset:3072 lds
  v_mfma_f32_16x16x32_bf16 v[56:59], a[180:183], v[116:119], v[56:59]
  ds_read_b128 v[136:139], v191 offset:4096
  s_add_u32 m0, s55, 81920
  v_mfma_f32_16x16x32_bf16 v[60:63], a[184:187], v[116:119], v[60:63]
  s_add_u32 s6, s61, 49152
  v_mfma_f32_16x16x32_bf16 v[64:67], v[116:119], a[188:191], v[64:67]
  s_waitcnt lgkmcnt(0)
  s_barrier
  v_mfma_f32_16x16x32_bf16 v[68:71], a[0:3], v[120:123], 0
  ds_read_b128 v[112:115], v191 offset:5120
  buffer_load_dwordx4 v2, s[40:43], s6 offen offset:0 sc1 lds
  v_mfma_f32_16x16x32_bf16 v[72:75], a[4:7], v[120:123], 0
  ds_read2_b32 v[148:149], v24 offset0:0 offset1:32
  ds_read_b128 v[140:143], v25 offset:0
  v_mfma_f32_16x16x32_bf16 v[76:79], v[120:123], a[8:11], 0
  ds_read_b128 v[144:147], v25 offset:128
  v_mfma_f32_16x16x32_bf16 v[68:71], a[12:15], v[124:127], v[68:71]
  ds_read_b128 v[116:119], v191 offset:6144
  v_mfma_f32_16x16x32_bf16 v[72:75], a[16:19], v[124:127], v[72:75]
  buffer_load_dwordx4 v2, s[40:43], s6 offen offset:1024 sc1 lds
  v_mfma_f32_16x16x32_bf16 v[76:79], v[124:127], a[20:23], v[76:79]
  v_mfma_f32_16x16x32_bf16 v[68:71], a[24:27], v[128:131], v[68:71]
  ds_read_b128 v[120:123], v191 offset:7168
  v_mfma_f32_16x16x32_bf16 v[72:75], a[28:31], v[128:131], v[72:75]
  v_mfma_f32_16x16x32_bf16 v[76:79], v[128:131], a[32:35], v[76:79]
  buffer_load_dwordx4 v2, s[40:43], s6 offen offset:2048 sc1 lds
  v_mfma_f32_16x16x32_bf16 v[68:71], a[36:39], v[132:135], v[68:71]
  ds_read_b128 v[124:127], v191 offset:8192
  v_mfma_f32_16x16x32_bf16 v[72:75], a[40:43], v[132:135], v[72:75]
  s_waitcnt lgkmcnt(4)
  v_fma_f32 v60, -v148, v36, v60
  v_fma_f32 v61, -v148, v37, v61
  v_mfma_f32_16x16x32_bf16 v[76:79], v[132:135], a[44:47], v[76:79]
  v_fma_f32 v62, -v148, v38, v62
  v_fma_f32 v63, -v148, v39, v63
  v_mfma_f32_16x16x32_bf16 v[68:71], a[48:51], v[136:139], v[68:71]
  ds_read_b128 v[128:131], v191 offset:9216
  buffer_load_dwordx4 v2, s[40:43], s6 offen offset:3072 sc1 lds
  v_mfma_f32_16x16x32_bf16 v[72:75], a[52:55], v[136:139], v[72:75]
  v_fma_f32 v56, -v148, v32, v56
  v_fma_f32 v57, -v148, v33, v57
  v_mfma_f32_16x16x32_bf16 v[76:79], v[136:139], a[56:59], v[76:79]
  v_fma_f32 v58, -v148, v34, v58
  v_fma_f32 v59, -v148, v35, v59
  v_mfma_f32_16x16x32_bf16 v[68:71], a[60:63], v[112:115], v[68:71]
  ds_read_b128 v[132:135], v191 offset:10240
  v_mul_f32 v60, v60, v149
  v_mfma_f32_16x16x32_bf16 v[72:75], a[64:67], v[112:115], v[72:75]
  v_and_b32 v164, 256, v10
  v_add_u32 v164, v164, v10
  buffer_load_dwordx4 v[48:51], v164, s[40:43], s86 offen sc1
  v_mfma_f32_16x16x32_bf16 v[76:79], v[112:115], a[68:71], v[76:79]
  s_waitcnt lgkmcnt(2)
  v_mul_f32 v61, v61, v149
  v_mul_f32 v62, v62, v149
  v_mfma_f32_16x16x32_bf16 v[68:71], a[72:75], v[116:119], v[68:71]
  ds_read_b128 v[136:139], v191 offset:11264
  v_mul_f32 v63, v63, v149
  v_mfma_f32_16x16x32_bf16 v[72:75], a[76:79], v[116:119], v[72:75]
  v_cvt_pk_bf16_f32 v80, v56, v57
  v_cvt_pk_bf16_f32 v81, v58, v59
  v_mfma_f32_16x16x32_bf16 v[76:79], v[116:119], a[80:83], v[76:79]
  buffer_load_dwordx4 v[52:55], v164, s[40:43], s86 offen offset:256 sc1
  v_mfma_f32_16x16x32_bf16 v[68:71], a[84:87], v[120:123], v[68:71]
  ds_read_b128 v[112:115], v191 offset:12288
  v_cvt_pk_bf16_f32 v90, v60, v61
  v_mfma_f32_16x16x32_bf16 v[72:75], a[88:91], v[120:123], v[72:75]
  v_cvt_pk_bf16_f32 v91, v62, v63
  v_mul_f32 v108, 0x3eb8aa3b, v149
  v_mfma_f32_16x16x32_bf16 v[76:79], v[120:123], a[92:95], v[76:79]
  v_fma_f32 v64, -v140, v22, v64
  v_fma_f32 v65, -v141, v22, v65
  v_mfma_f32_16x16x32_bf16 v[68:71], a[96:99], v[124:127], v[68:71]
  ds_read_b128 v[116:119], v191 offset:13312
  v_mov_b32 v7, L_p3_1-2048-L_pc
  v_add_u32 v7, s39, v7
  global_load_dword v6, v7, s[90:91]
  v_mfma_f32_16x16x32_bf16 v[72:75], a[100:103], v[124:127], v[72:75]
  v_lshlrev_b32 v7, 5, v17
  buffer_load_dword v1, v7, s[40:43], s66 offen sc1
  s_add_u32 m0, s55, 114688
  s_add_u32 s6, s60, 0
  v_mfma_f32_16x16x32_bf16 v[76:79], v[124:127], a[104:107], v[76:79]
  s_waitcnt lgkmcnt(2)
  buffer_load_dwordx4 v2, s[40:43], s6 offen offset:0 sc1 lds
  v_mfma_f32_16x16x32_bf16 v[68:71], a[108:111], v[128:131], v[68:71]
  ds_read_b128 v[120:123], v191 offset:14336
  v_fma_f32 v66, -v142, v22, v66
  v_mfma_f32_16x16x32_bf16 v[72:75], a[112:115], v[128:131], v[72:75]
  v_fma_f32 v67, -v143, v22, v67
  v_mul_f32 v64, v64, v144
  v_mfma_f32_16x16x32_bf16 v[76:79], v[128:131], a[116:119], v[76:79]
  v_mul_f32 v65, v65, v145
  v_mul_f32 v66, v66, v146
  v_mfma_f32_16x16x32_bf16 v[68:71], a[120:123], v[132:135], v[68:71]
  ds_read_b128 v[124:127], v191 offset:15360
  v_mul_f32 v67, v67, v147
  v_mfma_f32_16x16x32_bf16 v[72:75], a[124:127], v[132:135], v[72:75]
  v_cvt_pk_bf16_f32 v100, v64, v65
  v_cvt_pk_bf16_f32 v101, v66, v67
  v_mfma_f32_16x16x32_bf16 v[76:79], v[132:135], a[128:131], v[76:79]
  s_waitcnt vmcnt(9)
  s_barrier
  v_mfma_f32_16x16x32_bf16 v[68:71], a[132:135], v[136:139], v[68:71]
  ds_read_b128 v[128:131], v190 offset:0
  buffer_load_dwordx4 v2, s[40:43], s6 offen offset:1024 sc1 lds
  v_mfma_f32_16x16x32_bf16 v[72:75], a[136:139], v[136:139], v[72:75]
  v_add_u32 v150, 16384, v8
  v_mfma_f32_16x16x32_bf16 v[76:79], v[136:139], a[140:143], v[76:79]
  s_waitcnt lgkmcnt(3)
  v_add_u32 v191, 81920, v2
  v_xor_b32 v151, 64, v150
  v_mfma_f32_16x16x32_bf16 v[68:71], a[144:147], v[112:115], v[68:71]
  ds_read_b128 v[132:135], v190 offset:1024
  ds_read_b64_tr_b16 a[192:193], v150 offset:0
  v_mfma_f32_16x16x32_bf16 v[72:75], a[148:151], v[112:115], v[72:75]
  ds_read_b64_tr_b16 a[194:195], v150 offset:512
  ds_read_b64_tr_b16 a[196:197], v151 offset:0
  v_mfma_f32_16x16x32_bf16 v[76:79], v[112:115], a[152:155], v[76:79]
  ds_read_b64_tr_b16 a[198:199], v151 offset:512
  ds_read_b64_tr_b16 a[200:201], v150 offset:2048
  v_mfma_f32_16x16x32_bf16 v[68:71], a[156:159], v[116:119], v[68:71]
  ds_read_b128 v[136:139], v190 offset:2048
  ds_read_b64_tr_b16 a[202:203], v150 offset:2560
  v_mfma_f32_16x16x32_bf16 v[72:75], a[160:163], v[116:119], v[72:75]
  buffer_load_dwordx4 v2, s[40:43], s6 offen offset:2048 sc1 lds
  v_mfma_f32_16x16x32_bf16 v[76:79], v[116:119], a[164:167], v[76:79]
  s_waitcnt lgkmcnt(9)
  ds_read2_b32 v[148:149], v24 offset0:16 offset1:48
  ds_read_b128 v[140:143], v25 offset:64
  v_mfma_f32_16x16x32_bf16 v[68:71], a[168:171], v[120:123], v[68:71]
  ds_read_b128 v[112:115], v190 offset:3072
  ds_read_b128 v[144:147], v25 offset:192
  v_mfma_f32_16x16x32_bf16 v[72:75], a[172:175], v[120:123], v[72:75]
  ds_read_b64_tr_b16 a[204:205], v151 offset:2048
  ds_read_b64_tr_b16 a[206:207], v151 offset:2560
  v_mfma_f32_16x16x32_bf16 v[76:79], v[120:123], a[176:179], v[76:79]
  s_waitcnt lgkmcnt(10)
  ds_read_b64_tr_b16 a[208:209], v150 offset:4096
  ds_read_b64_tr_b16 a[210:211], v150 offset:4608
  v_mfma_f32_16x16x32_bf16 v[68:71], a[180:183], v[124:127], v[68:71]
  ds_read_b128 v[116:119], v190 offset:4096
  ds_read_b64_tr_b16 a[212:213], v151 offset:4096
  v_mfma_f32_16x16x32_bf16 v[72:75], a[184:187], v[124:127], v[72:75]
  ds_read_b64_tr_b16 a[214:215], v151 offset:4608
  s_waitcnt lgkmcnt(10)
  ds_read_b64_tr_b16 a[216:217], v150 offset:6144
  v_mfma_f32_16x16x32_bf16 v[76:79], v[124:127], a[188:191], v[76:79]
  s_waitcnt vmcnt(6)
  v_lshlrev_b32 v40, 16, v48
  v_and_b32 v41, 0xffff0000, v48
  v_lshlrev_b32 v42, 16, v49
  v_and_b32 v43, 0xffff0000, v49
  v_lshlrev_b32 v44, 16, v50
  v_and_b32 v45, 0xffff0000, v50
  v_lshlrev_b32 v46, 16, v51
  v_and_b32 v47, 0xffff0000, v51
  s_waitcnt vmcnt(5)
  v_lshlrev_b32 v48, 16, v52
  v_and_b32 v49, 0xffff0000, v52
  v_lshlrev_b32 v50, 16, v53
  v_and_b32 v51, 0xffff0000, v53
  v_lshlrev_b32 v52, 16, v54
  v_and_b32 v53, 0xffff0000, v54
  v_lshlrev_b32 v54, 16, v55
  v_and_b32 v55, 0xffff0000, v55
  buffer_load_dwordx4 v2, s[40:43], s6 offen offset:3072 sc1 lds
  v_mfma_f32_16x16x32_bf16 v[56:59], a[0:3], v[128:131], 0
  ds_read_b128 v[120:123], v190 offset:5120
  s_add_u32 m0, s55, 131072
  v_mfma_f32_16x16x32_bf16 v[60:63], a[4:7], v[128:131], 0
  s_add_u32 s6, s60, 16384
  ds_read_b64_tr_b16 a[218:219], v150 offset:6656
  v_mfma_f32_16x16x32_bf16 v[64:67], v[128:131], a[8:11], 0
  ds_read_b64_tr_b16 a[220:221], v151 offset:6144
  ds_read_b64_tr_b16 a[222:223], v151 offset:6656
  v_mfma_f32_16x16x32_bf16 v[56:59], a[12:15], v[132:135], v[56:59]
  s_waitcnt lgkmcnt(4)
  ds_read_b128 v[124:127], v190 offset:6144
  v_fma_f32 v72, -v148, v36, v72
  v_mfma_f32_16x16x32_bf16 v[60:63], a[16:19], v[132:135], v[60:63]
  v_fma_f32 v73, -v148, v37, v73
  v_fma_f32 v74, -v148, v38, v74
  v_mfma_f32_16x16x32_bf16 v[64:67], v[132:135], a[20:23], v[64:67]
  v_fma_f32 v75, -v148, v39, v75
  v_fma_f32 v68, -v148, v32, v68
  v_mfma_f32_16x16x32_bf16 v[56:59], a[24:27], v[136:139], v[56:59]
  ds_read_b128 v[128:131], v190 offset:7168
  buffer_load_dwordx4 v2, s[40:43], s6 offen offset:0 sc1 lds
  v_mfma_f32_16x16x32_bf16 v[60:63], a[28:31], v[136:139], v[60:63]
  v_fma_f32 v69, -v148, v33, v69
  v_fma_f32 v70, -v148, v34, v70
  v_mfma_f32_16x16x32_bf16 v[64:67], v[136:139], a[32:35], v[64:67]
  v_fma_f32 v71, -v148, v35, v71
  v_mul_f32 v72, v72, v149
  v_mfma_f32_16x16x32_bf16 v[56:59], a[36:39], v[112:115], v[56:59]
  ds_read_b128 v[132:135], v190 offset:8192
  v_add_u32 v152, 32768, v8
  v_mfma_f32_16x16x32_bf16 v[60:63], a[40:43], v[112:115], v[60:63]
  v_xor_b32 v153, 64, v152
  v_mul_f32 v73, v73, v149
  v_mfma_f32_16x16x32_bf16 v[64:67], v[112:115], a[44:47], v[64:67]
  ds_read_b64_tr_b16 a[224:225], v152 offset:0
  ds_read_b64_tr_b16 a[226:227], v152 offset:512
  ds_read_b64_tr_b16 a[228:229], v153 offset:0
  v_mfma_f32_16x16x32_bf16 v[56:59], a[48:51], v[116:119], v[56:59]
  ds_read_b128 v[136:139], v190 offset:9216
  ds_read_b64_tr_b16 a[230:231], v153 offset:512
  v_mfma_f32_16x16x32_bf16 v[60:63], a[52:55], v[116:119], v[60:63]
  buffer_load_dwordx4 v2, s[40:43], s6 offen offset:1024 sc1 lds
  ds_read_b64_tr_b16 a[232:233], v152 offset:2048
  ds_read_b64_tr_b16 a[234:235], v152 offset:2560
  v_mfma_f32_16x16x32_bf16 v[64:67], v[116:119], a[56:59], v[64:67]
  s_waitcnt lgkmcnt(8)
  ds_read_b64_tr_b16 a[236:237], v153 offset:2048
  ds_read_b64_tr_b16 a[238:239], v153 offset:2560
  v_mfma_f32_16x16x32_bf16 v[56:59], a[60:63], v[120:123], v[56:59]
  ds_read_b128 v[112:115], v190 offset:10240
  ds_read_b64_tr_b16 a[240:241], v152 offset:4096
  v_mfma_f32_16x16x32_bf16 v[60:63], a[64:67], v[120:123], v[60:63]
  ds_read_b64_tr_b16 a[242:243], v152 offset:4608
  ds_read_b64_tr_b16 a[244:245], v153 offset:4096
  v_mfma_f32_16x16x32_bf16 v[64:67], v[120:123], a[68:71], v[64:67]
  ds_read_b64_tr_b16 a[246:247], v153 offset:4608
  s_waitcnt lgkmcnt(10)
  ds_read_b64_tr_b16 a[248:249], v152 offset:6144
  v_mfma_f32_16x16x32_bf16 v[56:59], a[72:75], v[124:127], v[56:59]
  ds_read_b128 v[116:119], v190 offset:11264
  ds_read_b64_tr_b16 a[250:251], v152 offset:6656
  v_mfma_f32_16x16x32_bf16 v[60:63], a[76:79], v[124:127], v[60:63]
  ds_read_b64_tr_b16 a[252:253], v153 offset:6144
  ds_read_b64_tr_b16 a[254:255], v153 offset:6656
  buffer_load_dwordx4 v2, s[40:43], s6 offen offset:2048 sc1 lds
  v_mfma_f32_16x16x32_bf16 v[64:67], v[124:127], a[80:83], v[64:67]
  v_mul_f32 v74, v74, v149
  v_mul_f32 v75, v75, v149
  v_mfma_f32_16x16x32_bf16 v[56:59], a[84:87], v[128:131], v[56:59]
  buffer_load_dwordx4 v2, s[40:43], s6 offen offset:3072 sc1 lds
  s_waitcnt vmcnt(8) lgkmcnt(12)
  v_cmp_ne_u32 vcc, v1, v26
  s_mov_b32 s7, 0
  s_cbranch_vccz L_spd_22
L_sp_21:
  buffer_load_dword v1, v7, s[40:43], s66 offen sc1
  s_add_u32 s7, s7, 1
  s_waitcnt vmcnt(0)
  v_cmp_ne_u32 vcc, v1, v26
  s_cmp_lt_u32 s7, 0x40000
  s_cbranch_vccz L_spd_22
  s_cbranch_scc1 L_sp_21
L_spd_22:
  ds_read_b128 v[120:123], v190 offset:12288
  s_add_u32 m0, s55, 98304
  s_nop 0
  buffer_load_dwordx4 v2, s[40:43], s63 offen offset:0 sc1 lds
  v_mfma_f32_16x16x32_bf16 v[60:63], a[88:91], v[128:131], v[60:63]
  buffer_load_dword v150, v160, s[40:43], s70 offen offset:64 sc1
  v_mfma_f32_16x16x32_bf16 v[64:67], v[128:131], a[92:95], v[64:67]
  buffer_load_dword v151, v160, s[40:43], s70 offen offset:576 sc1
  v_mfma_f32_16x16x32_bf16 v[56:59], a[96:99], v[132:135], v[56:59]
  ds_read_b128 v[124:127], v190 offset:13312
  buffer_load_dword v152, v160, s[40:43], s70 offen offset:1088 sc1
  v_mfma_f32_16x16x32_bf16 v[60:63], a[100:103], v[132:135], v[60:63]
  buffer_load_dwordx4 v2, s[40:43], s63 offen offset:1024 sc1 lds
  v_mfma_f32_16x16x32_bf16 v[64:67], v[132:135], a[104:107], v[64:67]
  buffer_load_dword v153, v160, s[40:43], s70 offen offset:1600 sc1
  v_mfma_f32_16x16x32_bf16 v[56:59], a[108:111], v[136:139], v[56:59]
  ds_read_b128 v[128:131], v190 offset:14336
  buffer_load_dword v154, v160, s[40:43], s70 offen offset:2112 sc1
  v_mfma_f32_16x16x32_bf16 v[60:63], a[112:115], v[136:139], v[60:63]
  buffer_load_dword v155, v160, s[40:43], s70 offen offset:2624 sc1
  v_mfma_f32_16x16x32_bf16 v[64:67], v[136:139], a[116:119], v[64:67]
  s_waitcnt lgkmcnt(2)
  buffer_load_dwordx4 v2, s[40:43], s63 offen offset:2048 sc1 lds
  v_mfma_f32_16x16x32_bf16 v[56:59], a[120:123], v[112:115], v[56:59]
  ds_read_b128 v[132:135], v190 offset:15360
  buffer_load_dword v156, v160, s[40:43], s70 offen offset:3136 sc1
  v_mfma_f32_16x16x32_bf16 v[60:63], a[124:127], v[112:115], v[60:63]
  buffer_load_dword v157, v160, s[40:43], s70 offen offset:3648 sc1
  v_mfma_f32_16x16x32_bf16 v[64:67], v[112:115], a[128:131], v[64:67]
  s_waitcnt lgkmcnt(0)
  s_barrier
  buffer_load_dwordx4 v2, s[40:43], s63 offen offset:3072 sc1 lds
  v_mfma_f32_16x16x32_bf16 v[56:59], a[132:135], v[116:119], v[56:59]
  ds_read_b128 v[136:139], v191 offset:0
  s_add_u32 s6, s24, 262144
  v_mfma_f32_16x16x32_bf16 v[60:63], a[136:139], v[116:119], v[60:63]
  v_add_u32 v163, 148032, v161
  v_cvt_pk_bf16_f32 v82, v68, v69
  v_mfma_f32_16x16x32_bf16 v[64:67], v[116:119], a[140:143], v[64:67]
  v_add_u32 v190, 98304, v2
  v_cvt_pk_bf16_f32 v83, v70, v71
  v_mfma_f32_16x16x32_bf16 v[56:59], a[144:147], v[120:123], v[56:59]
  ds_read_b128 v[112:115], v191 offset:1024
  buffer_load_dword v6, v16, s[40:43], s6 offen sc1
  s_add_u32 s6, s25, 32768
  v_mfma_f32_16x16x32_bf16 v[60:63], a[148:151], v[120:123], v[60:63]
  buffer_load_dword v6, v3, s[40:43], s6 offen sc1
  s_add_u32 m0, s55, 49152
  s_add_u32 s6, s60, 32768
  buffer_load_dwordx4 v2, s[40:43], s6 offen offset:0 sc1 lds
  v_mfma_f32_16x16x32_bf16 v[64:67], v[120:123], a[152:155], v[64:67]
  v_cvt_pk_bf16_f32 v92, v72, v73
  v_cvt_pk_bf16_f32 v93, v74, v75
  v_mfma_f32_16x16x32_bf16 v[56:59], a[156:159], v[124:127], v[56:59]
  ds_read_b128 v[116:119], v191 offset:2048
  v_mul_f32 v109, 0x3eb8aa3b, v149
  v_mfma_f32_16x16x16_bf16 v[166:169], v[92:93], v[82:83], 0
  v_fma_f32 v76, -v140, v22, v76
  v_fma_f32 v77, -v141, v22, v77
  v_mfma_f32_16x16x16_bf16 v[170:173], v[90:91], v[82:83], 0
  v_fma_f32 v78, -v142, v22, v78
  v_fma_f32 v79, -v143, v22, v79
  v_mfma_f32_16x16x32_bf16 v[60:63], a[160:163], v[124:127], v[60:63]
  ds_read2_b32 v[148:149], v24 offset0:64 offset1:96
  s_nop 0
  v_cndmask_b32 v186, v166, v167, s[72:73]
  v_mfma_f32_16x16x32_bf16 v[64:67], v[124:127], a[164:167], v[64:67]
  v_cndmask_b32 v187, v168, v169, s[72:73]
  v_cndmask_b32 v188, v170, v171, s[72:73]
  v_mfma_f32_16x16x32_bf16 v[56:59], a[168:171], v[128:131], v[56:59]
  ds_read_b128 v[120:123], v191 offset:3072
  buffer_load_dwordx4 v2, s[40:43], s6 offen offset:1024 sc1 lds
  v_mfma_f32_16x16x32_bf16 v[60:63], a[172:175], v[128:131], v[60:63]
  v_mul_f32 v76, v76, v144
  v_mul_f32 v77, v77, v145
  v_mfma_f32_16x16x32_bf16 v[64:67], v[128:131], a[176:179], v[64:67]
  v_mul_f32 v78, v78, v146
  v_cndmask_b32 v189, v172, v173, s[72:73]
  v_mfma_f32_16x16x32_bf16 v[56:59], a[180:183], v[132:135], v[56:59]
  ds_read_b128 v[124:127], v191 offset:4096
  v_mul_f32 v79, v79, v147
  v_cvt_pk_bf16_f32 v102, v76, v77
  v_mfma_f32_16x16x32_bf16 v[60:63], a[184:187], v[132:135], v[60:63]
  v_cvt_pk_bf16_f32 v103, v78, v79
  v_cndmask_b32 v186, v188, v186, s[74:75]
  v_mfma_f32_16x16x32_bf16 v[64:67], v[132:135], a[188:191], v[64:67]
  s_waitcnt lgkmcnt(3)
  ds_read_b128 v[140:143], v25 offset:256
  ds_read_b128 v[144:147], v25 offset:384
  v_mfma_f32_16x16x32_bf16 v[68:71], a[0:3], v[136:139], 0
  ds_read_b128 v[128:131], v191 offset:5120
  v_cndmask_b32 v187, v189, v187, s[76:77]
  v_mfma_f32_16x16x32_bf16 v[72:75], a[4:7], v[136:139], 0
  buffer_load_dwordx4 v2, s[40:43], s6 offen offset:2048 sc1 lds
  v_mfma_f32_16x16x32_bf16 v[76:79], v[136:139], a[8:11], 0
  v_max_f32 v188, v186, v187
  v_max_f32 v189, v186, v187
  v_mfma_f32_16x16x32_bf16 v[68:71], a[12:15], v[112:115], v[68:71]
  ds_read_b128 v[132:135], v191 offset:6144
  v_permlane16_swap_b32 v188, v189
  v_mfma_f32_16x16x32_bf16 v[72:75], a[16:19], v[112:115], v[72:75]
  v_max_f32 v166, v188, v189
  v_max_f32 v189, v188, v189
  v_mfma_f32_16x16x32_bf16 v[76:79], v[112:115], a[20:23], v[76:79]
  s_waitcnt lgkmcnt(5)
  v_fma_f32 v60, -v148, v36, v60
  v_permlane32_swap_b32 v166, v189
  v_mfma_f32_16x16x32_bf16 v[68:71], a[24:27], v[116:119], v[68:71]
  ds_read_b128 v[136:139], v191 offset:7168
  v_max_f32 v188, v166, v189
  v_mfma_f32_16x16x32_bf16 v[72:75], a[28:31], v[116:119], v[72:75]
  v_mul_f32 v188, v188, v109
  v_fma_f32 v61, -v148, v37, v61
  v_mfma_f32_16x16x32_bf16 v[76:79], v[116:119], a[32:35], v[76:79]
  buffer_load_dwordx4 v2, s[40:43], s6 offen offset:3072 sc1 lds
  v_mfma_f32_16x16x32_bf16 v[68:71], a[36:39], v[120:123], v[68:71]
  ds_read_b128 v[112:115], v191 offset:8192
  s_add_u32 m0, s55, 16384
  v_mfma_f32_16x16x32_bf16 v[72:75], a[40:43], v[120:123], v[72:75]
  s_add_u32 s6, s60, 49152
  v_fma_f32 v186, v186, v109, -v188
  v_mfma_f32_16x16x32_bf16 v[76:79], v[120:123], a[44:47], v[76:79]
  s_waitcnt lgkmcnt(3)
  v_fma_f32 v187, v187, v109, -v188
  v_fma_f32 v62, -v148, v38, v62
  v_mfma_f32_16x16x32_bf16 v[68:71], a[48:51], v[124:127], v[68:71]
  ds_read_b128 v[116:119], v191 offset:9216
  v_fma_f32 v63, -v148, v39, v63
  v_mfma_f32_16x16x32_bf16 v[72:75], a[52:55], v[124:127], v[72:75]
  v_exp_f32 v186, v186
  v_mfma_f32_16x16x32_bf16 v[76:79], v[124:127], a[56:59], v[76:79]
  v_exp_f32 v187, v187
  v_mfma_f32_16x16x32_bf16 v[68:71], a[60:63], v[128:131], v[68:71]
  ds_read_b128 v[120:123], v191 offset:10240
  buffer_load_dwordx4 v2, s[40:43], s6 offen offset:0 sc1 lds
  v_mfma_f32_16x16x32_bf16 v[72:75], a[64:67], v[128:131], v[72:75]
  v_cvt_pk_bf16_f32 v186, v186, v186
  v_cvt_pk_bf16_f32 v187, v187, v187
  v_mfma_f32_16x16x32_bf16 v[76:79], v[128:131], a[68:71], v[76:79]
  s_waitcnt lgkmcnt(3)
  v_and_b32 v174, v186, v20
  v_and_b32 v176, v186, v18
  v_mfma_f32_16x16x32_bf16 v[68:71], a[72:75], v[132:135], v[68:71]
  ds_read_b128 v[124:127], v191 offset:11264
  v_and_b32 v175, v187, v21
  v_mfma_f32_16x16x32_bf16 v[72:75], a[76:79], v[132:135], v[72:75]
  v_and_b32 v177, v187, v19
  v_fma_f32 v56, -v148, v32, v56
  v_mfma_f32_16x16x32_bf16 v[76:79], v[132:135], a[80:83], v[76:79]
  v_fma_f32 v57, -v148, v33, v57
  v_fma_f32 v58, -v148, v34, v58
  v_mfma_f32_16x16x32_bf16 v[182:185], v[28:31], v[174:177], 0
  v_fma_f32 v59, -v148, v35, v59
  v_mul_f32 v60, v60, v149
  v_mfma_f32_16x16x32_bf16 v[178:181], v[100:103], v[174:177], 0
  buffer_load_dwordx4 v2, s[40:43], s6 offen offset:1024 sc1 lds
  v_mfma_f32_16x16x32_bf16 v[68:71], a[84:87], v[136:139], v[68:71]
  ds_read_b128 v[128:131], v191 offset:12288
  v_mul_f32 v61, v61, v149
  v_mfma_f32_16x16x32_bf16 v[72:75], a[88:91], v[136:139], v[72:75]
  v_rcp_f32 v186, v182
  v_mfma_f32_16x16x32_bf16 v[76:79], v[136:139], a[92:95], v[76:79]
  s_waitcnt lgkmcnt(2)
  v_mul_f32 v178, v178, v186
  v_mul_f32 v179, v179, v186
  v_mfma_f32_16x16x32_bf16 v[68:71], a[96:99], v[112:115], v[68:71]
  ds_read_b128 v[132:135], v191 offset:13312
  s_waitcnt vmcnt(17)
  v_add_f32 v150, v150, v151
  v_mfma_f32_16x16x32_bf16 v[72:75], a[100:103], v[112:115], v[72:75]
  v_mul_f32 v180, v180, v186
  v_mul_f32 v181, v181, v186
  v_mfma_f32_16x16x32_bf16 v[76:79], v[112:115], a[104:107], v[76:79]
  v_cvt_pk_bf16_f32 v178, v178, v179
  v_cvt_pk_bf16_f32 v179, v180, v181
  v_mfma_f32_16x16x32_bf16 v[68:71], a[108:111], v[116:119], v[68:71]
  ds_read_b128 v[136:139], v191 offset:14336
  buffer_load_dwordx4 v2, s[40:43], s6 offen offset:2048 sc1 lds
  v_mfma_f32_16x16x32_bf16 v[72:75], a[112:115], v[116:119], v[72:75]
  buffer_store_dwordx2 v[178:179], v14, s[12:15], s97 offen
  v_mfma_f32_16x16x32_bf16 v[76:79], v[116:119], a[116:119], v[76:79]
  buffer_store_dwordx2 v[178:179], v14, s[44:47], s97 offen sc1
  v_mfma_f32_16x16x32_bf16 v[68:71], a[120:123], v[120:123], v[68:71]
  ds_read_b128 v[112:115], v191 offset:15360
  s_waitcnt vmcnt(17) lgkmcnt(3)
  v_add_f32 v152, v152, v153
  v_mfma_f32_16x16x32_bf16 v[72:75], a[124:127], v[120:123], v[72:75]
  s_waitcnt vmcnt(15)
  v_add_f32 v154, v154, v155
  v_mul_f32 v62, v62, v149
  v_mfma_f32_16x16x32_bf16 v[76:79], v[120:123], a[128:131], v[76:79]
  s_waitcnt vmcnt(11)
  s_barrier
  v_mfma_f32_16x16x32_bf16 v[68:71], a[132:135], v[124:127], v[68:71]
  ds_read_b128 v[116:119], v190 offset:0
  v_add_f32 v156, v156, v157
  v_mfma_f32_16x16x32_bf16 v[72:75], a[136:139], v[124:127], v[72:75]
  buffer_load_dwordx4 v2, s[40:43], s6 offen offset:3072 sc1 lds
  v_mfma_f32_16x16x32_bf16 v[76:79], v[124:127], a[140:143], v[76:79]
  s_add_u32 m0, s55, 32768
  s_add_u32 s6, s60, 65536
  v_mfma_f32_16x16x32_bf16 v[68:71], a[144:147], v[128:131], v[68:71]
  ds_read_b128 v[120:123], v190 offset:1024
  v_add_f32 v150, v150, v152
  v_mfma_f32_16x16x32_bf16 v[72:75], a[148:151], v[128:131], v[72:75]
  v_add_f32 v154, v154, v156
  v_mul_f32 v63, v63, v149
  v_mfma_f32_16x16x32_bf16 v[76:79], v[128:131], a[152:155], v[76:79]
  s_waitcnt lgkmcnt(3)
  v_add_f32 v150, v150, v154
  v_cvt_pk_bf16_f32 v84, v56, v57
  v_mfma_f32_16x16x32_bf16 v[68:71], a[156:159], v[132:135], v[68:71]
  ds_read_b128 v[124:127], v190 offset:2048
  v_mov_b32 v151, v150
  v_mfma_f32_16x16x32_bf16 v[72:75], a[160:163], v[132:135], v[72:75]
  v_fma_f32 v64, -v140, v22, v64
  v_permlane16_swap_b32 v150, v151
  v_mfma_f32_16x16x32_bf16 v[76:79], v[132:135], a[164:167], v[76:79]
  buffer_load_dwordx4 v2, s[40:43], s6 offen offset:0 sc1 lds
  v_fma_f32 v65, -v141, v22, v65
  v_fma_f32 v66, -v142, v22, v66
  v_mfma_f32_16x16x32_bf16 v[68:71], a[168:171], v[136:139], v[68:71]
  ds_read_b128 v[128:131], v190 offset:3072
  v_fma_f32 v67, -v143, v22, v67
  v_mfma_f32_16x16x32_bf16 v[72:75], a[172:175], v[136:139], v[72:75]
  v_mul_f32 v64, v64, v144
  v_mul_f32 v65, v65, v145
  v_mfma_f32_16x16x32_bf16 v[76:79], v[136:139], a[176:179], v[76:79]
  s_waitcnt lgkmcnt(2)
  v_cvt_pk_bf16_f32 v85, v58, v59
  v_mul_f32 v66, v66, v146
  v_mfma_f32_16x16x32_bf16 v[68:71], a[180:183], v[112:115], v[68:71]
  ds_read_b128 v[132:135], v190 offset:4096
  v_cvt_pk_bf16_f32 v94, v60, v61
  v_cvt_pk_bf16_f32 v95, v62, v63
  v_mul_f32 v67, v67, v147
  v_cvt_pk_bf16_f32 v104, v64, v65
  v_mfma_f32_16x16x32_bf16 v[72:75], a[184:187], v[112:115], v[72:75]
  v_mul_f32 v110, 0x3eb8aa3b, v149
  v_cvt_pk_bf16_f32 v105, v66, v67
  v_mfma_f32_16x16x16_bf16 v[166:169], v[94:95], v[84:85], 0
  buffer_load_dwordx4 v2, s[40:43], s6 offen offset:1024 sc1 lds
  v_mfma_f32_16x16x16_bf16 v[170:173], v[92:93], v[84:85], 0
  ds_read2_b32 v[148:149], v24 offset0:80 offset1:112
  ds_read_b128 v[140:143], v25 offset:320
  v_mfma_f32_16x16x32_bf16 v[76:79], v[112:115], a[188:191], v[76:79]
  ds_read_b128 v[144:147], v25 offset:448
  v_add_f32 v150, v150, v151
  v_mfma_f32_16x16x32_bf16 v[60:63], a[4:7], v[116:119], 0
  ds_read_b128 v[136:139], v190 offset:5120
  v_mov_b32 v151, v150
  v_mfma_f32_16x16x32_bf16 v[64:67], v[116:119], a[8:11], 0
  v_cndmask_b32 v186, v166, v167, s[72:73]
  v_permlane32_swap_b32 v150, v151
  v_mfma_f32_16x16x32_bf16 v[60:63], a[16:19], v[120:123], v[60:63]
  ds_read_b128 v[112:115], v190 offset:6144
  v_mul_f32 v152, 0x3b000000, v150
  v_mfma_f32_16x16x32_bf16 v[64:67], v[120:123], a[20:23], v[64:67]
  s_waitcnt lgkmcnt(5)
  v_mul_f32 v151, 0x3b000000, v151
  v_cndmask_b32 v187, v168, v169, s[72:73]
  v_mfma_f32_16x16x32_bf16 v[60:63], a[28:31], v[124:127], v[60:63]
  ds_read_b128 v[116:119], v190 offset:7168
  buffer_load_dwordx4 v2, s[40:43], s6 offen offset:2048 sc1 lds
  v_mfma_f32_16x16x32_bf16 v[64:67], v[124:127], a[32:35], v[64:67]
  v_fma_f32 v151, -v152, v152, v151
  v_cndmask_b32 v188, v170, v171, s[72:73]
  v_mfma_f32_16x16x32_bf16 v[60:63], a[40:43], v[128:131], v[60:63]
  ds_read_b128 v[120:123], v190 offset:8192
  v_max_f32 v151, 0, v151
  v_mfma_f32_16x16x32_bf16 v[64:67], v[128:131], a[44:47], v[64:67]
  v_add_f32 v153, 0x3727c5ac, v151
  v_cndmask_b32 v189, v172, v173, s[72:73]
  v_mfma_f32_16x16x32_bf16 v[60:63], a[52:55], v[132:135], v[60:63]
  ds_read_b128 v[124:127], v190 offset:9216
  v_cndmask_b32 v186, v188, v186, s[74:75]
  v_mfma_f32_16x16x32_bf16 v[64:67], v[132:135], a[56:59], v[64:67]
  s_waitcnt lgkmcnt(4)
  v_rsq_f32 v154, v153
  v_mfma_f32_16x16x32_bf16 v[60:63], a[64:67], v[136:139], v[60:63]
  ds_read_b128 v[128:131], v190 offset:10240
  v_cndmask_b32 v152, v152, v154, s[78:79]
  v_mfma_f32_16x16x32_bf16 v[64:67], v[136:139], a[68:71], v[64:67]
  s_waitcnt lgkmcnt(4)
  buffer_load_dwordx4 v2, s[40:43], s6 offen offset:3072 sc1 lds
  v_mfma_f32_16x16x32_bf16 v[60:63], a[76:79], v[112:115], v[60:63]
  ds_read_b128 v[132:135], v190 offset:11264
  s_add_u32 m0, s55, 0
  v_mfma_f32_16x16x32_bf16 v[64:67], v[112:115], a[80:83], v[64:67]
  s_waitcnt lgkmcnt(4)
  s_add_u32 s6, s60, 81920
  ds_write_b32 v163, v152
  v_mfma_f32_16x16x32_bf16 v[60:63], a[88:91], v[116:119], v[60:63]
  ds_read_b128 v[136:139], v190 offset:12288
  v_cndmask_b32 v187, v189, v187, s[76:77]
  v_mfma_f32_16x16x32_bf16 v[64:67], v[116:119], a[92:95], v[64:67]
  s_waitcnt lgkmcnt(5)
  v_max_f32 v188, v186, v187
  v_max_f32 v189, v186, v187
  v_mfma_f32_16x16x32_bf16 v[60:63], a[100:103], v[120:123], v[60:63]
  ds_read_b128 v[112:115], v190 offset:13312
  v_permlane16_swap_b32 v188, v189
  v_mfma_f32_16x16x32_bf16 v[64:67], v[120:123], a[104:107], v[64:67]
  s_waitcnt lgkmcnt(5)
  v_max_f32 v166, v188, v189
  v_max_f32 v189, v188, v189
  v_mfma_f32_16x16x32_bf16 v[60:63], a[112:115], v[124:127], v[60:63]
  ds_read_b128 v[116:119], v190 offset:14336
  buffer_load_dwordx4 v2, s[40:43], s6 offen offset:0 sc1 lds
  v_mfma_f32_16x16x32_bf16 v[64:67], v[124:127], a[116:119], v[64:67]
  s_waitcnt lgkmcnt(5)
  v_permlane32_swap_b32 v166, v189
  v_fma_f32 v72, -v148, v36, v72
  v_mfma_f32_16x16x32_bf16 v[60:63], a[124:127], v[128:131], v[60:63]
  ds_read_b128 v[120:123], v190 offset:15360
  v_max_f32 v188, v166, v189
  v_mfma_f32_16x16x32_bf16 v[64:67], v[128:131], a[128:131], v[64:67]
  s_waitcnt lgkmcnt(5)
  v_mul_f32 v188, v188, v110
  v_fma_f32 v73, -v148, v37, v73
  v_mfma_f32_16x16x32_bf16 v[60:63], a[136:139], v[132:135], v[60:63]
  v_fma_f32 v186, v186, v110, -v188
  v_fma_f32 v187, v187, v110, -v188
  v_mfma_f32_16x16x32_bf16 v[64:67], v[132:135], a[140:143], v[64:67]
  s_waitcnt lgkmcnt(3)
  v_exp_f32 v186, v186
  v_mfma_f32_16x16x32_bf16 v[60:63], a[148:151], v[136:139], v[60:63]
  v_exp_f32 v187, v187
  v_mfma_f32_16x16x32_bf16 v[64:67], v[136:139], a[152:155], v[64:67]
  s_waitcnt lgkmcnt(2)
  buffer_load_dwordx4 v2, s[40:43], s6 offen offset:1024 sc1 lds
  v_mfma_f32_16x16x32_bf16 v[60:63], a[160:163], v[112:115], v[60:63]
  v_cvt_pk_bf16_f32 v186, v186, v186
  v_cvt_pk_bf16_f32 v187, v187, v187
  v_mfma_f32_16x16x32_bf16 v[64:67], v[112:115], a[164:167], v[64:67]
  s_waitcnt lgkmcnt(1)
  v_and_b32 v174, v186, v20
  v_and_b32 v176, v186, v18
  v_mfma_f32_16x16x32_bf16 v[60:63], a[172:175], v[116:119], v[60:63]
  v_and_b32 v175, v187, v21
  v_and_b32 v177, v187, v19
  v_mfma_f32_16x16x32_bf16 v[64:67], v[116:119], a[176:179], v[64:67]
  s_waitcnt lgkmcnt(0)
  v_fma_f32 v74, -v148, v38, v74
  v_fma_f32 v75, -v148, v39, v75
  v_mfma_f32_16x16x32_bf16 v[182:185], v[28:31], v[174:177], 0
  v_fma_f32 v68, -v148, v32, v68
  v_fma_f32 v69, -v148, v33, v69
  v_mfma_f32_16x16x32_bf16 v[178:181], v[102:105], v[174:177], 0
  v_fma_f32 v70, -v148, v34, v70
  v_fma_f32 v71, -v148, v35, v71
  v_mfma_f32_16x16x32_bf16 v[60:63], a[184:187], v[120:123], v[60:63]
  buffer_load_dwordx4 v2, s[40:43], s6 offen offset:2048 sc1 lds
  v_mfma_f32_16x16x32_bf16 v[64:67], v[120:123], a[188:191], v[64:67]
  buffer_load_dwordx4 v2, s[40:43], s6 offen offset:3072 sc1 lds
  v_rcp_f32 v186, v182
  s_nop 0
  v_mul_f32 v178, v178, v186
  v_mul_f32 v179, v179, v186
  v_mul_f32 v180, v180, v186
  v_mul_f32 v181, v181, v186
  v_cvt_pk_bf16_f32 v178, v178, v179
  v_cvt_pk_bf16_f32 v179, v180, v181
  buffer_store_dwordx2 v[178:179], v14, s[12:15], s98 offen
  buffer_store_dwordx2 v[178:179], v14, s[44:47], s98 offen sc1
  v_mul_f32 v72, v72, v149
  v_mul_f32 v73, v73, v149
  v_mul_f32 v74, v74, v149
  v_mul_f32 v75, v75, v149
  v_cvt_pk_bf16_f32 v86, v68, v69
  v_cvt_pk_bf16_f32 v87, v70, v71
  v_cvt_pk_bf16_f32 v96, v72, v73
  v_cvt_pk_bf16_f32 v97, v74, v75
  s_nop 1
  v_mfma_f32_16x16x16_bf16 v[166:169], v[96:97], v[86:87], 0
  v_mfma_f32_16x16x16_bf16 v[170:173], v[94:95], v[86:87], 0
  s_nop 6
  v_cndmask_b32 v186, v166, v167, s[72:73]
  v_cndmask_b32 v187, v168, v169, s[72:73]
  v_cndmask_b32 v188, v170, v171, s[72:73]
  v_cndmask_b32 v189, v172, v173, s[72:73]
  v_cndmask_b32 v186, v188, v186, s[74:75]
  v_cndmask_b32 v187, v189, v187, s[76:77]
  v_max_f32 v188, v186, v187
  v_max_f32 v189, v186, v187
  v_mul_f32 v111, 0x3eb8aa3b, v149
  ds_read2_b32 v[148:149], v24 offset0:144 offset1:176
  v_fma_f32 v76, -v140, v22, v76
  v_fma_f32 v77, -v141, v22, v77
  v_fma_f32 v78, -v142, v22, v78
  v_fma_f32 v79, -v143, v22, v79
  v_mul_f32 v76, v76, v144
  v_mul_f32 v77, v77, v145
  v_mul_f32 v78, v78, v146
  v_mul_f32 v79, v79, v147
  v_cvt_pk_bf16_f32 v106, v76, v77
  v_cvt_pk_bf16_f32 v107, v78, v79
  ds_read_b128 v[140:143], v25 offset:576
  ds_read_b128 v[144:147], v25 offset:704
  s_waitcnt lgkmcnt(2)
  v_pk_fma_f32 v[60:61], v[148:149], v[36:37], v[60:61] op_sel:[0,0,0] op_sel_hi:[0,1,1] neg_lo:[1,0,0] neg_hi:[1,0,0]
  v_pk_fma_f32 v[62:63], v[148:149], v[38:39], v[62:63] op_sel:[0,0,0] op_sel_hi:[0,1,1] neg_lo:[1,0,0] neg_hi:[1,0,0]
  v_pk_mul_f32 v[60:61], v[60:61], v[148:149] op_sel:[0,1] op_sel_hi:[1,1]
  v_pk_mul_f32 v[62:63], v[62:63], v[148:149] op_sel:[0,1] op_sel_hi:[1,1]
  v_cvt_pk_bf16_f32 v88, v60, v61
  v_cvt_pk_bf16_f32 v89, v62, v63
  v_mfma_f32_16x16x16_bf16 v[112:115], v[90:91], v[80:81], 0
  v_permlane16_swap_b32 v188, v189
  v_mfma_f32_16x16x16_bf16 v[116:119], v[88:89], v[80:81], 0
  s_waitcnt lgkmcnt(1)
  v_pk_fma_f32 v[64:65], v[140:141], v[22:23], v[64:65] op_sel:[0,0,0] op_sel_hi:[1,0,1] neg_lo:[1,0,0] neg_hi:[1,0,0]
  v_pk_fma_f32 v[66:67], v[142:143], v[22:23], v[66:67] op_sel:[0,0,0] op_sel_hi:[1,0,1] neg_lo:[1,0,0] neg_hi:[1,0,0]
  s_waitcnt lgkmcnt(0)
  v_pk_mul_f32 v[64:65], v[64:65], v[144:145] op_sel:[0,0] op_sel_hi:[1,1]
  v_pk_mul_f32 v[66:67], v[66:67], v[146:147] op_sel:[0,0] op_sel_hi:[1,1]
  v_cvt_pk_bf16_f32 v98, v64, v65
  v_cvt_pk_bf16_f32 v99, v66, v67
  v_cndmask_b32 v132, v112, v113, s[72:73]
  v_cndmask_b32 v133, v114, v115, s[72:73]
  v_max_f32 v166, v188, v189
  v_cndmask_b32 v134, v116, v117, s[72:73]
  v_cndmask_b32 v135, v118, v119, s[72:73]
  v_min_f32 v134, s71, v134
  v_min_f32 v135, s71, v135
  v_cndmask_b32 v132, v134, v132, s[74:75]
  v_cndmask_b32 v133, v135, v133, s[76:77]
  v_max_f32 v189, v188, v189
  v_max_f32 v134, v132, v133
  v_max_f32 v135, v132, v133
  v_permlane32_swap_b32 v166, v189
  s_nop 0
  v_permlane16_swap_b32 v134, v135
  v_max_f32 v188, v166, v189
  v_max_f32 v112, v134, v135
  v_max_f32 v135, v134, v135
  v_pk_add_f32 v[186:187], v[186:187], v[188:189] op_sel:[0,0] op_sel_hi:[1,0] neg_lo:[0,1] neg_hi:[0,1]
  v_pk_mul_f32 v[186:187], v[186:187], v[110:111] op_sel:[0,1] op_sel_hi:[1,1]
  v_permlane32_swap_b32 v112, v135
  v_exp_f32 v186, v186
  v_max_f32 v134, v112, v135
  v_exp_f32 v187, v187
  v_pk_add_f32 v[132:133], v[132:133], v[134:135] op_sel:[0,0] op_sel_hi:[1,0] neg_lo:[0,1] neg_hi:[0,1]
  v_cvt_pk_bf16_f32 v186, v186, v186
  v_pk_mul_f32 v[132:133], v[132:133], v[108:109] op_sel:[0,0] op_sel_hi:[1,0]
  v_cvt_pk_bf16_f32 v187, v187, v187
  v_exp_f32 v132, v132
  v_exp_f32 v133, v133
  v_cvt_pk_bf16_f32 v132, v132, v132
  v_and_b32 v174, v186, v20
  v_cvt_pk_bf16_f32 v133, v133, v133
  v_and_b32 v120, v132, v20
  v_and_b32 v122, v132, v18
  v_and_b32 v176, v186, v18
  v_and_b32 v121, v133, v21
  v_and_b32 v175, v187, v21
  v_and_b32 v123, v133, v19
  v_and_b32 v177, v187, v19
  s_nop 0
  v_mfma_f32_16x16x32_bf16 v[128:131], v[28:31], v[120:123], 0
  v_mfma_f32_16x16x32_bf16 v[182:185], v[28:31], v[174:177], 0
  v_mfma_f32_16x16x32_bf16 v[124:127], v[98:101], v[120:123], 0
  s_nop 5
  v_rcp_f32 v132, v128
  v_mfma_f32_16x16x32_bf16 v[178:181], v[104:107], v[174:177], 0
  v_rcp_f32 v186, v182
  v_pk_mul_f32 v[124:125], v[124:125], v[132:133] op_sel:[0,0] op_sel_hi:[1,0]
  v_pk_mul_f32 v[126:127], v[126:127], v[132:133] op_sel:[0,0] op_sel_hi:[1,0]
  v_cvt_pk_bf16_f32 v124, v124, v125
  v_cvt_pk_bf16_f32 v125, v126, v127
  s_nop 2
  v_pk_mul_f32 v[178:179], v[178:179], v[186:187] op_sel:[0,0] op_sel_hi:[1,0]
  v_pk_mul_f32 v[180:181], v[180:181], v[186:187] op_sel:[0,0] op_sel_hi:[1,0]
  v_cvt_pk_bf16_f32 v178, v178, v179
  v_cvt_pk_bf16_f32 v179, v180, v181
  buffer_store_dwordx2 v[124:125], v14, s[12:15], s96 offen
  buffer_store_dwordx2 v[178:179], v14, s[12:15], s99 offen
  buffer_store_dwordx2 v[124:125], v14, s[44:47], s96 offen sc1
  buffer_store_dwordx2 v[178:179], v14, s[44:47], s99 offen sc1
  s_add_u32 s38, s37, 7
  v_mov_b32 v26, s38
  s_waitcnt vmcnt(0)
  s_barrier
  buffer_store_dword v26, v9, s[40:43], s67 offen
  buffer_store_dword v26, v9, s[44:47], s67 offen offset:256 sc1
  s_lshl_b32 s3, s89, 1
  s_add_u32 s3, s3, s83
  s_lshl_b32 s5, s50, 1
  s_add_u32 s5, s5, s84
  s_lshl_b32 s96, s3, 15
  s_lshl_b32 s4, s5, 10
  s_add_u32 s96, s96, s4
  s_add_u32 s96, s96, s54
  s_add_u32 s96, s96, 262144
  s_lshl_b32 s97, s3, 12
  s_lshl_b32 s4, s5, 8
  s_add_u32 s97, s97, s4
  s_add_u32 s97, s97, s54
  s_add_u32 s97, s97, 32768
  s_lshl_b32 s85, s3, 15
  s_lshl_b32 s4, s84, 13
  s_add_u32 s85, s85, s4
  s_add_u32 s85, s85, s54
  s_add_u32 s85, s85, 786432
  s_add_u32 s3, s55, 98304
  v_add_u32 v184, s3, v2
  v_xor_b32 v185, 8192, v184
  v_and_b32 v116, 256, v10
  v_add_u32 v116, v116, v10
  s_mov_b32 s7, 0
  s_cmp_lg_u32 s53, 0
  s_cbranch_scc1 L_join_23
  s_mov_b64 exec, 0xff
  buffer_load_dword v1, v3, s[40:43], s64 offen sc1
  buffer_load_dword v12, v3, s[40:43], s64 offen sc1
  buffer_load_dword v15, v3, s[40:43], s64 offen sc1
L_ploop_24:
  s_waitcnt vmcnt(2)
  v_sub_u32 v27, v1, v26
  v_cmp_le_u32 vcc, 16, v27
  s_add_u32 s7, s7, 1
  s_cbranch_vccz L_join_23
  buffer_load_dword v1, v3, s[40:43], s64 offen sc1
  s_waitcnt vmcnt(2)
  v_sub_u32 v27, v12, v26
  v_cmp_le_u32 vcc, 16, v27
  s_add_u32 s7, s7, 1
  s_cbranch_vccz L_join_23
  buffer_load_dword v12, v3, s[40:43], s64 offen sc1
  s_waitcnt vmcnt(2)
  v_sub_u32 v27, v15, v26
  v_cmp_le_u32 vcc, 16, v27
  s_add_u32 s7, s7, 1
  s_cbranch_vccz L_join_23
  buffer_load_dword v15, v3, s[40:43], s64 offen sc1
  s_and_b32 s3, s7, s22
  s_cbranch_scc1 L_ploop_24
  buffer_load_dword v27, v3, s[40:43], s64 offen offset:256 sc1
  s_waitcnt vmcnt(0)
  v_sub_u32 v27, v27, v26
  v_cmp_le_u32 vcc, 16, v27
  s_cmp_lt_u32 s7, 0x80000
  s_cbranch_vccz L_join_23
  s_cbranch_scc1 L_ploop_24
L_join_23:
  s_mov_b64 exec, -1
  s_barrier
  buffer_load_dwordx4 v[120:123], v10, s[40:43], s85 offen offset:0 sc1
  buffer_load_dwordx4 v[124:127], v10, s[40:43], s85 offen offset:512 sc1
  buffer_load_dwordx4 v[128:131], v10, s[40:43], s85 offen offset:1024 sc1
  buffer_load_dwordx4 v[132:135], v10, s[40:43], s85 offen offset:1536 sc1
  buffer_load_dwordx4 v[136:139], v10, s[40:43], s85 offen offset:2048 sc1
  buffer_load_dwordx4 v[140:143], v10, s[40:43], s85 offen offset:2560 sc1
  buffer_load_dwordx4 v[144:147], v10, s[40:43], s85 offen offset:3072 sc1
  buffer_load_dwordx4 v[148:151], v10, s[40:43], s85 offen offset:3584 sc1
  s_add_u32 s85, s85, 4096
  buffer_load_dwordx4 v[152:155], v10, s[40:43], s85 offen offset:0 sc1
  buffer_load_dwordx4 v[156:159], v10, s[40:43], s85 offen offset:512 sc1
  s_waitcnt vmcnt(9)
  v_mfma_f32_32x32x16_bf16 v[72:87], v[196:199], v[120:123], 0
  buffer_load_dwordx4 v[160:163], v10, s[40:43], s85 offen offset:1024 sc1
  v_mfma_f32_32x32x16_bf16 v[56:71], v[192:195], v[120:123], v[40:55]
  s_waitcnt vmcnt(9)
  v_mfma_f32_32x32x16_bf16 v[72:87], v[204:207], v[124:127], v[72:87]
  buffer_load_dwordx4 v[164:167], v10, s[40:43], s85 offen offset:1536 sc1
  v_mfma_f32_32x32x16_bf16 v[56:71], v[200:203], v[124:127], v[56:71]
  s_waitcnt vmcnt(9)
  v_mfma_f32_32x32x16_bf16 v[72:87], v[212:215], v[128:131], v[72:87]
  buffer_load_dwordx4 v[168:171], v10, s[40:43], s85 offen offset:2048 sc1
  v_mfma_f32_32x32x16_bf16 v[56:71], v[208:211], v[128:131], v[56:71]
  s_waitcnt vmcnt(9)
  v_mfma_f32_32x32x16_bf16 v[72:87], v[220:223], v[132:135], v[72:87]
  buffer_load_dwordx4 v[172:175], v10, s[40:43], s85 offen offset:2560 sc1
  v_mfma_f32_32x32x16_bf16 v[56:71], v[216:219], v[132:135], v[56:71]
  s_waitcnt vmcnt(9)
  v_mfma_f32_32x32x16_bf16 v[72:87], v[228:231], v[136:139], v[72:87]
  buffer_load_dwordx4 v[176:179], v10, s[40:43], s85 offen offset:3072 sc1
  v_mfma_f32_32x32x16_bf16 v[56:71], v[224:227], v[136:139], v[56:71]
  s_waitcnt vmcnt(9)
  v_mfma_f32_32x32x16_bf16 v[72:87], v[236:239], v[140:143], v[72:87]
  buffer_load_dwordx4 v[180:183], v10, s[40:43], s85 offen offset:3584 sc1
  v_mfma_f32_32x32x16_bf16 v[56:71], v[232:235], v[140:143], v[56:71]
  s_waitcnt vmcnt(9)
  v_mfma_f32_32x32x16_bf16 v[72:87], v[244:247], v[144:147], v[72:87]
  s_add_u32 m0, s55, 65536
  s_add_u32 s6, s60, 98304
  buffer_load_dwordx4 v2, s[40:43], s6 offen offset:0 sc1 lds
  v_mfma_f32_32x32x16_bf16 v[56:71], v[240:243], v[144:147], v[56:71]
  s_waitcnt vmcnt(9)
  v_mfma_f32_32x32x16_bf16 v[72:87], v[252:255], v[148:151], v[72:87]
  v_mfma_f32_32x32x16_bf16 v[56:71], v[248:251], v[148:151], v[56:71]
  s_waitcnt vmcnt(8)
  v_mfma_f32_32x32x16_bf16 v[72:87], a[196:199], v[152:155], v[72:87]
  buffer_load_dwordx4 v2, s[40:43], s6 offen offset:1024 sc1 lds
  v_mfma_f32_32x32x16_bf16 v[56:71], a[192:195], v[152:155], v[56:71]
  s_waitcnt vmcnt(8)
  v_mfma_f32_32x32x16_bf16 v[72:87], a[204:207], v[156:159], v[72:87]
  v_mfma_f32_32x32x16_bf16 v[56:71], a[200:203], v[156:159], v[56:71]
  s_waitcnt vmcnt(7)
  v_mfma_f32_32x32x16_bf16 v[72:87], a[212:215], v[160:163], v[72:87]
  buffer_load_dwordx4 v2, s[40:43], s6 offen offset:2048 sc1 lds
  v_mfma_f32_32x32x16_bf16 v[56:71], a[208:211], v[160:163], v[56:71]
  s_waitcnt vmcnt(7)
  v_mfma_f32_32x32x16_bf16 v[72:87], a[220:223], v[164:167], v[72:87]
  v_mfma_f32_32x32x16_bf16 v[56:71], a[216:219], v[164:167], v[56:71]
  s_waitcnt vmcnt(6)
  v_mfma_f32_32x32x16_bf16 v[72:87], a[228:231], v[168:171], v[72:87]
  buffer_load_dwordx4 v2, s[40:43], s6 offen offset:3072 sc1 lds
  v_mfma_f32_32x32x16_bf16 v[56:71], a[224:227], v[168:171], v[56:71]
  s_waitcnt vmcnt(6)
  v_mfma_f32_32x32x16_bf16 v[72:87], a[236:239], v[172:175], v[72:87]
  v_mfma_f32_32x32x16_bf16 v[56:71], a[232:235], v[172:175], v[56:71]
  s_waitcnt vmcnt(5)
  v_mfma_f32_32x32x16_bf16 v[72:87], a[244:247], v[176:179], v[72:87]
  s_add_u32 m0, s55, 81920
  s_add_u32 s6, s60, 114688
  buffer_load_dwordx4 v2, s[40:43], s6 offen offset:0 sc1 lds
  v_mfma_f32_32x32x16_bf16 v[56:71], a[240:243], v[176:179], v[56:71]
  s_waitcnt vmcnt(5)
  v_mfma_f32_32x32x16_bf16 v[72:87], a[252:255], v[180:183], v[72:87]
  v_mfma_f32_32x32x16_bf16 v[56:71], a[248:251], v[180:183], v[56:71]
  buffer_load_dwordx4 v2, s[40:43], s6 offen offset:1024 sc1 lds
  buffer_load_dwordx4 v2, s[40:43], s6 offen offset:2048 sc1 lds
  buffer_load_dwordx4 v2, s[40:43], s6 offen offset:3072 sc1 lds
  s_nop 7
  ds_write_b128 v184, v[72:75] offset:0
  ds_write_b128 v184, v[76:79] offset:1024
  ds_write_b128 v184, v[80:83] offset:2048
  ds_write_b128 v184, v[84:87] offset:3072
  s_waitcnt lgkmcnt(0)
  s_barrier
  ds_read_b128 v[88:91], v185 offset:0
  ds_read_b128 v[92:95], v185 offset:1024
  ds_read_b128 v[96:99], v185 offset:2048
  ds_read_b128 v[100:103], v185 offset:3072
  s_waitcnt lgkmcnt(3)
  v_pk_add_f32 v[56:57], v[56:57], v[88:89] op_sel:[0,0] op_sel_hi:[1,1]
  v_pk_add_f32 v[58:59], v[58:59], v[90:91] op_sel:[0,0] op_sel_hi:[1,1]
  s_waitcnt lgkmcnt(2)
  v_pk_add_f32 v[60:61], v[60:61], v[92:93] op_sel:[0,0] op_sel_hi:[1,1]
  v_pk_add_f32 v[62:63], v[62:63], v[94:95] op_sel:[0,0] op_sel_hi:[1,1]
  v_cvt_pk_bf16_f32 v104, v56, v57
  v_cvt_pk_bf16_f32 v105, v58, v59
  v_cvt_pk_bf16_f32 v106, v60, v61
  v_cvt_pk_bf16_f32 v107, v62, v63
  buffer_store_dwordx4 v[104:107], v116, s[12:15], s96 offen
  s_waitcnt lgkmcnt(1)
  v_pk_add_f32 v[64:65], v[64:65], v[96:97] op_sel:[0,0] op_sel_hi:[1,1]
  v_pk_add_f32 v[66:67], v[66:67], v[98:99] op_sel:[0,0] op_sel_hi:[1,1]
  s_waitcnt lgkmcnt(0)
  v_pk_add_f32 v[68:69], v[68:69], v[100:101] op_sel:[0,0] op_sel_hi:[1,1]
  v_pk_add_f32 v[70:71], v[70:71], v[102:103] op_sel:[0,0] op_sel_hi:[1,1]
  v_cvt_pk_bf16_f32 v108, v64, v65
  v_cvt_pk_bf16_f32 v109, v66, v67
  v_cvt_pk_bf16_f32 v110, v68, v69
  v_cvt_pk_bf16_f32 v111, v70, v71
  buffer_store_dwordx4 v[108:111], v116, s[12:15], s96 offen offset:256
  v_dot2_f32_bf16 v114, v104, v28, 0
  v_dot2_f32_bf16 v115, v104, v104, 0
  v_dot2_f32_bf16 v112, v105, v28, 0
  v_dot2_f32_bf16 v113, v105, v105, 0
  v_dot2_f32_bf16 v114, v106, v28, v114
  v_dot2_f32_bf16 v115, v106, v106, v115
  v_dot2_f32_bf16 v112, v107, v28, v112
  v_dot2_f32_bf16 v113, v107, v107, v113
  v_dot2_f32_bf16 v114, v108, v28, v114
  v_dot2_f32_bf16 v115, v108, v108, v115
  v_dot2_f32_bf16 v112, v109, v28, v112
  v_dot2_f32_bf16 v113, v109, v109, v113
  v_dot2_f32_bf16 v114, v110, v28, v114
  v_dot2_f32_bf16 v115, v110, v110, v115
  v_dot2_f32_bf16 v112, v111, v28, v112
  v_dot2_f32_bf16 v113, v111, v111, v113
  s_nop 2
  v_pk_add_f32 v[112:113], v[112:113], v[114:115] op_sel:[0,0] op_sel_hi:[1,1]
  s_nop 1
  v_permlane32_swap_b32 v112, v113
  v_add_f32 v112, v112, v113
  buffer_store_dword v112, v3, s[12:15], s97 offen
  s_cmp_lg_u32 s23, 0
  s_cbranch_scc1 L_sl_25
  buffer_store_dwordx4 v[104:107], v116, s[44:47], s96 offen sc1
  buffer_store_dwordx4 v[108:111], v116, s[44:47], s96 offen offset:256 sc1
  buffer_store_dword v112, v3, s[44:47], s97 offen sc1
L_sl_25:
  s_add_u32 s38, s37, 8
  v_mov_b32 v26, s38
  s_waitcnt vmcnt(0)
  s_barrier
  buffer_store_dword v26, v9, s[40:43], s67 offen
  buffer_store_dword v26, v9, s[44:47], s67 offen offset:256 sc1
L_p3_1:
  s_and_b32 s3, s51, 1
  s_lshl_b32 s3, s3, 2
  s_add_u32 s3, s3, s53
  s_mov_b32 s5, s52
  s_lshl_b32 s97, s3, 15
  s_lshl_b32 s4, s5, 10
  s_add_u32 s97, s97, s4
  s_add_u32 s97, s97, s54
  s_add_u32 s97, s97, 262144
  s_and_b32 s3, s51, 1
  s_lshl_b32 s3, s3, 2
  s_add_u32 s3, s3, s53
  s_lshl_b32 s85, s3, 15
  s_add_u32 s85, s85, s54
  s_add_u32 s85, s85, 262144
  s_lshl_b32 s96, s3, 12
  s_add_u32 s96, s96, s54
  s_add_u32 s96, s96, 32768
  s_mul_i32 s86, s3, 114688
  s_lshr_b32 s4, s52, 3
  s_mul_i32 s4, s4, 26624
  s_add_u32 s86, s86, s4
  s_lshl_b32 s4, s52, 8
  s_add_u32 s86, s86, s4
  s_add_u32 s86, s86, s54
  s_add_u32 s86, s86, 2621440
  v_add_u32 v188, 114688, v2
  ds_read_b128 v[120:123], v188 offset:0
  ds_read_b128 v[124:127], v188 offset:1024
  ds_read_b128 v[128:131], v188 offset:2048
  ds_read_b128 v[132:135], v188 offset:3072
  ds_read_b128 v[136:139], v188 offset:4096
  ds_read_b128 v[140:143], v188 offset:5120
  ds_read_b128 v[144:147], v188 offset:6144
  ds_read_b128 v[148:151], v188 offset:7168
  s_mov_b32 s7, 0
  s_cmp_lg_u32 s53, 0
  s_cbranch_scc1 L_join_26
  s_mov_b64 exec, 0xffff
  buffer_load_dword v1, v3, s[40:43], s65 offen sc1
  buffer_load_dword v12, v3, s[40:43], s65 offen sc1
  buffer_load_dword v15, v3, s[40:43], s65 offen sc1
L_ploop_27:
  s_waitcnt vmcnt(2)
  v_sub_u32 v27, v1, v26
  v_cmp_le_u32 vcc, 16, v27
  s_add_u32 s7, s7, 1
  s_cbranch_vccz L_join_26
  buffer_load_dword v1, v3, s[40:43], s65 offen sc1
  s_waitcnt vmcnt(2)
  v_sub_u32 v27, v12, v26
  v_cmp_le_u32 vcc, 16, v27
  s_add_u32 s7, s7, 1
  s_cbranch_vccz L_join_26
  buffer_load_dword v12, v3, s[40:43], s65 offen sc1
  s_waitcnt vmcnt(2)
  v_sub_u32 v27, v15, v26
  v_cmp_le_u32 vcc, 16, v27
  s_add_u32 s7, s7, 1
  s_cbranch_vccz L_join_26
  buffer_load_dword v15, v3, s[40:43], s65 offen sc1
  s_and_b32 s3, s7, s22
  s_cbranch_scc1 L_ploop_27
  buffer_load_dword v27, v3, s[40:43], s65 offen offset:256 sc1
  s_waitcnt vmcnt(0)
  v_sub_u32 v27, v27, v26
  v_cmp_le_u32 vcc, 16, v27
  s_cmp_lt_u32 s7, 0x80000
  s_cbranch_vccz L_join_26
  s_cbranch_scc1 L_ploop_27
L_join_26:
  s_mov_b64 exec, -1
  s_barrier
  buffer_load_dwordx4 v[192:195], v10, s[40:43], s85 offen offset:0 sc1
  buffer_load_dwordx4 v[196:199], v10, s[40:43], s85 offen offset:512 sc1
  buffer_load_dwordx4 v[200:203], v10, s[40:43], s85 offen offset:1024 sc1
  buffer_load_dwordx4 v[204:207], v10, s[40:43], s85 offen offset:1536 sc1
  buffer_load_dwordx4 v[208:211], v10, s[40:43], s85 offen offset:2048 sc1
  buffer_load_dwordx4 v[212:215], v10, s[40:43], s85 offen offset:2560 sc1
  buffer_load_dwordx4 v[216:219], v10, s[40:43], s85 offen offset:3072 sc1
  buffer_load_dwordx4 v[220:223], v10, s[40:43], s85 offen offset:3584 sc1
  s_add_u32 s85, s85, 4096
  buffer_load_dwordx4 v[224:227], v10, s[40:43], s85 offen offset:0 sc1
  buffer_load_dwordx4 v[228:231], v10, s[40:43], s85 offen offset:512 sc1
  v_add_u32 v27, 131072, v2
  s_waitcnt vmcnt(9) lgkmcnt(6)
  ds_read_b128 v[152:155], v188 offset:8192
  buffer_load_dwordx4 v[232:235], v10, s[40:43], s85 offen offset:1024 sc1
  v_mfma_f32_32x32x16_bf16 v[56:71], v[120:123], v[192:195], 0
  ds_read_b128 v[156:159], v188 offset:9216
  v_mfma_f32_32x32x16_bf16 v[72:87], v[124:127], v[192:195], 0
  s_waitcnt lgkmcnt(2)
  ds_read_b128 v[120:123], v188 offset:10240
  v_mfma_f32_32x32x16_bf16 v[88:103], v[128:131], v[192:195], 0
  s_waitcnt vmcnt(9)
  ds_read_b128 v[124:127], v188 offset:11264
  buffer_load_dwordx4 v[236:239], v10, s[40:43], s85 offen offset:1536 sc1
  v_mfma_f32_32x32x16_bf16 v[56:71], v[132:135], v[196:199], v[56:71]
  ds_read_b128 v[128:131], v188 offset:12288
  v_mfma_f32_32x32x16_bf16 v[72:87], v[136:139], v[196:199], v[72:87]
  ds_read_b128 v[132:135], v188 offset:13312
  buffer_load_dwordx4 v[240:243], v10, s[40:43], s85 offen offset:2048 sc1
  v_mfma_f32_32x32x16_bf16 v[88:103], v[140:143], v[196:199], v[88:103]
  s_waitcnt vmcnt(10) lgkmcnt(4)
  ds_read_b128 v[136:139], v188 offset:14336
  v_mfma_f32_32x32x16_bf16 v[56:71], v[144:147], v[200:203], v[56:71]
  ds_read_b128 v[140:143], v188 offset:15360
  buffer_load_dwordx4 v[244:247], v10, s[40:43], s85 offen offset:2560 sc1
  v_mfma_f32_32x32x16_bf16 v[72:87], v[148:151], v[200:203], v[72:87]
  s_barrier
  ds_read_b128 v[144:147], v27 offset:0
  v_add_u32 v188, 49152, v2
  v_mfma_f32_32x32x16_bf16 v[88:103], v[152:155], v[200:203], v[88:103]
  s_waitcnt vmcnt(10) lgkmcnt(4)
  ds_read_b128 v[148:151], v27 offset:1024
  buffer_load_dwordx4 v[248:251], v10, s[40:43], s85 offen offset:3072 sc1
  v_mfma_f32_32x32x16_bf16 v[56:71], v[156:159], v[204:207], v[56:71]
  ds_read_b128 v[152:155], v27 offset:2048
  v_mfma_f32_32x32x16_bf16 v[72:87], v[120:123], v[204:207], v[72:87]
  ds_read_b128 v[156:159], v27 offset:3072
  buffer_load_dwordx4 v[252:255], v10, s[40:43], s85 offen offset:3584 sc1
  s_add_u32 s85, s85, 4096
  v_mfma_f32_32x32x16_bf16 v[88:103], v[124:127], v[204:207], v[88:103]
  s_waitcnt vmcnt(11) lgkmcnt(4)
  ds_read_b128 v[120:123], v27 offset:4096
  v_mfma_f32_32x32x16_bf16 v[56:71], v[128:131], v[208:211], v[56:71]
  ds_read_b128 v[124:127], v27 offset:5120
  buffer_load_dwordx4 a[192:195], v10, s[40:43], s85 offen offset:0 sc1
  v_mfma_f32_32x32x16_bf16 v[72:87], v[132:135], v[208:211], v[72:87]
  ds_read_b128 v[128:131], v27 offset:6144
  v_mfma_f32_32x32x16_bf16 v[88:103], v[136:139], v[208:211], v[88:103]
  s_waitcnt vmcnt(11) lgkmcnt(4)
  ds_read_b128 v[132:135], v27 offset:7168
  buffer_load_dword v104, v3, s[40:43], s96 offen offset:0 sc1
  buffer_load_dword v105, v3, s[40:43], s96 offen offset:256 sc1
  v_mfma_f32_32x32x16_bf16 v[56:71], v[140:143], v[212:215], v[56:71]
  ds_read_b128 v[136:139], v27 offset:8192
  buffer_load_dwordx4 a[196:199], v10, s[40:43], s85 offen offset:512 sc1
  v_mfma_f32_32x32x16_bf16 v[72:87], v[144:147], v[212:215], v[72:87]
  ds_read_b128 v[140:143], v27 offset:9216
  v_mfma_f32_32x32x16_bf16 v[88:103], v[148:151], v[212:215], v[88:103]
  s_waitcnt vmcnt(13) lgkmcnt(4)
  ds_read_b128 v[144:147], v27 offset:10240
  buffer_load_dword v106, v3, s[40:43], s96 offen offset:512 sc1
  buffer_load_dword v107, v3, s[40:43], s96 offen offset:768 sc1
  v_mfma_f32_32x32x16_bf16 v[56:71], v[152:155], v[216:219], v[56:71]
  ds_read_b128 v[148:151], v27 offset:11264
  buffer_load_dwordx4 a[200:203], v10, s[40:43], s85 offen offset:1024 sc1
  v_mfma_f32_32x32x16_bf16 v[72:87], v[156:159], v[216:219], v[72:87]
  ds_read_b128 v[152:155], v27 offset:12288
  v_mfma_f32_32x32x16_bf16 v[88:103], v[120:123], v[216:219], v[88:103]
  s_waitcnt vmcnt(15) lgkmcnt(4)
  ds_read_b128 v[156:159], v27 offset:13312
  buffer_load_dword v108, v3, s[40:43], s96 offen offset:1024 sc1
  buffer_load_dword v109, v3, s[40:43], s96 offen offset:1280 sc1
  v_mfma_f32_32x32x16_bf16 v[56:71], v[124:127], v[220:223], v[56:71]
  ds_read_b128 v[120:123], v27 offset:14336
  buffer_load_dwordx4 a[204:207], v10, s[40:43], s85 offen offset:1536 sc1
  v_mfma_f32_32x32x16_bf16 v[72:87], v[128:131], v[220:223], v[72:87]
  ds_read_b128 v[124:127], v27 offset:15360
  v_mfma_f32_32x32x16_bf16 v[88:103], v[132:135], v[220:223], v[88:103]
  s_waitcnt vmcnt(17) lgkmcnt(4)
  s_barrier
  ds_read_b128 v[128:131], v188 offset:0
  v_add_u32 v27, 16384, v2
  v_mfma_f32_32x32x16_bf16 v[56:71], v[136:139], v[224:227], v[56:71]
  ds_read_b128 v[132:135], v188 offset:1024
  buffer_load_dword v110, v3, s[40:43], s96 offen offset:1536 sc1
  buffer_load_dword v111, v3, s[40:43], s96 offen offset:1792 sc1
  v_mfma_f32_32x32x16_bf16 v[72:87], v[140:143], v[224:227], v[72:87]
  ds_read_b128 v[136:139], v188 offset:2048
  buffer_load_dwordx4 a[208:211], v10, s[40:43], s85 offen offset:2048 sc1
  v_mfma_f32_32x32x16_bf16 v[88:103], v[144:147], v[224:227], v[88:103]
  s_waitcnt vmcnt(19) lgkmcnt(4)
  ds_read_b128 v[140:143], v188 offset:3072
  v_mfma_f32_32x32x16_bf16 v[56:71], v[148:151], v[228:231], v[56:71]
  ds_read_b128 v[144:147], v188 offset:4096
  buffer_load_dword v112, v3, s[40:43], s96 offen offset:2048 sc1
  buffer_load_dword v113, v3, s[40:43], s96 offen offset:2304 sc1
  v_mfma_f32_32x32x16_bf16 v[72:87], v[152:155], v[228:231], v[72:87]
  ds_read_b128 v[148:151], v188 offset:5120
  buffer_load_dwordx4 a[212:215], v10, s[40:43], s85 offen offset:2560 sc1
  v_mfma_f32_32x32x16_bf16 v[88:103], v[156:159], v[228:231], v[88:103]
  s_waitcnt vmcnt(21) lgkmcnt(4)
  ds_read_b128 v[152:155], v188 offset:6144
  v_mfma_f32_32x32x16_bf16 v[56:71], v[120:123], v[232:235], v[56:71]
  ds_read_b128 v[156:159], v188 offset:7168
  buffer_load_dword v114, v3, s[40:43], s96 offen offset:2560 sc1
  buffer_load_dword v115, v3, s[40:43], s96 offen offset:2816 sc1
  v_mfma_f32_32x32x16_bf16 v[72:87], v[124:127], v[232:235], v[72:87]
  ds_read_b128 v[120:123], v188 offset:8192
  buffer_load_dwordx4 a[216:219], v10, s[40:43], s85 offen offset:3072 sc1
  v_mfma_f32_32x32x16_bf16 v[88:103], v[128:131], v[232:235], v[88:103]
  s_waitcnt vmcnt(23) lgkmcnt(4)
  ds_read_b128 v[124:127], v188 offset:9216
  v_mfma_f32_32x32x16_bf16 v[56:71], v[132:135], v[236:239], v[56:71]
  ds_read_b128 v[128:131], v188 offset:10240
  buffer_load_dword v116, v3, s[40:43], s96 offen offset:3072 sc1
  buffer_load_dword v117, v3, s[40:43], s96 offen offset:3328 sc1
  v_mfma_f32_32x32x16_bf16 v[72:87], v[136:139], v[236:239], v[72:87]
  ds_read_b128 v[132:135], v188 offset:11264
  buffer_load_dwordx4 a[220:223], v10, s[40:43], s85 offen offset:3584 sc1
  v_mfma_f32_32x32x16_bf16 v[88:103], v[140:143], v[236:239], v[88:103]
  s_waitcnt vmcnt(25) lgkmcnt(4)
  ds_read_b128 v[136:139], v188 offset:12288
  v_mfma_f32_32x32x16_bf16 v[56:71], v[144:147], v[240:243], v[56:71]
  ds_read_b128 v[140:143], v188 offset:13312
  buffer_load_dword v118, v3, s[40:43], s96 offen offset:3584 sc1
  buffer_load_dword v119, v3, s[40:43], s96 offen offset:3840 sc1
  s_add_u32 s85, s85, 4096
  v_mfma_f32_32x32x16_bf16 v[72:87], v[148:151], v[240:243], v[72:87]
  ds_read_b128 v[144:147], v188 offset:14336
  buffer_load_dwordx4 a[224:227], v10, s[40:43], s85 offen offset:0 sc1
  v_mfma_f32_32x32x16_bf16 v[88:103], v[152:155], v[240:243], v[88:103]
  s_waitcnt vmcnt(27) lgkmcnt(4)
  ds_read_b128 v[148:151], v188 offset:15360
  v_mfma_f32_32x32x16_bf16 v[56:71], v[156:159], v[244:247], v[56:71]
  s_barrier
  ds_read_b128 v[152:155], v27 offset:0
  v_add_u32 v188, 32768, v2
  v_mfma_f32_32x32x16_bf16 v[72:87], v[120:123], v[244:247], v[72:87]
  ds_read_b128 v[156:159], v27 offset:1024
  buffer_load_dwordx4 a[228:231], v10, s[40:43], s85 offen offset:512 sc1
  v_mfma_f32_32x32x16_bf16 v[88:103], v[124:127], v[244:247], v[88:103]
  s_waitcnt vmcnt(27) lgkmcnt(4)
  ds_read_b128 v[120:123], v27 offset:2048
  v_mfma_f32_32x32x16_bf16 v[56:71], v[128:131], v[248:251], v[56:71]
  ds_read_b128 v[124:127], v27 offset:3072
  buffer_load_dwordx4 a[232:235], v10, s[40:43], s85 offen offset:1024 sc1
  v_mfma_f32_32x32x16_bf16 v[72:87], v[132:135], v[248:251], v[72:87]
  ds_read_b128 v[128:131], v27 offset:4096
  v_mfma_f32_32x32x16_bf16 v[88:103], v[136:139], v[248:251], v[88:103]
  s_waitcnt vmcnt(27) lgkmcnt(4)
  ds_read_b128 v[132:135], v27 offset:5120
  buffer_load_dwordx4 a[236:239], v10, s[40:43], s85 offen offset:1536 sc1
  v_mfma_f32_32x32x16_bf16 v[56:71], v[140:143], v[252:255], v[56:71]
  ds_read_b128 v[136:139], v27 offset:6144
  v_mfma_f32_32x32x16_bf16 v[72:87], v[144:147], v[252:255], v[72:87]
  ds_read_b128 v[140:143], v27 offset:7168
  buffer_load_dwordx4 a[240:243], v10, s[40:43], s85 offen offset:2048 sc1
  v_mfma_f32_32x32x16_bf16 v[88:103], v[148:151], v[252:255], v[88:103]
  s_waitcnt vmcnt(28) lgkmcnt(4)
  ds_read_b128 v[144:147], v27 offset:8192
  v_mfma_f32_32x32x16_bf16 v[56:71], v[152:155], a[192:195], v[56:71]
  ds_read_b128 v[148:151], v27 offset:9216
  buffer_load_dwordx4 a[244:247], v10, s[40:43], s85 offen offset:2560 sc1
  v_mfma_f32_32x32x16_bf16 v[72:87], v[156:159], a[192:195], v[72:87]
  ds_read_b128 v[152:155], v27 offset:10240
  v_mfma_f32_32x32x16_bf16 v[88:103], v[120:123], a[192:195], v[88:103]
  s_waitcnt vmcnt(26) lgkmcnt(4)
  ds_read_b128 v[156:159], v27 offset:11264
  buffer_load_dwordx4 a[248:251], v10, s[40:43], s85 offen offset:3072 sc1
  v_mfma_f32_32x32x16_bf16 v[56:71], v[124:127], a[196:199], v[56:71]
  ds_read_b128 v[120:123], v27 offset:12288
  v_mfma_f32_32x32x16_bf16 v[72:87], v[128:131], a[196:199], v[72:87]
  ds_read_b128 v[124:127], v27 offset:13312
  buffer_load_dwordx4 a[252:255], v10, s[40:43], s85 offen offset:3584 sc1
  v_mfma_f32_32x32x16_bf16 v[88:103], v[132:135], a[196:199], v[88:103]
  s_waitcnt vmcnt(25) lgkmcnt(4)
  ds_read_b128 v[128:131], v27 offset:14336
  v_mfma_f32_32x32x16_bf16 v[56:71], v[136:139], a[200:203], v[56:71]
  ds_read_b128 v[132:135], v27 offset:15360
  v_and_b32 v1, 256, v10
  v_add_u32 v1, v1, v10
  buffer_load_dwordx4 v[48:51], v1, s[40:43], s97 offen sc1
  v_mfma_f32_32x32x16_bf16 v[72:87], v[140:143], a[200:203], v[72:87]
  s_barrier
  ds_read_b128 v[136:139], v188 offset:0
  v_add_u32 v27, 0, v2
  v_mfma_f32_32x32x16_bf16 v[88:103], v[144:147], a[200:203], v[88:103]
  s_waitcnt vmcnt(23) lgkmcnt(4)
  ds_read_b128 v[140:143], v188 offset:1024
  buffer_load_dwordx4 v[52:55], v1, s[40:43], s97 offen offset:256 sc1
  s_add_u32 m0, s55, 98304
  s_add_u32 s6, s60, 131072
  v_mfma_f32_32x32x16_bf16 v[56:71], v[148:151], a[204:207], v[56:71]
  ds_read_b128 v[144:147], v188 offset:2048
  v_mfma_f32_32x32x16_bf16 v[72:87], v[152:155], a[204:207], v[72:87]
  ds_read_b128 v[148:151], v188 offset:3072
  buffer_load_dwordx4 v2, s[40:43], s6 offen offset:0 sc1 lds
  v_mfma_f32_32x32x16_bf16 v[88:103], v[156:159], a[204:207], v[88:103]
  s_waitcnt vmcnt(22) lgkmcnt(4)
  ds_read_b128 v[152:155], v188 offset:4096
  v_mfma_f32_32x32x16_bf16 v[56:71], v[120:123], a[208:211], v[56:71]
  ds_read_b128 v[156:159], v188 offset:5120
  v_add_f32 v104, v104, v105
  v_add_f32 v106, v106, v107
  v_add_f32 v108, v108, v109
  v_add_f32 v110, v110, v111
  s_waitcnt vmcnt(20) lgkmcnt(4)
  v_add_f32 v112, v112, v113
  v_mfma_f32_32x32x16_bf16 v[72:87], v[124:127], a[208:211], v[72:87]
  ds_read_b128 v[120:123], v188 offset:6144
  s_waitcnt vmcnt(17)
  v_add_f32 v114, v114, v115
  v_mfma_f32_32x32x16_bf16 v[88:103], v[128:131], a[208:211], v[88:103]
  ds_read_b128 v[124:127], v188 offset:7168
  buffer_load_dwordx4 v2, s[40:43], s6 offen offset:1024 sc1 lds
  s_waitcnt vmcnt(15) lgkmcnt(4)
  v_add_f32 v116, v116, v117
  v_mfma_f32_32x32x16_bf16 v[56:71], v[132:135], a[212:215], v[56:71]
  ds_read_b128 v[128:131], v188 offset:8192
  v_mfma_f32_32x32x16_bf16 v[72:87], v[136:139], a[212:215], v[72:87]
  ds_read_b128 v[132:135], v188 offset:9216
  v_mfma_f32_32x32x16_bf16 v[88:103], v[140:143], a[212:215], v[88:103]
  ds_read_b128 v[136:139], v188 offset:10240
  s_waitcnt vmcnt(12) lgkmcnt(5)
  v_add_f32 v118, v118, v119
  v_add_f32 v104, v104, v106
  v_add_f32 v108, v108, v110
  v_add_f32 v112, v112, v114
  v_add_f32 v116, v116, v118
  v_mfma_f32_32x32x16_bf16 v[56:71], v[144:147], a[216:219], v[56:71]
  ds_read_b128 v[140:143], v188 offset:11264
  buffer_load_dwordx4 v2, s[40:43], s6 offen offset:2048 sc1 lds
  v_add_f32 v104, v104, v108
  v_add_f32 v112, v112, v116
  v_mfma_f32_32x32x16_bf16 v[72:87], v[148:151], a[216:219], v[72:87]
  ds_read_b128 v[144:147], v188 offset:12288
  v_add_f32 v104, v104, v112
  v_mfma_f32_32x32x16_bf16 v[88:103], v[152:155], a[216:219], v[88:103]
  ds_read_b128 v[148:151], v188 offset:13312
  v_mov_b32 v105, v104
  v_mfma_f32_32x32x16_bf16 v[56:71], v[156:159], a[220:223], v[56:71]
  s_waitcnt lgkmcnt(4)
  ds_read_b128 v[152:155], v188 offset:14336
  v_permlane32_swap_b32 v104, v105
  v_mfma_f32_32x32x16_bf16 v[72:87], v[120:123], a[220:223], v[72:87]
  ds_read_b128 v[156:159], v188 offset:15360
  buffer_load_dwordx4 v2, s[40:43], s6 offen offset:3072 sc1 lds
  v_mul_f32 v106, 0x3b000000, v104
  v_mul_f32 v105, 0x3b000000, v105
  v_mfma_f32_32x32x16_bf16 v[88:103], v[124:127], a[220:223], v[88:103]
  s_waitcnt vmcnt(13) lgkmcnt(4)
  s_barrier
  ds_read_b128 v[120:123], v27 offset:0
  v_add_u32 v188, 65536, v2
  v_fma_f32 v105, -v106, v106, v105
  v_mfma_f32_32x32x16_bf16 v[56:71], v[128:131], a[224:227], v[56:71]
  ds_read_b128 v[124:127], v27 offset:1024
  v_max_f32 v105, 0, v105
  v_mfma_f32_32x32x16_bf16 v[72:87], v[132:135], a[224:227], v[72:87]
  ds_read_b128 v[128:131], v27 offset:2048
  v_add_f32 v191, 0x3727c5ac, v105
  v_mfma_f32_32x32x16_bf16 v[88:103], v[136:139], a[224:227], v[88:103]
  s_waitcnt vmcnt(12) lgkmcnt(4)
  ds_read_b128 v[132:135], v27 offset:3072
  v_mov_b32 v7, L_p3_1+2048-L_pc
  v_add_u32 v7, s39, v7
  global_load_dword v6, v7, s[90:91]
  s_add_u32 m0, s55, 114688
  s_add_u32 s6, s60, 147456
  v_mfma_f32_32x32x16_bf16 v[56:71], v[140:143], a[228:231], v[56:71]
  ds_read_b128 v[136:139], v27 offset:4096
  buffer_load_dwordx4 v2, s[40:43], s6 offen offset:0 sc1 lds
  v_rsq_f32 v107, v191
  v_sub_f32 v106, 0, v106
  v_mfma_f32_32x32x16_bf16 v[72:87], v[144:147], a[228:231], v[72:87]
  ds_read_b128 v[140:143], v27 offset:5120
  v_mul_f32 v189, 0xc0135761, v107
  v_cndmask_b32 v106, v106, 0, s[78:79]
  v_mul_f32 v105, v107, v107
  v_mov_b32 v110, 0xffff
  v_mul_f32 v105, 0x3d372713, v105
  v_mfma_f32_32x32x16_bf16 v[88:103], v[148:151], a[228:231], v[88:103]
  s_waitcnt vmcnt(13) lgkmcnt(4)
  ds_read_b128 v[144:147], v27 offset:6144
  v_mov_b32 v163, 0
  v_mul_f32 v190, v189, v105
  v_cvt_pk_bf16_f32 v160, v106, v106
  v_mfma_f32_32x32x16_bf16 v[56:71], v[152:155], a[232:235], v[56:71]
  ds_read_b128 v[148:151], v27 offset:7168
  v_and_b32 v109, 0xffff0000, v160
  v_mfma_f32_32x32x16_bf16 v[72:87], v[156:159], a[232:235], v[72:87]
  ds_read_b128 v[152:155], v27 offset:8192
  buffer_load_dwordx4 v2, s[40:43], s6 offen offset:1024 sc1 lds
  v_sub_f32 v106, v106, v109
  v_mfma_f32_32x32x16_bf16 v[88:103], v[120:123], a[232:235], v[88:103]
  s_waitcnt vmcnt(13) lgkmcnt(4)
  ds_read_b128 v[156:159], v27 offset:9216
  v_cvt_pk_bf16_f32 v161, v106, v106
  v_mfma_f32_32x32x16_bf16 v[56:71], v[124:127], a[236:239], v[56:71]
  ds_read_b128 v[120:123], v27 offset:10240
  v_and_b32 v109, 0xffff0000, v161
  v_mfma_f32_32x32x16_bf16 v[72:87], v[128:131], a[236:239], v[72:87]
  ds_read_b128 v[124:127], v27 offset:11264
  v_sub_f32 v106, v106, v109
  v_mfma_f32_32x32x16_bf16 v[88:103], v[132:135], a[236:239], v[88:103]
  s_waitcnt vmcnt(12) lgkmcnt(4)
  ds_read_b128 v[128:131], v27 offset:12288
  buffer_load_dwordx4 v2, s[40:43], s6 offen offset:2048 sc1 lds
  v_cvt_pk_bf16_f32 v108, v106, v106
  v_mfma_f32_32x32x16_bf16 v[56:71], v[136:139], a[240:243], v[56:71]
  ds_read_b128 v[132:135], v27 offset:13312
  v_bfi_b32 v162, v110, v160, v108
  v_and_b32 v105, 256, v10
  v_mfma_f32_32x32x16_bf16 v[72:87], v[140:143], a[240:243], v[72:87]
  ds_read_b128 v[136:139], v27 offset:14336
  v_mad_u32_u24 v15, v105, 7, v11
  s_waitcnt vmcnt(9) lgkmcnt(4)
  v_lshlrev_b32 v40, 16, v48
  v_and_b32 v41, 0xffff0000, v48
  v_lshlrev_b32 v42, 16, v49
  v_and_b32 v43, 0xffff0000, v49
  v_mfma_f32_32x32x16_bf16 v[88:103], v[144:147], a[240:243], v[88:103]
  ds_read_b128 v[140:143], v27 offset:15360
  v_lshlrev_b32 v44, 16, v50
  v_and_b32 v45, 0xffff0000, v50
  v_lshlrev_b32 v46, 16, v51
  v_and_b32 v47, 0xffff0000, v51
  s_waitcnt vmcnt(8) lgkmcnt(4)
  v_lshlrev_b32 v48, 16, v52
  v_mfma_f32_32x32x16_bf16 v[56:71], v[148:151], a[244:247], v[56:71]
  ds_read_b128 v[144:147], v13 offset:0
  buffer_load_dwordx4 v2, s[40:43], s6 offen offset:3072 sc1 lds
  s_add_u32 m0, s55, 131072
  s_add_u32 s6, s60, 163840
  v_and_b32 v49, 0xffff0000, v52
  v_mfma_f32_32x32x16_bf16 v[72:87], v[152:155], a[244:247], v[72:87]
  ds_read_b128 v[148:151], v13 offset:512
  v_lshlrev_b32 v50, 16, v53
  v_and_b32 v51, 0xffff0000, v53
  v_lshlrev_b32 v52, 16, v54
  v_and_b32 v53, 0xffff0000, v54
  v_lshlrev_b32 v54, 16, v55
  v_mfma_f32_32x32x16_bf16 v[88:103], v[156:159], a[244:247], v[88:103]
  ds_read_b128 v[152:155], v13 offset:1024
  v_and_b32 v55, 0xffff0000, v55
  v_mfma_f32_32x32x16_bf16 v[56:71], v[120:123], a[248:251], v[56:71]
  ds_read_b128 v[156:159], v13 offset:1536
  v_mfma_f32_32x32x16_bf16 v[72:87], v[124:127], a[248:251], v[72:87]
  s_waitcnt lgkmcnt(4)
  s_barrier
  ds_read_b128 v[120:123], v188 offset:0
  v_add_u32 v27, 81920, v2
  v_mfma_f32_32x32x16_bf16 v[88:103], v[128:131], a[248:251], v[88:103]
  ds_read_b128 v[124:127], v188 offset:1024
  buffer_load_dwordx4 v2, s[40:43], s6 offen offset:0 sc1 lds
  v_mfma_f32_32x32x16_bf16 v[56:71], v[132:135], a[252:255], v[56:71]
  ds_read_b128 v[128:131], v188 offset:2048
  v_mfma_f32_32x32x16_bf16 v[72:87], v[136:139], a[252:255], v[72:87]
  ds_read_b128 v[132:135], v188 offset:3072
  v_mfma_f32_32x32x16_bf16 v[88:103], v[140:143], a[252:255], v[88:103]
  s_waitcnt lgkmcnt(4)
  ds_read_b128 v[136:139], v188 offset:4096
  v_mfma_f32_32x32x16_bf16 v[56:71], v[144:147], v[160:163], v[56:71]
  ds_read_b128 v[140:143], v188 offset:5120
  buffer_load_dwordx4 v2, s[40:43], s6 offen offset:1024 sc1 lds
  v_mfma_f32_32x32x16_bf16 v[72:87], v[148:151], v[160:163], v[72:87]
  ds_read_b128 v[144:147], v188 offset:6144
  v_mfma_f32_32x32x16_bf16 v[88:103], v[152:155], v[160:163], v[88:103]
  ds_read_b128 v[148:151], v188 offset:7168
  v_mfma_f32_32x32x16_bf16 v[104:119], v[156:159], v[160:163], 0
  s_waitcnt lgkmcnt(4)
  ds_read_b128 v[152:155], v188 offset:8192
  s_nop 2
  v_mul_f32 v164, v56, v56
  v_mul_f32 v165, v57, v57
  v_mul_f32 v166, v58, v58
  v_mul_f32 v167, v59, v59
  v_fma_f32 v164, v164, v190, v189
  v_fma_f32 v165, v165, v190, v189
  v_fma_f32 v166, v166, v190, v189
  v_fma_f32 v167, v167, v190, v189
  v_mul_f32 v164, v164, v56
  v_mul_f32 v165, v165, v57
  v_mfma_f32_32x32x16_bf16 v[104:119], v[120:123], v[192:195], v[104:119]
  ds_read_b128 v[156:159], v188 offset:9216
  buffer_load_dwordx4 v2, s[40:43], s6 offen offset:2048 sc1 lds
  v_mul_f32 v166, v166, v58
  v_mul_f32 v167, v167, v59
  v_exp_f32 v164, v164
  v_mul_f32 v64, v64, v56
  v_exp_f32 v165, v165
  v_mul_f32 v65, v65, v57
  v_mfma_f32_32x32x16_bf16 v[104:119], v[124:127], v[196:199], v[104:119]
  ds_read_b128 v[120:123], v188 offset:10240
  v_exp_f32 v166, v166
  v_mul_f32 v66, v66, v58
  v_exp_f32 v167, v167
  v_mul_f32 v67, v67, v59
  v_fma_f32 v164, v164, v191, v191
  v_fma_f32 v165, v165, v191, v191
  v_fma_f32 v166, v166, v191, v191
  v_fma_f32 v167, v167, v191, v191
  v_mfma_f32_32x32x16_bf16 v[104:119], v[128:131], v[200:203], v[104:119]
  ds_read_b128 v[124:127], v188 offset:11264
  v_rcp_f32 v164, v164
  v_rcp_f32 v165, v165
  v_mul_f32 v172, v72, v72
  v_mul_f32 v173, v73, v73
  v_mul_f32 v174, v74, v74
  v_mul_f32 v175, v75, v75
  v_fma_f32 v172, v172, v190, v189
  v_fma_f32 v173, v173, v190, v189
  v_mfma_f32_32x32x16_bf16 v[104:119], v[132:135], v[204:207], v[104:119]
  s_waitcnt lgkmcnt(2)
  ds_read_b128 v[128:131], v188 offset:12288
  buffer_load_dwordx4 v2, s[40:43], s6 offen offset:3072 sc1 lds
  s_add_u32 m0, s55, 49152
  s_add_u32 s6, s60, 180224
  v_rcp_f32 v166, v166
  v_fma_f32 v174, v174, v190, v189
  v_fma_f32 v175, v175, v190, v189
  v_mul_f32 v172, v172, v72
  v_mul_f32 v173, v173, v73
  v_mfma_f32_32x32x16_bf16 v[104:119], v[136:139], v[208:211], v[104:119]
  ds_read_b128 v[132:135], v188 offset:13312
  v_rcp_f32 v167, v167
  v_mul_f32 v174, v174, v74
  v_mul_f32 v175, v175, v75
  v_exp_f32 v172, v172
  v_mfma_f32_32x32x16_bf16 v[104:119], v[140:143], v[212:215], v[104:119]
  ds_read_b128 v[136:139], v188 offset:14336
  v_mul_f32 v64, v64, v164
  v_mul_f32 v80, v80, v72
  v_mul_f32 v65, v65, v165
  v_mul_f32 v66, v66, v166
  v_mul_f32 v67, v67, v167
  v_mfma_f32_32x32x16_bf16 v[104:119], v[144:147], v[216:219], v[104:119]
  ds_read_b128 v[140:143], v188 offset:15360
  buffer_load_dwordx4 v2, s[40:43], s6 offen offset:0 sc1 lds
  v_exp_f32 v173, v173
  v_cvt_pk_bf16_f32 v180, v64, v65
  v_mfma_f32_32x32x16_bf16 v[104:119], v[148:151], v[220:223], v[104:119]
  s_barrier
  ds_read_b128 v[144:147], v27 offset:0
  v_add_u32 v188, 98304, v2
  v_mul_f32 v81, v81, v73
  v_exp_f32 v174, v174
  v_mfma_f32_32x32x16_bf16 v[104:119], v[152:155], v[224:227], v[104:119]
  ds_read_b128 v[148:151], v27 offset:1024
  v_cvt_pk_bf16_f32 v181, v66, v67
  v_mul_f32 v168, v60, v60
  v_mul_f32 v82, v82, v74
  v_mul_f32 v169, v61, v61
  v_mul_f32 v170, v62, v62
  v_mfma_f32_32x32x16_bf16 v[104:119], v[156:159], v[228:231], v[104:119]
  s_waitcnt lgkmcnt(4)
  ds_read_b128 v[152:155], v27 offset:2048
  v_exp_f32 v175, v175
  v_mul_f32 v171, v63, v63
  v_fma_f32 v168, v168, v190, v189
  v_fma_f32 v169, v169, v190, v189
  v_mfma_f32_32x32x16_bf16 v[104:119], v[120:123], v[232:235], v[104:119]
  ds_read_b128 v[156:159], v27 offset:3072
  buffer_load_dwordx4 v2, s[40:43], s6 offen offset:1024 sc1 lds
  v_mul_f32 v83, v83, v75
  v_fma_f32 v172, v172, v191, v191
  v_fma_f32 v170, v170, v190, v189
  v_mfma_f32_32x32x16_bf16 v[104:119], v[124:127], v[236:239], v[104:119]
  ds_read_b128 v[120:123], v27 offset:4096
  v_fma_f32 v173, v173, v191, v191
  v_fma_f32 v174, v174, v191, v191
  v_fma_f32 v171, v171, v190, v189
  v_mul_f32 v168, v168, v60
  v_mul_f32 v169, v169, v61
  v_mfma_f32_32x32x16_bf16 v[104:119], v[128:131], v[240:243], v[104:119]
  ds_read_b128 v[124:127], v27 offset:5120
  v_fma_f32 v175, v175, v191, v191
  v_rcp_f32 v172, v172
  v_mul_f32 v170, v170, v62
  v_mul_f32 v171, v171, v63
  v_mfma_f32_32x32x16_bf16 v[104:119], v[132:135], v[244:247], v[104:119]
  s_waitcnt lgkmcnt(4)
  ds_read_b128 v[128:131], v27 offset:6144
  v_rcp_f32 v173, v173
  v_exp_f32 v168, v168
  v_mul_f32 v68, v68, v60
  v_mfma_f32_32x32x16_bf16 v[104:119], v[136:139], v[248:251], v[104:119]
  ds_read_b128 v[132:135], v27 offset:7168
  buffer_load_dwordx4 v2, s[40:43], s6 offen offset:2048 sc1 lds
  v_rcp_f32 v174, v174
  v_mfma_f32_32x32x16_bf16 v[104:119], v[140:143], v[252:255], v[104:119]
  ds_read_b128 v[136:139], v27 offset:8192
  v_rcp_f32 v175, v175
  v_exp_f32 v169, v169
  v_mul_f32 v69, v69, v61
  v_mfma_f32_32x32x16_bf16 v[104:119], v[144:147], a[192:195], v[104:119]
  ds_read_b128 v[140:143], v27 offset:9216
  v_mul_f32 v80, v80, v172
  v_exp_f32 v170, v170
  v_mul_f32 v70, v70, v62
  v_mul_f32 v81, v81, v173
  v_mfma_f32_32x32x16_bf16 v[104:119], v[148:151], a[196:199], v[104:119]
  s_waitcnt lgkmcnt(4)
  ds_read_b128 v[144:147], v27 offset:10240
  v_mul_f32 v82, v82, v174
  v_exp_f32 v171, v171
  v_mul_f32 v71, v71, v63
  v_fma_f32 v168, v168, v191, v191
  v_mfma_f32_32x32x16_bf16 v[104:119], v[152:155], a[200:203], v[104:119]
  ds_read_b128 v[148:151], v27 offset:11264
  buffer_load_dwordx4 v2, s[40:43], s6 offen offset:3072 sc1 lds
  s_add_u32 m0, s55, 16384
  s_add_u32 s6, s60, 196608
  v_mul_f32 v83, v83, v175
  v_cvt_pk_bf16_f32 v184, v80, v81
  v_mfma_f32_32x32x16_bf16 v[104:119], v[156:159], a[204:207], v[104:119]
  ds_read_b128 v[152:155], v27 offset:12288
  v_cvt_pk_bf16_f32 v185, v82, v83
  v_mul_f32 v176, v76, v76
  v_fma_f32 v169, v169, v191, v191
  v_fma_f32 v170, v170, v191, v191
  v_fma_f32 v171, v171, v191, v191
  v_mfma_f32_32x32x16_bf16 v[104:119], v[120:123], a[208:211], v[104:119]
  ds_read_b128 v[156:159], v27 offset:13312
  v_mul_f32 v177, v77, v77
  v_mul_f32 v178, v78, v78
  v_rcp_f32 v168, v168
  v_mul_f32 v179, v79, v79
  v_mfma_f32_32x32x16_bf16 v[104:119], v[124:127], a[212:215], v[104:119]
  s_waitcnt lgkmcnt(4)
  ds_read_b128 v[120:123], v27 offset:14336
  v_fma_f32 v176, v176, v190, v189
  v_rcp_f32 v169, v169
  v_rcp_f32 v170, v170
  v_mfma_f32_32x32x16_bf16 v[104:119], v[128:131], a[216:219], v[104:119]
  ds_read_b128 v[124:127], v27 offset:15360
  buffer_load_dwordx4 v2, s[40:43], s6 offen offset:0 sc1 lds
  v_fma_f32 v177, v177, v190, v189
  v_fma_f32 v178, v178, v190, v189
  v_fma_f32 v179, v179, v190, v189
  v_mfma_f32_32x32x16_bf16 v[104:119], v[132:135], a[220:223], v[104:119]
  ds_read_b128 v[128:131], v13 offset:2048
  v_mul_f32 v176, v176, v76
  v_rcp_f32 v171, v171
  v_mul_f32 v68, v68, v168
  v_mul_f32 v69, v69, v169
  v_mfma_f32_32x32x16_bf16 v[104:119], v[136:139], a[224:227], v[104:119]
  s_waitcnt vmcnt(14)
  s_barrier
  ds_read_b128 v[132:135], v188 offset:0
  v_add_u32 v27, 114688, v2
  v_mul_f32 v177, v177, v77
  v_mul_f32 v178, v178, v78
  v_mfma_f32_32x32x16_bf16 v[104:119], v[140:143], a[228:231], v[104:119]
  s_waitcnt lgkmcnt(4)
  ds_read_b128 v[136:139], v188 offset:1024
  v_mul_f32 v179, v179, v79
  v_exp_f32 v176, v176
  v_mul_f32 v70, v70, v170
  v_mul_f32 v71, v71, v171
  v_mfma_f32_32x32x16_bf16 v[104:119], v[144:147], a[232:235], v[104:119]
  ds_read_b128 v[140:143], v188 offset:2048
  buffer_load_dwordx4 v2, s[40:43], s6 offen offset:1024 sc1 lds
  v_mul_f32 v84, v84, v76
  v_cvt_pk_bf16_f32 v182, v68, v69
  v_cvt_pk_bf16_f32 v183, v70, v71
  v_mfma_f32_32x32x16_bf16 v[104:119], v[148:151], a[236:239], v[104:119]
  ds_read_b128 v[144:147], v188 offset:3072
  s_add_u32 s26, s86, 0
  buffer_store_dwordx4 v[180:183], v15, s[40:43], s26 offen sc1
  v_exp_f32 v177, v177
  v_mfma_f32_32x32x16_bf16 v[104:119], v[152:155], a[240:243], v[104:119]
  ds_read_b128 v[148:151], v188 offset:4096
  v_mul_f32 v85, v85, v77
  v_exp_f32 v178, v178
  v_mul_f32 v164, v88, v88
  v_mul_f32 v165, v89, v89
  v_mfma_f32_32x32x16_bf16 v[104:119], v[156:159], a[244:247], v[104:119]
  s_waitcnt lgkmcnt(4)
  ds_read_b128 v[152:155], v188 offset:5120
  v_mul_f32 v86, v86, v78
  v_mul_f32 v166, v90, v90
  v_mul_f32 v167, v91, v91
  v_fma_f32 v164, v164, v190, v189
  v_fma_f32 v165, v165, v190, v189
  v_mfma_f32_32x32x16_bf16 v[104:119], v[120:123], a[248:251], v[104:119]
  ds_read_b128 v[156:159], v188 offset:6144
  buffer_load_dwordx4 v2, s[40:43], s6 offen offset:2048 sc1 lds
  v_exp_f32 v179, v179
  v_fma_f32 v166, v166, v190, v189
  v_mfma_f32_32x32x16_bf16 v[104:119], v[124:127], a[252:255], v[104:119]
  ds_read_b128 v[120:123], v188 offset:7168
  v_mul_f32 v87, v87, v79
  v_fma_f32 v176, v176, v191, v191
  v_fma_f32 v167, v167, v190, v189
  v_mul_f32 v164, v164, v88
  v_mul_f32 v165, v165, v89
  v_mfma_f32_32x32x16_bf16 v[56:71], v[128:131], v[160:163], 0
  ds_read_b128 v[124:127], v188 offset:8192
  v_fma_f32 v177, v177, v191, v191
  v_fma_f32 v178, v178, v191, v191
  v_mul_f32 v166, v166, v90
  v_mul_f32 v167, v167, v91
  v_fma_f32 v179, v179, v191, v191
  v_mfma_f32_32x32x16_bf16 v[56:71], v[132:135], v[192:195], v[56:71]
  s_waitcnt lgkmcnt(4)
  ds_read_b128 v[128:131], v188 offset:9216
  v_rcp_f32 v176, v176
  v_exp_f32 v164, v164
  v_mul_f32 v96, v96, v88
  v_mfma_f32_32x32x16_bf16 v[56:71], v[136:139], v[196:199], v[56:71]
  ds_read_b128 v[132:135], v188 offset:10240
  buffer_load_dwordx4 v2, s[40:43], s6 offen offset:3072 sc1 lds
  s_add_u32 m0, s55, 32768
  s_add_u32 s6, s60, 212992
  v_rcp_f32 v177, v177
  v_mfma_f32_32x32x16_bf16 v[56:71], v[140:143], v[200:203], v[56:71]
  ds_read_b128 v[136:139], v188 offset:11264
  v_rcp_f32 v178, v178
  v_exp_f32 v165, v165
  v_mul_f32 v97, v97, v89
  v_mfma_f32_32x32x16_bf16 v[56:71], v[144:147], v[204:207], v[56:71]
  ds_read_b128 v[140:143], v188 offset:12288
  v_rcp_f32 v179, v179
  v_exp_f32 v166, v166
  v_mul_f32 v98, v98, v90
  v_mfma_f32_32x32x16_bf16 v[56:71], v[148:151], v[208:211], v[56:71]
  s_waitcnt lgkmcnt(4)
  ds_read_b128 v[144:147], v188 offset:13312
  v_mul_f32 v84, v84, v176
  v_exp_f32 v167, v167
  v_mul_f32 v99, v99, v91
  v_fma_f32 v164, v164, v191, v191
  v_mfma_f32_32x32x16_bf16 v[56:71], v[152:155], v[212:215], v[56:71]
  ds_read_b128 v[148:151], v188 offset:14336
  buffer_load_dwordx4 v2, s[40:43], s6 offen offset:0 sc1 lds
  v_mul_f32 v85, v85, v177
  v_mul_f32 v86, v86, v178
  v_fma_f32 v165, v165, v191, v191
  v_mfma_f32_32x32x16_bf16 v[56:71], v[156:159], v[216:219], v[56:71]
  ds_read_b128 v[152:155], v188 offset:15360
  v_mul_f32 v87, v87, v179
  v_cvt_pk_bf16_f32 v186, v84, v85
  v_fma_f32 v166, v166, v191, v191
  v_fma_f32 v167, v167, v191, v191
  v_cvt_pk_bf16_f32 v187, v86, v87
  v_mfma_f32_32x32x16_bf16 v[56:71], v[120:123], v[220:223], v[56:71]
  s_waitcnt vmcnt(14)
  s_barrier
  ds_read_b128 v[156:159], v27 offset:0
  v_add_u32 v188, 131072, v2
  v_rcp_f32 v164, v164
  v_mfma_f32_32x32x16_bf16 v[56:71], v[124:127], v[224:227], v[56:71]
  s_waitcnt lgkmcnt(4)
  ds_read_b128 v[120:123], v27 offset:1024
  s_add_u32 s26, s86, 4096
  buffer_store_dwordx4 v[184:187], v15, s[40:43], s26 offen sc1
  v_rcp_f32 v165, v165
  v_mfma_f32_32x32x16_bf16 v[56:71], v[128:131], v[228:231], v[56:71]
  ds_read_b128 v[124:127], v27 offset:2048
  buffer_load_dwordx4 v2, s[40:43], s6 offen offset:1024 sc1 lds
  v_mul_f32 v172, v104, v104
  v_mul_f32 v173, v105, v105
  v_mul_f32 v174, v106, v106
  v_mfma_f32_32x32x16_bf16 v[56:71], v[132:135], v[232:235], v[56:71]
  ds_read_b128 v[128:131], v27 offset:3072
  v_mul_f32 v175, v107, v107
  v_rcp_f32 v166, v166
  v_rcp_f32 v167, v167
  v_mfma_f32_32x32x16_bf16 v[56:71], v[136:139], v[236:239], v[56:71]
  ds_read_b128 v[132:135], v27 offset:4096
  v_fma_f32 v172, v172, v190, v189
  v_fma_f32 v173, v173, v190, v189
  v_mul_f32 v96, v96, v164
  v_mul_f32 v97, v97, v165
  v_mul_f32 v98, v98, v166
  v_mfma_f32_32x32x16_bf16 v[56:71], v[140:143], v[240:243], v[56:71]
  s_waitcnt lgkmcnt(4)
  ds_read_b128 v[136:139], v27 offset:5120
  v_fma_f32 v174, v174, v190, v189
  v_fma_f32 v175, v175, v190, v189
  v_mul_f32 v99, v99, v167
  v_cvt_pk_bf16_f32 v180, v96, v97
  v_cvt_pk_bf16_f32 v181, v98, v99
  v_mfma_f32_32x32x16_bf16 v[56:71], v[144:147], v[244:247], v[56:71]
  ds_read_b128 v[140:143], v27 offset:6144
  buffer_load_dwordx4 v2, s[40:43], s6 offen offset:2048 sc1 lds
  v_mul_f32 v172, v172, v104
  v_mul_f32 v173, v173, v105
  v_mul_f32 v168, v92, v92
  v_mfma_f32_32x32x16_bf16 v[56:71], v[148:151], v[248:251], v[56:71]
  ds_read_b128 v[144:147], v27 offset:7168
  v_mul_f32 v174, v174, v106
  v_mul_f32 v175, v175, v107
  v_mul_f32 v169, v93, v93
  v_mul_f32 v170, v94, v94
  v_mul_f32 v171, v95, v95
  v_mfma_f32_32x32x16_bf16 v[56:71], v[152:155], v[252:255], v[56:71]
  ds_read_b128 v[148:151], v27 offset:8192
  v_exp_f32 v172, v172
  v_fma_f32 v168, v168, v190, v189
  v_fma_f32 v169, v169, v190, v189
  v_fma_f32 v170, v170, v190, v189
  v_mfma_f32_32x32x16_bf16 v[56:71], v[156:159], a[192:195], v[56:71]
  s_waitcnt lgkmcnt(4)
  ds_read_b128 v[152:155], v27 offset:9216
  v_mul_f32 v112, v112, v104
  v_exp_f32 v173, v173
  v_fma_f32 v171, v171, v190, v189
  v_mul_f32 v168, v168, v92
  v_mfma_f32_32x32x16_bf16 v[56:71], v[120:123], a[196:199], v[56:71]
  ds_read_b128 v[156:159], v27 offset:10240
  buffer_load_dwordx4 v2, s[40:43], s6 offen offset:3072 sc1 lds
  s_add_u32 m0, s55, 0
  s_add_u32 s6, s57, 0
  v_mul_f32 v113, v113, v105
  v_mfma_f32_32x32x16_bf16 v[56:71], v[124:127], a[200:203], v[56:71]
  ds_read_b128 v[120:123], v27 offset:11264
  v_exp_f32 v174, v174
  v_mul_f32 v169, v169, v93
  v_mul_f32 v170, v170, v94
  v_mul_f32 v171, v171, v95
  v_mfma_f32_32x32x16_bf16 v[56:71], v[128:131], a[204:207], v[56:71]
  ds_read_b128 v[124:127], v27 offset:12288
  v_mul_f32 v114, v114, v106
  v_exp_f32 v175, v175
  v_exp_f32 v168, v168
  v_mfma_f32_32x32x16_bf16 v[56:71], v[132:135], a[208:211], v[56:71]
  s_waitcnt lgkmcnt(4)
  ds_read_b128 v[128:131], v27 offset:13312
  v_mul_f32 v115, v115, v107
  v_mul_f32 v100, v100, v92
  v_exp_f32 v169, v169
  v_mul_f32 v101, v101, v93
  v_mfma_f32_32x32x16_bf16 v[56:71], v[136:139], a[212:215], v[56:71]
  ds_read_b128 v[132:135], v27 offset:14336
  buffer_load_dwordx4 v2, s[40:43], s6 offen offset:0 sc1 lds
  v_fma_f32 v172, v172, v191, v191
  v_fma_f32 v173, v173, v191, v191
  v_fma_f32 v174, v174, v191, v191
  v_mfma_f32_32x32x16_bf16 v[56:71], v[140:143], a[216:219], v[56:71]
  ds_read_b128 v[136:139], v27 offset:15360
  v_fma_f32 v175, v175, v191, v191
  v_exp_f32 v170, v170
  v_mul_f32 v102, v102, v94
  v_mfma_f32_32x32x16_bf16 v[56:71], v[144:147], a[220:223], v[56:71]
  ds_read_b128 v[140:143], v13 offset:2560
  v_rcp_f32 v172, v172
  v_exp_f32 v171, v171
  v_mul_f32 v103, v103, v95
  v_mfma_f32_32x32x16_bf16 v[56:71], v[148:151], a[224:227], v[56:71]
  s_waitcnt lgkmcnt(4)
  s_waitcnt vmcnt(15)
  s_barrier
  ds_read_b128 v[144:147], v188 offset:0
  v_add_u32 v27, 49152, v2
  v_rcp_f32 v173, v173
  v_mfma_f32_32x32x16_bf16 v[56:71], v[152:155], a[228:231], v[56:71]
  ds_read_b128 v[148:151], v188 offset:1024
  buffer_load_dwordx4 v2, s[40:43], s6 offen offset:1024 sc1 lds
  v_rcp_f32 v174, v174
  v_fma_f32 v168, v168, v191, v191
  v_mfma_f32_32x32x16_bf16 v[56:71], v[156:159], a[232:235], v[56:71]
  ds_read_b128 v[152:155], v188 offset:2048
  v_rcp_f32 v175, v175
  v_fma_f32 v169, v169, v191, v191
  v_fma_f32 v170, v170, v191, v191
  v_fma_f32 v171, v171, v191, v191
  v_mfma_f32_32x32x16_bf16 v[56:71], v[120:123], a[236:239], v[56:71]
  ds_read_b128 v[156:159], v188 offset:3072
  v_mul_f32 v112, v112, v172
  v_mul_f32 v113, v113, v173
  v_rcp_f32 v168, v168
  v_mul_f32 v114, v114, v174
  v_mfma_f32_32x32x16_bf16 v[56:71], v[124:127], a[240:243], v[56:71]
  s_waitcnt lgkmcnt(4)
  ds_read_b128 v[120:123], v188 offset:4096
  v_mul_f32 v115, v115, v175
  v_rcp_f32 v169, v169
  v_rcp_f32 v170, v170
  v_mfma_f32_32x32x16_bf16 v[56:71], v[128:131], a[244:247], v[56:71]
  ds_read_b128 v[124:127], v188 offset:5120
  buffer_load_dwordx4 v2, s[40:43], s6 offen offset:2048 sc1 lds
  v_cvt_pk_bf16_f32 v184, v112, v113
  v_cvt_pk_bf16_f32 v185, v114, v115
  v_mul_f32 v176, v108, v108
  v_mfma_f32_32x32x16_bf16 v[56:71], v[132:135], a[248:251], v[56:71]
  ds_read_b128 v[128:131], v188 offset:6144
  v_mul_f32 v177, v109, v109
  v_rcp_f32 v171, v171
  v_mul_f32 v100, v100, v168
  v_mul_f32 v101, v101, v169
  v_mfma_f32_32x32x16_bf16 v[56:71], v[136:139], a[252:255], v[56:71]
  ds_read_b128 v[132:135], v188 offset:7168
  v_mul_f32 v178, v110, v110
  v_mul_f32 v179, v111, v111
  v_mul_f32 v102, v102, v170
  v_mul_f32 v103, v103, v171
  v_cvt_pk_bf16_f32 v182, v100, v101
  v_mfma_f32_32x32x16_bf16 v[72:87], v[140:143], v[160:163], 0
  s_waitcnt lgkmcnt(4)
  ds_read_b128 v[136:139], v188 offset:8192
  v_fma_f32 v176, v176, v190, v189
  v_fma_f32 v177, v177, v190, v189
  v_cvt_pk_bf16_f32 v183, v102, v103
  v_fma_f32 v178, v178, v190, v189
  v_fma_f32 v179, v179, v190, v189
  v_mfma_f32_32x32x16_bf16 v[72:87], v[144:147], v[192:195], v[72:87]
  ds_read_b128 v[140:143], v188 offset:9216
  buffer_load_dwordx4 v2, s[40:43], s6 offen offset:3072 sc1 lds
  s_add_u32 s26, s86, 8192
  buffer_store_dwordx4 v[180:183], v15, s[40:43], s26 offen sc1
  v_mfma_f32_32x32x16_bf16 v[72:87], v[148:151], v[196:199], v[72:87]
  ds_read_b128 v[144:147], v188 offset:10240
  v_mul_f32 v176, v176, v108
  v_mul_f32 v177, v177, v109
  v_mul_f32 v164, v56, v56
  v_mul_f32 v165, v57, v57
  v_mul_f32 v166, v58, v58
  v_mfma_f32_32x32x16_bf16 v[72:87], v[152:155], v[200:203], v[72:87]
  ds_read_b128 v[148:151], v188 offset:11264
  v_mul_f32 v178, v178, v110
  v_mul_f32 v179, v179, v111
  v_mul_f32 v167, v59, v59
  v_fma_f32 v164, v164, v190, v189
  v_fma_f32 v165, v165, v190, v189
  v_mfma_f32_32x32x16_bf16 v[72:87], v[156:159], v[204:207], v[72:87]
  s_waitcnt lgkmcnt(4)
  ds_read_b128 v[152:155], v188 offset:12288
  v_exp_f32 v176, v176
  v_fma_f32 v166, v166, v190, v189
  v_fma_f32 v167, v167, v190, v189
  v_mul_f32 v164, v164, v56
  v_mfma_f32_32x32x16_bf16 v[72:87], v[120:123], v[208:211], v[72:87]
  ds_read_b128 v[156:159], v188 offset:13312
  v_mov_b32 v7, L_p3_1+6144-L_pc
  v_add_u32 v7, s39, v7
  global_load_dword v6, v7, s[90:91]
  s_add_u32 m0, s55, 65536
  s_add_u32 s6, s57, 16384
  v_mul_f32 v116, v116, v108
  v_exp_f32 v177, v177
  v_mfma_f32_32x32x16_bf16 v[72:87], v[124:127], v[212:215], v[72:87]
  ds_read_b128 v[120:123], v188 offset:14336
  buffer_load_dwordx4 v2, s[40:43], s6 offen offset:0 sc1 lds
  v_mul_f32 v117, v117, v109
  v_mul_f32 v165, v165, v57
  v_mul_f32 v166, v166, v58
  v_mfma_f32_32x32x16_bf16 v[72:87], v[128:131], v[216:219], v[72:87]
  ds_read_b128 v[124:127], v188 offset:15360
  v_exp_f32 v178, v178
  v_mul_f32 v167, v167, v59
  v_exp_f32 v164, v164
  v_mfma_f32_32x32x16_bf16 v[72:87], v[132:135], v[220:223], v[72:87]
  s_waitcnt lgkmcnt(3)
  s_waitcnt vmcnt(17)
  s_barrier
  ds_read_b128 v[128:131], v27 offset:0
  v_add_u32 v188, 16384, v2
  v_mul_f32 v118, v118, v110
  v_exp_f32 v179, v179
  v_mfma_f32_32x32x16_bf16 v[72:87], v[136:139], v[224:227], v[72:87]
  ds_read_b128 v[132:135], v27 offset:1024
  v_mul_f32 v119, v119, v111
  v_mul_f32 v64, v64, v56
  v_exp_f32 v165, v165
  v_mul_f32 v65, v65, v57
  v_mfma_f32_32x32x16_bf16 v[72:87], v[140:143], v[228:231], v[72:87]
  ds_read_b128 v[136:139], v27 offset:2048
  buffer_load_dwordx4 v2, s[40:43], s6 offen offset:1024 sc1 lds
  v_fma_f32 v176, v176, v191, v191
  v_fma_f32 v177, v177, v191, v191
  v_fma_f32 v178, v178, v191, v191
  v_mfma_f32_32x32x16_bf16 v[72:87], v[144:147], v[232:235], v[72:87]
  ds_read_b128 v[140:143], v27 offset:3072
  v_fma_f32 v179, v179, v191, v191
  v_exp_f32 v166, v166
  v_mul_f32 v66, v66, v58
  v_mfma_f32_32x32x16_bf16 v[72:87], v[148:151], v[236:239], v[72:87]
  ds_read_b128 v[144:147], v27 offset:4096
  v_rcp_f32 v176, v176
  v_exp_f32 v167, v167
  v_mul_f32 v67, v67, v59
  v_mfma_f32_32x32x16_bf16 v[72:87], v[152:155], v[240:243], v[72:87]
  s_waitcnt lgkmcnt(4)
  ds_read_b128 v[148:151], v27 offset:5120
  v_rcp_f32 v177, v177
  v_fma_f32 v164, v164, v191, v191
  v_fma_f32 v165, v165, v191, v191
  v_fma_f32 v166, v166, v191, v191
  v_mfma_f32_32x32x16_bf16 v[72:87], v[156:159], v[244:247], v[72:87]
  ds_read_b128 v[152:155], v27 offset:6144
  buffer_load_dwordx4 v2, s[40:43], s6 offen offset:2048 sc1 lds
  v_rcp_f32 v178, v178
  v_fma_f32 v167, v167, v191, v191
  v_mfma_f32_32x32x16_bf16 v[72:87], v[120:123], v[248:251], v[72:87]
  ds_read_b128 v[156:159], v27 offset:7168
  v_rcp_f32 v179, v179
  v_rcp_f32 v164, v164
  v_mul_f32 v116, v116, v176
  v_mfma_f32_32x32x16_bf16 v[72:87], v[124:127], v[252:255], v[72:87]
  ds_read_b128 v[120:123], v27 offset:8192
  v_mul_f32 v117, v117, v177
  v_rcp_f32 v165, v165
  v_rcp_f32 v166, v166
  v_mfma_f32_32x32x16_bf16 v[72:87], v[128:131], a[192:195], v[72:87]
  s_waitcnt lgkmcnt(4)
  ds_read_b128 v[124:127], v27 offset:9216
  v_mul_f32 v118, v118, v178
  v_mul_f32 v119, v119, v179
  v_rcp_f32 v167, v167
  v_mul_f32 v64, v64, v164
  v_mfma_f32_32x32x16_bf16 v[72:87], v[132:135], a[196:199], v[72:87]
  ds_read_b128 v[128:131], v27 offset:10240
  buffer_load_dwordx4 v2, s[40:43], s6 offen offset:3072 sc1 lds
  s_add_u32 m0, s55, 81920
  s_add_u32 s6, s57, 32768
  v_cvt_pk_bf16_f32 v186, v116, v117
  v_cvt_pk_bf16_f32 v187, v118, v119
  v_mfma_f32_32x32x16_bf16 v[72:87], v[136:139], a[200:203], v[72:87]
  ds_read_b128 v[132:135], v27 offset:11264
  s_add_u32 s26, s86, 12288
  buffer_store_dwordx4 v[184:187], v15, s[40:43], s26 offen sc1
  v_mul_f32 v65, v65, v165
  v_mul_f32 v66, v66, v166
  v_mfma_f32_32x32x16_bf16 v[72:87], v[140:143], a[204:207], v[72:87]
  ds_read_b128 v[136:139], v27 offset:12288
  v_mul_f32 v67, v67, v167
  v_cvt_pk_bf16_f32 v180, v64, v65
  v_cvt_pk_bf16_f32 v181, v66, v67
  v_mul_f32 v168, v60, v60
  v_mul_f32 v169, v61, v61
  v_mfma_f32_32x32x16_bf16 v[72:87], v[144:147], a[208:211], v[72:87]
  s_waitcnt lgkmcnt(4)
  ds_read_b128 v[140:143], v27 offset:13312
  v_mul_f32 v170, v62, v62
  v_mul_f32 v171, v63, v63
  v_fma_f32 v168, v168, v190, v189
  v_fma_f32 v169, v169, v190, v189
  v_fma_f32 v170, v170, v190, v189
  v_mfma_f32_32x32x16_bf16 v[72:87], v[148:151], a[212:215], v[72:87]
  ds_read_b128 v[144:147], v27 offset:14336
  buffer_load_dwordx4 v2, s[40:43], s6 offen offset:0 sc1 lds
  v_fma_f32 v171, v171, v190, v189
  v_mul_f32 v168, v168, v60
  v_mul_f32 v169, v169, v61
  v_mfma_f32_32x32x16_bf16 v[72:87], v[152:155], a[216:219], v[72:87]
  ds_read_b128 v[148:151], v27 offset:15360
  v_mul_f32 v170, v170, v62
  v_mul_f32 v171, v171, v63
  v_exp_f32 v168, v168
  v_mul_f32 v68, v68, v60
  v_mfma_f32_32x32x16_bf16 v[72:87], v[156:159], a[220:223], v[72:87]
  ds_read_b128 v[152:155], v13 offset:3072
  v_exp_f32 v169, v169
  v_mul_f32 v69, v69, v61
  v_exp_f32 v170, v170
  v_mfma_f32_32x32x16_bf16 v[72:87], v[120:123], a[224:227], v[72:87]
  s_waitcnt lgkmcnt(4)
  s_waitcnt vmcnt(17)
  s_barrier
  ds_read_b128 v[156:159], v188 offset:0
  v_add_u32 v27, 32768, v2
  v_mul_f32 v70, v70, v62
  v_mfma_f32_32x32x16_bf16 v[72:87], v[124:127], a[228:231], v[72:87]
  ds_read_b128 v[120:123], v188 offset:1024
  buffer_load_dwordx4 v2, s[40:43], s6 offen offset:1024 sc1 lds
  v_exp_f32 v171, v171
  v_mul_f32 v71, v71, v63
  s_and_b32 s3, s51, 1
  s_lshl_b32 s3, s3, 2
  s_add_u32 s3, s3, s53
  s_mul_i32 s85, s3, 114688
  s_and_b32 s4, s52, 1
  s_mul_i32 s4, s4, 28672
  s_add_u32 s85, s85, s4
  s_add_u32 s85, s85, s54
  s_add_u32 s85, s85, 2621440
  v_mfma_f32_32x32x16_bf16 v[72:87], v[128:131], a[232:235], v[72:87]
  ds_read_b128 v[124:127], v188 offset:2048
  v_fma_f32 v168, v168, v191, v191
  v_fma_f32 v169, v169, v191, v191
  v_fma_f32 v170, v170, v191, v191
  v_fma_f32 v171, v171, v191, v191
  v_mfma_f32_32x32x16_bf16 v[72:87], v[132:135], a[236:239], v[72:87]
  ds_read_b128 v[128:131], v188 offset:3072
  v_rcp_f32 v168, v168
  v_rcp_f32 v169, v169
  v_mfma_f32_32x32x16_bf16 v[72:87], v[136:139], a[240:243], v[72:87]
  s_waitcnt lgkmcnt(3)
  ds_read_b128 v[132:135], v188 offset:4096
  buffer_load_dwordx4 v2, s[40:43], s6 offen offset:2048 sc1 lds
  v_rcp_f32 v170, v170
  v_mfma_f32_32x32x16_bf16 v[72:87], v[140:143], a[244:247], v[72:87]
  ds_read_b128 v[136:139], v188 offset:5120
  v_rcp_f32 v171, v171
  v_mul_f32 v68, v68, v168
  v_mul_f32 v69, v69, v169
  v_mul_f32 v70, v70, v170
  v_mfma_f32_32x32x16_bf16 v[72:87], v[144:147], a[248:251], v[72:87]
  ds_read_b128 v[140:143], v188 offset:6144
  v_mul_f32 v71, v71, v171
  v_cvt_pk_bf16_f32 v182, v68, v69
  v_cvt_pk_bf16_f32 v183, v70, v71
  v_mfma_f32_32x32x16_bf16 v[72:87], v[148:151], a[252:255], v[72:87]
  ds_read_b128 v[144:147], v188 offset:7168
  s_add_u32 s26, s86, 16384
  buffer_store_dwordx4 v[180:183], v15, s[40:43], s26 offen sc1
  v_mfma_f32_32x32x16_bf16 v[88:103], v[152:155], v[160:163], 0
  ds_read_b128 v[148:151], v188 offset:8192
  buffer_load_dwordx4 v2, s[40:43], s6 offen offset:3072 sc1 lds
  s_add_u32 m0, s55, 98304
  s_add_u32 s6, s57, 49152
  v_mfma_f32_32x32x16_bf16 v[88:103], v[156:159], v[192:195], v[88:103]
  s_waitcnt lgkmcnt(4)
  ds_read_b128 v[152:155], v188 offset:9216
  v_mfma_f32_32x32x16_bf16 v[88:103], v[120:123], v[196:199], v[88:103]
  ds_read_b128 v[156:159], v188 offset:10240
  v_mul_f32 v172, v72, v72
  v_mul_f32 v173, v73, v73
  v_mul_f32 v174, v74, v74
  v_mul_f32 v175, v75, v75
  v_fma_f32 v172, v172, v190, v189
  v_fma_f32 v173, v173, v190, v189
  v_fma_f32 v174, v174, v190, v189
  v_fma_f32 v175, v175, v190, v189
  v_mul_f32 v172, v172, v72
  v_mul_f32 v173, v173, v73
  v_mfma_f32_32x32x16_bf16 v[88:103], v[124:127], v[200:203], v[88:103]
  ds_read_b128 v[120:123], v188 offset:11264
  buffer_load_dwordx4 v2, s[40:43], s6 offen offset:0 sc1 lds
  v_mul_f32 v174, v174, v74
  v_mul_f32 v175, v175, v75
  v_exp_f32 v172, v172
  v_mul_f32 v80, v80, v72
  v_exp_f32 v173, v173
  v_mul_f32 v81, v81, v73
  v_mfma_f32_32x32x16_bf16 v[88:103], v[128:131], v[204:207], v[88:103]
  ds_read_b128 v[124:127], v188 offset:12288
  v_exp_f32 v174, v174
  v_mul_f32 v82, v82, v74
  v_exp_f32 v175, v175
  v_mul_f32 v83, v83, v75
  v_fma_f32 v172, v172, v191, v191
  v_fma_f32 v173, v173, v191, v191
  v_fma_f32 v174, v174, v191, v191
  v_fma_f32 v175, v175, v191, v191
  v_mfma_f32_32x32x16_bf16 v[88:103], v[132:135], v[208:211], v[88:103]
  s_waitcnt lgkmcnt(2)
  ds_read_b128 v[128:131], v188 offset:13312
  v_rcp_f32 v172, v172
  v_rcp_f32 v173, v173
  v_rcp_f32 v174, v174
  v_rcp_f32 v175, v175
  v_mul_f32 v80, v80, v172
  v_mfma_f32_32x32x16_bf16 v[88:103], v[136:139], v[212:215], v[88:103]
  ds_read_b128 v[132:135], v188 offset:14336
  buffer_load_dwordx4 v2, s[40:43], s6 offen offset:1024 sc1 lds
  v_mul_f32 v81, v81, v173
  v_mul_f32 v82, v82, v174
  v_mul_f32 v83, v83, v175
  v_mfma_f32_32x32x16_bf16 v[88:103], v[140:143], v[216:219], v[88:103]
  ds_read_b128 v[136:139], v188 offset:15360
  v_cvt_pk_bf16_f32 v184, v80, v81
  v_cvt_pk_bf16_f32 v185, v82, v83
  v_mul_f32 v176, v76, v76
  v_mul_f32 v177, v77, v77
  v_mul_f32 v178, v78, v78
  v_mfma_f32_32x32x16_bf16 v[88:103], v[144:147], v[220:223], v[88:103]
  s_waitcnt vmcnt(7)
  s_barrier
  ds_read_b128 v[140:143], v27 offset:0
  v_mul_f32 v179, v79, v79
  v_fma_f32 v176, v176, v190, v189
  v_fma_f32 v177, v177, v190, v189
  v_mfma_f32_32x32x16_bf16 v[88:103], v[148:151], v[224:227], v[88:103]
  ds_read_b128 v[144:147], v27 offset:1024
  s_add_u32 s38, s37, 10
  v_mov_b32 v26, s38
  buffer_store_dword v26, v9, s[40:43], s67 offen
  buffer_store_dword v26, v9, s[44:47], s67 offen offset:256 sc1
  v_mfma_f32_32x32x16_bf16 v[88:103], v[152:155], v[228:231], v[88:103]
  ds_read_b128 v[148:151], v27 offset:2048
  buffer_load_dwordx4 v2, s[40:43], s6 offen offset:2048 sc1 lds
  v_fma_f32 v178, v178, v190, v189
  v_fma_f32 v179, v179, v190, v189
  v_mul_f32 v176, v176, v76
  v_mfma_f32_32x32x16_bf16 v[88:103], v[156:159], v[232:235], v[88:103]
  s_waitcnt lgkmcnt(4)
  ds_read_b128 v[152:155], v27 offset:3072
  v_mul_f32 v177, v177, v77
  v_mul_f32 v178, v178, v78
  v_mul_f32 v179, v179, v79
  v_exp_f32 v176, v176
  v_mfma_f32_32x32x16_bf16 v[88:103], v[120:123], v[236:239], v[88:103]
  ds_read_b128 v[156:159], v27 offset:4096
  v_mul_f32 v84, v84, v76
  v_exp_f32 v177, v177
  v_mul_f32 v85, v85, v77
  v_mfma_f32_32x32x16_bf16 v[88:103], v[124:127], v[240:243], v[88:103]
  ds_read_b128 v[120:123], v27 offset:5120
  v_exp_f32 v178, v178
  v_mul_f32 v86, v86, v78
  v_exp_f32 v179, v179
  v_mfma_f32_32x32x16_bf16 v[88:103], v[128:131], v[244:247], v[88:103]
  ds_read_b128 v[124:127], v27 offset:6144
  buffer_load_dwordx4 v2, s[40:43], s6 offen offset:3072 sc1 lds
  s_add_u32 m0, s55, 114688
  s_add_u32 s6, s57, 65536
  v_mul_f32 v87, v87, v79
  v_mfma_f32_32x32x16_bf16 v[88:103], v[132:135], v[248:251], v[88:103]
  s_waitcnt lgkmcnt(4)
  ds_read_b128 v[128:131], v27 offset:7168
  v_fma_f32 v176, v176, v191, v191
  v_fma_f32 v177, v177, v191, v191
  v_fma_f32 v178, v178, v191, v191
  v_fma_f32 v179, v179, v191, v191
  v_mfma_f32_32x32x16_bf16 v[88:103], v[136:139], v[252:255], v[88:103]
  ds_read_b128 v[132:135], v27 offset:8192
  v_rcp_f32 v176, v176
  v_rcp_f32 v177, v177
  v_mfma_f32_32x32x16_bf16 v[88:103], v[140:143], a[192:195], v[88:103]
  ds_read_b128 v[136:139], v27 offset:9216
  v_rcp_f32 v178, v178
  v_rcp_f32 v179, v179
  v_mul_f32 v84, v84, v176
  v_mfma_f32_32x32x16_bf16 v[88:103], v[144:147], a[196:199], v[88:103]
  ds_read_b128 v[140:143], v27 offset:10240
  buffer_load_dwordx4 v2, s[40:43], s6 offen offset:0 sc1 lds
  v_mul_f32 v85, v85, v177
  v_mul_f32 v86, v86, v178
  v_mul_f32 v87, v87, v179
  v_mfma_f32_32x32x16_bf16 v[88:103], v[148:151], a[200:203], v[88:103]
  s_waitcnt lgkmcnt(4)
  ds_read_b128 v[144:147], v27 offset:11264
  buffer_load_dword v1, v17, s[40:43], s65 offen sc1
  v_cvt_pk_bf16_f32 v186, v84, v85
  v_cvt_pk_bf16_f32 v187, v86, v87
  v_mfma_f32_32x32x16_bf16 v[88:103], v[152:155], a[204:207], v[88:103]
  ds_read_b128 v[148:151], v27 offset:12288
  s_add_u32 s26, s86, 20480
  buffer_store_dwordx4 v[184:187], v15, s[40:43], s26 offen sc1
  v_mfma_f32_32x32x16_bf16 v[88:103], v[156:159], a[208:211], v[88:103]
  ds_read_b128 v[152:155], v27 offset:13312
  v_mfma_f32_32x32x16_bf16 v[88:103], v[120:123], a[212:215], v[88:103]
  ds_read_b128 v[156:159], v27 offset:14336
  buffer_load_dwordx4 v2, s[40:43], s6 offen offset:1024 sc1 lds
  v_mfma_f32_32x32x16_bf16 v[88:103], v[124:127], a[216:219], v[88:103]
  s_waitcnt lgkmcnt(4)
  ds_read_b128 v[120:123], v27 offset:15360
  v_mfma_f32_32x32x16_bf16 v[88:103], v[128:131], a[220:223], v[88:103]
  v_mfma_f32_32x32x16_bf16 v[88:103], v[132:135], a[224:227], v[88:103]
  v_mfma_f32_32x32x16_bf16 v[88:103], v[136:139], a[228:231], v[88:103]
  buffer_load_dwordx4 v2, s[40:43], s6 offen offset:2048 sc1 lds
  v_mfma_f32_32x32x16_bf16 v[88:103], v[140:143], a[232:235], v[88:103]
  s_waitcnt lgkmcnt(1)
  v_mfma_f32_32x32x16_bf16 v[88:103], v[144:147], a[236:239], v[88:103]
  v_mfma_f32_32x32x16_bf16 v[88:103], v[148:151], a[240:243], v[88:103]
  v_mfma_f32_32x32x16_bf16 v[88:103], v[152:155], a[244:247], v[88:103]
  buffer_load_dwordx4 v2, s[40:43], s6 offen offset:3072 sc1 lds
  v_mfma_f32_32x32x16_bf16 v[88:103], v[156:159], a[248:251], v[88:103]
  s_waitcnt lgkmcnt(0)
  v_mfma_f32_32x32x16_bf16 v[88:103], v[120:123], a[252:255], v[88:103]
L_p4_1:
  s_barrier
  v_add_u32 v172, 0, v5
  v_xor_b32 v173, 1024, v172
  v_add_u32 v174, 65536, v5
  v_xor_b32 v175, 1024, v174
  v_add_u32 v176, 131072, v5
  v_xor_b32 v177, 1024, v176
  ds_read_b128 v[120:123], v173 offset:0
  ds_read_b128 v[124:127], v172 offset:0
  ds_read_b128 v[128:131], v173 offset:2048
  ds_read_b128 v[132:135], v172 offset:2048
  ds_read_b128 v[136:139], v173 offset:4096
  ds_read_b128 v[140:143], v172 offset:4096
  ds_read_b128 v[144:147], v173 offset:6144
  ds_read_b128 v[148:151], v172 offset:6144
  s_and_b32 s3, s48, 31
  s_lshl_b32 s3, s3, 2
  s_add_u32 s3, s3, s53
  s_lshl_b32 s20, s3, 11
  s_add_u32 s20, s20, s54
  s_add_u32 s20, s20, 786432
  s_xor_b32 s21, s20, 8192
  s_lshl_b32 s98, s3, 2
  s_add_u32 s98, s98, s54
  s_xor_b32 s99, s98, 16
  v_pk_mul_f32 v[164:165], v[88:89], v[88:89] op_sel:[0,0] op_sel_hi:[1,1]
  v_pk_mul_f32 v[166:167], v[90:91], v[90:91] op_sel:[0,0] op_sel_hi:[1,1]
  s_add_u32 s27, s37, 10
  s_waitcnt vmcnt(4)
  v_subrev_u32 v1, s27, v1
  v_cmp_le_u32 vcc, 16, v1
  s_mov_b32 s7, 0
  s_cbranch_vccz L_ckd_31
L_ck_30:
  buffer_load_dword v1, v17, s[40:43], s65 offen sc1
  s_add_u32 s7, s7, 1
  s_waitcnt vmcnt(0)
  v_subrev_u32 v1, s27, v1
  v_cmp_le_u32 vcc, 16, v1
  s_and_b32 s5, s7, s22
  s_cbranch_vccz L_ckd_31
  s_cbranch_scc1 L_ck_30
  buffer_load_dword v12, v17, s[40:43], s65 offen offset:256 sc1
  s_waitcnt vmcnt(0)
  v_subrev_u32 v12, s27, v12
  v_cmp_le_u32 vcc, 16, v12
  s_cmp_lt_u32 s7, 0x40000
  s_cbranch_vccz L_ckd_31
  s_cbranch_scc1 L_ck_30
L_ckd_31:
  buffer_load_dwordx4 v[192:195], v11, s[40:43], s85 offen offset:0 sc1
  v_pk_mul_f32 v[168:169], v[92:93], v[92:93] op_sel:[0,0] op_sel_hi:[1,1]
  v_pk_mul_f32 v[170:171], v[94:95], v[94:95] op_sel:[0,0] op_sel_hi:[1,1]
  buffer_load_dwordx4 v[196:199], v11, s[40:43], s85 offen offset:512 sc1
  v_pk_fma_f32 v[164:165], v[164:165], v[190:191], v[188:189] op_sel:[0,0,1] op_sel_hi:[1,0,1]
  v_pk_fma_f32 v[166:167], v[166:167], v[190:191], v[188:189] op_sel:[0,0,1] op_sel_hi:[1,0,1]
  v_pk_fma_f32 v[168:169], v[168:169], v[190:191], v[188:189] op_sel:[0,0,1] op_sel_hi:[1,0,1]
  buffer_load_dwordx4 v[200:203], v11, s[40:43], s85 offen offset:1024 sc1
  v_pk_fma_f32 v[170:171], v[170:171], v[190:191], v[188:189] op_sel:[0,0,1] op_sel_hi:[1,0,1]
  v_pk_mul_f32 v[164:165], v[164:165], v[88:89] op_sel:[0,0] op_sel_hi:[1,1]
  v_pk_mul_f32 v[166:167], v[166:167], v[90:91] op_sel:[0,0] op_sel_hi:[1,1]
  buffer_load_dwordx4 v[204:207], v11, s[40:43], s85 offen offset:1536 sc1
  v_pk_mul_f32 v[168:169], v[168:169], v[92:93] op_sel:[0,0] op_sel_hi:[1,1]
  v_pk_mul_f32 v[170:171], v[170:171], v[94:95] op_sel:[0,0] op_sel_hi:[1,1]
  v_exp_f32 v164, v164
  buffer_load_dwordx4 v[208:211], v11, s[40:43], s85 offen offset:2048 sc1
  v_exp_f32 v165, v165
  v_pk_mul_f32 v[96:97], v[96:97], v[88:89] op_sel:[0,0] op_sel_hi:[1,1]
  v_exp_f32 v166, v166
  buffer_load_dwordx4 v[212:215], v11, s[40:43], s85 offen offset:2560 sc1
  v_exp_f32 v167, v167
  v_pk_mul_f32 v[98:99], v[98:99], v[90:91] op_sel:[0,0] op_sel_hi:[1,1]
  v_exp_f32 v168, v168
  buffer_load_dwordx4 v[216:219], v11, s[40:43], s85 offen offset:3072 sc1
  v_exp_f32 v169, v169
  v_pk_mul_f32 v[100:101], v[100:101], v[92:93] op_sel:[0,0] op_sel_hi:[1,1]
  v_exp_f32 v170, v170
  buffer_load_dwordx4 v[220:223], v11, s[40:43], s85 offen offset:3584 sc1
  v_exp_f32 v171, v171
  v_pk_mul_f32 v[102:103], v[102:103], v[94:95] op_sel:[0,0] op_sel_hi:[1,1]
  s_add_u32 s85, s85, 4096
  buffer_load_dwordx4 v[224:227], v11, s[40:43], s85 offen offset:0 sc1
  v_pk_fma_f32 v[164:165], v[164:165], v[190:191], v[190:191] op_sel:[0,1,1] op_sel_hi:[1,1,1]
  v_pk_fma_f32 v[166:167], v[166:167], v[190:191], v[190:191] op_sel:[0,1,1] op_sel_hi:[1,1,1]
  v_pk_fma_f32 v[168:169], v[168:169], v[190:191], v[190:191] op_sel:[0,1,1] op_sel_hi:[1,1,1]
  buffer_load_dwordx4 v[228:231], v11, s[40:43], s85 offen offset:512 sc1
  v_pk_fma_f32 v[170:171], v[170:171], v[190:191], v[190:191] op_sel:[0,1,1] op_sel_hi:[1,1,1]
  v_rcp_f32 v164, v164
  v_rcp_f32 v165, v165
  buffer_load_dwordx4 v[232:235], v11, s[40:43], s85 offen offset:1024 sc1
  v_rcp_f32 v166, v166
  v_rcp_f32 v167, v167
  v_rcp_f32 v168, v168
  buffer_load_dwordx4 v[236:239], v11, s[40:43], s85 offen offset:1536 sc1
  v_rcp_f32 v169, v169
  v_rcp_f32 v170, v170
  v_rcp_f32 v171, v171
  buffer_load_dwordx4 v[240:243], v11, s[40:43], s85 offen offset:2048 sc1
  v_pk_mul_f32 v[96:97], v[96:97], v[164:165] op_sel:[0,0] op_sel_hi:[1,1]
  v_pk_mul_f32 v[98:99], v[98:99], v[166:167] op_sel:[0,0] op_sel_hi:[1,1]
  v_pk_mul_f32 v[100:101], v[100:101], v[168:169] op_sel:[0,0] op_sel_hi:[1,1]
  buffer_load_dwordx4 v[244:247], v11, s[40:43], s85 offen offset:2560 sc1
  v_pk_mul_f32 v[102:103], v[102:103], v[170:171] op_sel:[0,0] op_sel_hi:[1,1]
  v_cvt_pk_bf16_f32 v180, v96, v97
  v_cvt_pk_bf16_f32 v181, v98, v99
  v_cvt_pk_bf16_f32 v182, v100, v101
  v_cvt_pk_bf16_f32 v183, v102, v103
  s_add_u32 s26, s86, 24576
  buffer_store_dwordx4 v[180:183], v15, s[40:43], s26 offen sc1
  s_lshl_b32 s82, s51, 17
  s_lshl_b32 s3, s53, 15
  s_add_u32 s82, s82, s3
  s_lshl_b32 s3, s52, 6
  s_add_u32 s82, s82, s3
  v_and_b32 v116, 124, v3
  v_lshrrev_b32 v117, 7, v3
  v_lshlrev_b32 v116, 8, v116
  v_lshl_add_u32 v116, v117, 5, v116
  s_waitcnt vmcnt(14) lgkmcnt(0)
  ds_read_b128 v[152:155], v173 offset:8192
  buffer_load_dwordx4 v[248:251], v11, s[40:43], s85 offen offset:3072 sc1
  s_add_u32 m0, s55, 131072
  s_add_u32 s6, s57, 81920
  buffer_load_dwordx4 v2, s[40:43], s6 offen offset:0 sc1 lds
  v_mfma_f32_32x32x16_bf16 v[72:87], v[120:123], v[192:195], 0
  ds_read_b128 v[156:159], v172 offset:8192
  v_mfma_f32_32x32x16_bf16 v[56:71], v[124:127], v[192:195], v[40:55]
  s_waitcnt vmcnt(15)
  ds_read_b128 v[120:123], v173 offset:10240
  buffer_load_dwordx4 v[252:255], v11, s[40:43], s85 offen offset:3584 sc1
  v_mfma_f32_32x32x16_bf16 v[72:87], v[128:131], v[196:199], v[72:87]
  ds_read_b128 v[124:127], v172 offset:10240
  v_mfma_f32_32x32x16_bf16 v[56:71], v[132:135], v[196:199], v[56:71]
  s_waitcnt vmcnt(15)
  ds_read_b128 v[128:131], v173 offset:12288
  s_add_u32 s85, s85, 4096
  buffer_load_dwordx4 a[192:195], v11, s[40:43], s85 offen offset:0 sc1
  buffer_load_dwordx4 v2, s[40:43], s6 offen offset:1024 sc1 lds
  v_mfma_f32_32x32x16_bf16 v[72:87], v[136:139], v[200:203], v[72:87]
  ds_read_b128 v[132:135], v172 offset:12288
  v_mfma_f32_32x32x16_bf16 v[56:71], v[140:143], v[200:203], v[56:71]
  s_waitcnt vmcnt(16) lgkmcnt(4)
  ds_read_b128 v[136:139], v173 offset:14336
  buffer_load_dwordx4 a[196:199], v11, s[40:43], s85 offen offset:512 sc1
  v_mfma_f32_32x32x16_bf16 v[72:87], v[144:147], v[204:207], v[72:87]
  ds_read_b128 v[140:143], v172 offset:14336
  v_mfma_f32_32x32x16_bf16 v[56:71], v[148:151], v[204:207], v[56:71]
  s_waitcnt vmcnt(16) lgkmcnt(4)
  ds_read_b128 v[144:147], v175 offset:0
  buffer_load_dwordx4 a[200:203], v11, s[40:43], s85 offen offset:1024 sc1
  buffer_load_dwordx4 v2, s[40:43], s6 offen offset:2048 sc1 lds
  v_mfma_f32_32x32x16_bf16 v[72:87], v[152:155], v[208:211], v[72:87]
  ds_read_b128 v[148:151], v174 offset:0
  v_mfma_f32_32x32x16_bf16 v[56:71], v[156:159], v[208:211], v[56:71]
  s_waitcnt vmcnt(17) lgkmcnt(4)
  ds_read_b128 v[152:155], v175 offset:2048
  buffer_load_dwordx4 a[204:207], v11, s[40:43], s85 offen offset:1536 sc1
  v_mfma_f32_32x32x16_bf16 v[72:87], v[120:123], v[212:215], v[72:87]
  ds_read_b128 v[156:159], v174 offset:2048
  v_mfma_f32_32x32x16_bf16 v[56:71], v[124:127], v[212:215], v[56:71]
  s_waitcnt vmcnt(17) lgkmcnt(4)
  s_waitcnt vmcnt(9)
  s_barrier
  s_add_u32 s38, s37, 11
  v_mov_b32 v26, s38
  buffer_store_dword v26, v9, s[40:43], s67 offen
  buffer_store_dword v26, v9, s[44:47], s67 offen offset:256 sc1
  ds_read_b128 v[120:123], v175 offset:4096
  v_mfma_f32_32x32x16_bf16 v[72:87], v[128:131], v[216:219], v[72:87]
  ds_read_b128 v[124:127], v174 offset:4096
  buffer_load_dwordx4 a[208:211], v11, s[40:43], s85 offen offset:2048 sc1
  buffer_load_dwordx4 v2, s[40:43], s6 offen offset:3072 sc1 lds
  s_add_u32 m0, s55, 49152
  v_mfma_f32_32x32x16_bf16 v[56:71], v[132:135], v[216:219], v[56:71]
  ds_read_b128 v[128:131], v175 offset:6144
  s_add_u32 s6, s57, 98304
  v_mfma_f32_32x32x16_bf16 v[72:87], v[136:139], v[220:223], v[72:87]
  ds_read_b128 v[132:135], v174 offset:6144
  buffer_load_dwordx4 a[212:215], v11, s[40:43], s85 offen offset:2560 sc1
  v_mfma_f32_32x32x16_bf16 v[56:71], v[140:143], v[220:223], v[56:71]
  s_waitcnt lgkmcnt(4)
  ds_read_b128 v[136:139], v175 offset:8192
  v_mfma_f32_32x32x16_bf16 v[72:87], v[144:147], v[224:227], v[72:87]
  ds_read_b128 v[140:143], v174 offset:8192
  buffer_load_dwordx4 a[216:219], v11, s[40:43], s85 offen offset:3072 sc1
  buffer_load_dwordx4 v2, s[40:43], s6 offen offset:0 sc1 lds
  v_mfma_f32_32x32x16_bf16 v[56:71], v[148:151], v[224:227], v[56:71]
  ds_read_b128 v[144:147], v175 offset:10240
  v_mfma_f32_32x32x16_bf16 v[72:87], v[152:155], v[228:231], v[72:87]
  ds_read_b128 v[148:151], v174 offset:10240
  buffer_load_dwordx4 a[220:223], v11, s[40:43], s85 offen offset:3584 sc1
  v_mfma_f32_32x32x16_bf16 v[56:71], v[156:159], v[228:231], v[56:71]
  s_waitcnt lgkmcnt(4)
  ds_read_b128 v[152:155], v175 offset:12288
  v_mfma_f32_32x32x16_bf16 v[72:87], v[120:123], v[232:235], v[72:87]
  ds_read_b128 v[156:159], v174 offset:12288
  s_add_u32 s85, s85, 4096
  buffer_load_dwordx4 a[224:227], v11, s[40:43], s85 offen offset:0 sc1
  buffer_load_dwordx4 v2, s[40:43], s6 offen offset:1024 sc1 lds
  v_mfma_f32_32x32x16_bf16 v[56:71], v[124:127], v[232:235], v[56:71]
  buffer_load_dword v1, v17, s[40:43], s65 offen sc1
  ds_read_b128 v[120:123], v175 offset:14336
  v_mfma_f32_32x32x16_bf16 v[72:87], v[128:131], v[236:239], v[72:87]
  ds_read_b128 v[124:127], v174 offset:14336
  buffer_load_dwordx4 a[228:231], v11, s[40:43], s85 offen offset:512 sc1
  v_mfma_f32_32x32x16_bf16 v[56:71], v[132:135], v[236:239], v[56:71]
  s_waitcnt lgkmcnt(4)
  ds_read_b128 v[128:131], v175 offset:16384
  v_mfma_f32_32x32x16_bf16 v[72:87], v[136:139], v[240:243], v[72:87]
  ds_read_b128 v[132:135], v174 offset:16384
  buffer_load_dwordx4 a[232:235], v11, s[40:43], s85 offen offset:1024 sc1
  buffer_load_dwordx4 v2, s[40:43], s6 offen offset:2048 sc1 lds
  v_mfma_f32_32x32x16_bf16 v[56:71], v[140:143], v[240:243], v[56:71]
  ds_read_b128 v[136:139], v175 offset:18432
  v_mfma_f32_32x32x16_bf16 v[72:87], v[144:147], v[244:247], v[72:87]
  ds_read_b128 v[140:143], v174 offset:18432
  buffer_load_dwordx4 a[236:239], v11, s[40:43], s85 offen offset:1536 sc1
  v_mfma_f32_32x32x16_bf16 v[56:71], v[148:151], v[244:247], v[56:71]
  s_waitcnt vmcnt(23) lgkmcnt(4)
  ds_read_b128 v[144:147], v175 offset:20480
  v_mfma_f32_32x32x16_bf16 v[72:87], v[152:155], v[248:251], v[72:87]
  ds_read_b128 v[148:151], v174 offset:20480
  buffer_load_dwordx4 a[240:243], v11, s[40:43], s85 offen offset:2048 sc1
  buffer_load_dwordx4 v2, s[40:43], s6 offen offset:3072 sc1 lds
  v_mfma_f32_32x32x16_bf16 v[56:71], v[156:159], v[248:251], v[56:71]
  s_waitcnt vmcnt(23) lgkmcnt(4)
  ds_read_b128 v[152:155], v175 offset:22528
  v_mfma_f32_32x32x16_bf16 v[72:87], v[120:123], v[252:255], v[72:87]
  ds_read_b128 v[156:159], v174 offset:22528
  buffer_load_dwordx4 a[244:247], v11, s[40:43], s85 offen offset:2560 sc1
  v_mfma_f32_32x32x16_bf16 v[56:71], v[124:127], v[252:255], v[56:71]
  s_waitcnt vmcnt(23) lgkmcnt(4)
  ds_read_b128 v[120:123], v175 offset:24576
  v_mfma_f32_32x32x16_bf16 v[72:87], v[128:131], a[192:195], v[72:87]
  ds_read_b128 v[124:127], v174 offset:24576
  buffer_load_dwordx4 a[248:251], v11, s[40:43], s85 offen offset:3072 sc1
  v_mfma_f32_32x32x16_bf16 v[56:71], v[132:135], a[192:195], v[56:71]
  s_waitcnt vmcnt(22) lgkmcnt(4)
  ds_read_b128 v[128:131], v175 offset:26624
  v_mfma_f32_32x32x16_bf16 v[72:87], v[136:139], a[196:199], v[72:87]
  ds_read_b128 v[132:135], v174 offset:26624
  buffer_load_dwordx4 a[252:255], v11, s[40:43], s85 offen offset:3584 sc1
  v_mfma_f32_32x32x16_bf16 v[56:71], v[140:143], a[196:199], v[56:71]
  s_waitcnt vmcnt(22) lgkmcnt(4)
  ds_read_b128 v[136:139], v175 offset:28672
  v_mfma_f32_32x32x16_bf16 v[72:87], v[144:147], a[200:203], v[72:87]
  ds_read_b128 v[140:143], v174 offset:28672
  s_add_u32 s27, s37, 11
  s_waitcnt vmcnt(9) lgkmcnt(4)
  v_subrev_u32 v1, s27, v1
  v_cmp_le_u32 vcc, 16, v1
  s_mov_b32 s7, 0
  s_cbranch_vccz L_ckd_33
L_ck_32:
  buffer_load_dword v1, v17, s[40:43], s65 offen sc1
  s_add_u32 s7, s7, 1
  s_waitcnt vmcnt(0)
  v_subrev_u32 v1, s27, v1
  v_cmp_le_u32 vcc, 16, v1
  s_and_b32 s5, s7, s22
  s_cbranch_vccz L_ckd_33
  s_cbranch_scc1 L_ck_32
  buffer_load_dword v12, v17, s[40:43], s65 offen offset:256 sc1
  s_waitcnt vmcnt(0)
  v_subrev_u32 v12, s27, v12
  v_cmp_le_u32 vcc, 16, v12
  s_cmp_lt_u32 s7, 0x40000
  s_cbranch_vccz L_ckd_33
  s_cbranch_scc1 L_ck_32
L_ckd_33:
  s_add_u32 s85, s85, 4096
  buffer_load_dwordx4 v[192:195], v11, s[40:43], s85 offen offset:0 sc1
  v_mfma_f32_32x32x16_bf16 v[56:71], v[148:151], a[200:203], v[56:71]
  ds_read_b128 v[144:147], v175 offset:30720
  v_mfma_f32_32x32x16_bf16 v[72:87], v[152:155], a[204:207], v[72:87]
  ds_read_b128 v[148:151], v174 offset:30720
  buffer_load_dwordx4 v[196:199], v11, s[40:43], s85 offen offset:512 sc1
  v_mfma_f32_32x32x16_bf16 v[56:71], v[156:159], a[204:207], v[56:71]
  ds_read_b128 v[152:155], v175 offset:32768
  v_mfma_f32_32x32x16_bf16 v[72:87], v[120:123], a[208:211], v[72:87]
  ds_read_b128 v[156:159], v174 offset:32768
  buffer_load_dwordx4 v[200:203], v11, s[40:43], s85 offen offset:1024 sc1
  buffer_load_dword v6, v16, s[40:43], s20 offen sc1
  v_mfma_f32_32x32x16_bf16 v[56:71], v[124:127], a[208:211], v[56:71]
  s_waitcnt lgkmcnt(4)
  ds_read_b128 v[120:123], v175 offset:34816
  v_mfma_f32_32x32x16_bf16 v[72:87], v[128:131], a[212:215], v[72:87]
  ds_read_b128 v[124:127], v174 offset:34816
  buffer_load_dwordx4 v[204:207], v11, s[40:43], s85 offen offset:1536 sc1
  v_mfma_f32_32x32x16_bf16 v[56:71], v[132:135], a[212:215], v[56:71]
  ds_read_b128 v[128:131], v175 offset:36864
  v_mfma_f32_32x32x16_bf16 v[72:87], v[136:139], a[216:219], v[72:87]
  ds_read_b128 v[132:135], v174 offset:36864
  buffer_load_dwordx4 v[208:211], v11, s[40:43], s85 offen offset:2048 sc1
  v_mfma_f32_32x32x16_bf16 v[56:71], v[140:143], a[216:219], v[56:71]
  s_waitcnt lgkmcnt(4)
  ds_read_b128 v[136:139], v175 offset:38912
  v_mfma_f32_32x32x16_bf16 v[72:87], v[144:147], a[220:223], v[72:87]
  ds_read_b128 v[140:143], v174 offset:38912
  buffer_load_dwordx4 v[212:215], v11, s[40:43], s85 offen offset:2560 sc1
  v_mfma_f32_32x32x16_bf16 v[56:71], v[148:151], a[220:223], v[56:71]
  ds_read_b128 v[144:147], v175 offset:40960
  v_mfma_f32_32x32x16_bf16 v[72:87], v[152:155], a[224:227], v[72:87]
  ds_read_b128 v[148:151], v174 offset:40960
  buffer_load_dwordx4 v[216:219], v11, s[40:43], s85 offen offset:3072 sc1
  v_mfma_f32_32x32x16_bf16 v[56:71], v[156:159], a[224:227], v[56:71]
  s_waitcnt vmcnt(16) lgkmcnt(4)
  ds_read_b128 v[152:155], v175 offset:43008
  v_mfma_f32_32x32x16_bf16 v[72:87], v[120:123], a[228:231], v[72:87]
  ds_read_b128 v[156:159], v174 offset:43008
  buffer_load_dwordx4 v[220:223], v11, s[40:43], s85 offen offset:3584 sc1
  v_mfma_f32_32x32x16_bf16 v[56:71], v[124:127], a[228:231], v[56:71]
  s_waitcnt vmcnt(16) lgkmcnt(4)
  ds_read_b128 v[120:123], v175 offset:45056
  v_mfma_f32_32x32x16_bf16 v[72:87], v[128:131], a[232:235], v[72:87]
  ds_read_b128 v[124:127], v174 offset:45056
  s_add_u32 s85, s85, 4096
  buffer_load_dwordx4 v[224:227], v11, s[40:43], s85 offen offset:0 sc1
  v_mfma_f32_32x32x16_bf16 v[56:71], v[132:135], a[232:235], v[56:71]
  s_waitcnt vmcnt(15) lgkmcnt(4)
  ds_read_b128 v[128:131], v175 offset:47104
  v_mfma_f32_32x32x16_bf16 v[72:87], v[136:139], a[236:239], v[72:87]
  ds_read_b128 v[132:135], v174 offset:47104
  buffer_load_dwordx4 v[228:231], v11, s[40:43], s85 offen offset:512 sc1
  v_mfma_f32_32x32x16_bf16 v[56:71], v[140:143], a[236:239], v[56:71]
  s_waitcnt vmcnt(15) lgkmcnt(4)
  ds_read_b128 v[136:139], v175 offset:49152
  v_mfma_f32_32x32x16_bf16 v[72:87], v[144:147], a[240:243], v[72:87]
  ds_read_b128 v[140:143], v174 offset:49152
  buffer_load_dwordx4 v[232:235], v11, s[40:43], s85 offen offset:1024 sc1
  v_mfma_f32_32x32x16_bf16 v[56:71], v[148:151], a[240:243], v[56:71]
  s_waitcnt vmcnt(14) lgkmcnt(4)
  ds_read_b128 v[144:147], v175 offset:51200
  v_mfma_f32_32x32x16_bf16 v[72:87], v[152:155], a[244:247], v[72:87]
  ds_read_b128 v[148:151], v174 offset:51200
  buffer_load_dwordx4 v[236:239], v11, s[40:43], s85 offen offset:1536 sc1
  v_mfma_f32_32x32x16_bf16 v[56:71], v[156:159], a[244:247], v[56:71]
  s_waitcnt vmcnt(14) lgkmcnt(4)
  ds_read_b128 v[152:155], v175 offset:53248
  v_mfma_f32_32x32x16_bf16 v[72:87], v[120:123], a[248:251], v[72:87]
  ds_read_b128 v[156:159], v174 offset:53248
  buffer_load_dwordx4 v[240:243], v11, s[40:43], s85 offen offset:2048 sc1
  v_mfma_f32_32x32x16_bf16 v[56:71], v[124:127], a[248:251], v[56:71]
  s_waitcnt vmcnt(14) lgkmcnt(4)
  ds_read_b128 v[120:123], v175 offset:55296
  v_mfma_f32_32x32x16_bf16 v[72:87], v[128:131], a[252:255], v[72:87]
  ds_read_b128 v[124:127], v174 offset:55296
  buffer_load_dwordx4 v[244:247], v11, s[40:43], s85 offen offset:2560 sc1
  v_mfma_f32_32x32x16_bf16 v[56:71], v[132:135], a[252:255], v[56:71]
  s_waitcnt vmcnt(14) lgkmcnt(4)
  ds_read_b128 v[128:131], v175 offset:57344
  v_mfma_f32_32x32x16_bf16 v[72:87], v[136:139], v[192:195], v[72:87]
  ds_read_b128 v[132:135], v174 offset:57344
  buffer_load_dwordx4 v[248:251], v11, s[40:43], s85 offen offset:3072 sc1
  v_mfma_f32_32x32x16_bf16 v[56:71], v[140:143], v[192:195], v[56:71]
  s_waitcnt vmcnt(14) lgkmcnt(4)
  ds_read_b128 v[136:139], v175 offset:59392
  v_mfma_f32_32x32x16_bf16 v[72:87], v[144:147], v[196:199], v[72:87]
  ds_read_b128 v[140:143], v174 offset:59392
  buffer_load_dwordx4 v[252:255], v11, s[40:43], s85 offen offset:3584 sc1
  v_mfma_f32_32x32x16_bf16 v[56:71], v[148:151], v[196:199], v[56:71]
  s_waitcnt vmcnt(14) lgkmcnt(4)
  ds_read_b128 v[144:147], v175 offset:61440
  v_mfma_f32_32x32x16_bf16 v[72:87], v[152:155], v[200:203], v[72:87]
  ds_read_b128 v[148:151], v174 offset:61440
  s_add_u32 s85, s85, 4096
  buffer_load_dwordx4 a[192:195], v11, s[40:43], s85 offen offset:0 sc1
  v_mfma_f32_32x32x16_bf16 v[56:71], v[156:159], v[200:203], v[56:71]
  s_waitcnt vmcnt(13) lgkmcnt(4)
  ds_read_b128 v[152:155], v175 offset:63488
  v_mfma_f32_32x32x16_bf16 v[72:87], v[120:123], v[204:207], v[72:87]
  ds_read_b128 v[156:159], v174 offset:63488
  buffer_load_dwordx4 a[196:199], v11, s[40:43], s85 offen offset:512 sc1
  v_mfma_f32_32x32x16_bf16 v[56:71], v[124:127], v[204:207], v[56:71]
  s_waitcnt vmcnt(13) lgkmcnt(4)
  s_barrier
  ds_read_b128 v[120:123], v177 offset:0
  v_mfma_f32_32x32x16_bf16 v[72:87], v[128:131], v[208:211], v[72:87]
  ds_read_b128 v[124:127], v176 offset:0
  buffer_load_dwordx4 a[200:203], v11, s[40:43], s85 offen offset:1024 sc1
  v_mfma_f32_32x32x16_bf16 v[56:71], v[132:135], v[208:211], v[56:71]
  s_waitcnt vmcnt(13) lgkmcnt(4)
  ds_read_b128 v[128:131], v177 offset:2048
  v_mfma_f32_32x32x16_bf16 v[72:87], v[136:139], v[212:215], v[72:87]
  ds_read_b128 v[132:135], v176 offset:2048
  buffer_load_dwordx4 a[204:207], v11, s[40:43], s85 offen offset:1536 sc1
  v_mfma_f32_32x32x16_bf16 v[56:71], v[140:143], v[212:215], v[56:71]
  s_waitcnt vmcnt(13) lgkmcnt(4)
  ds_read_b128 v[136:139], v177 offset:4096
  v_mfma_f32_32x32x16_bf16 v[72:87], v[144:147], v[216:219], v[72:87]
  ds_read_b128 v[140:143], v176 offset:4096
  buffer_load_dwordx4 a[208:211], v11, s[40:43], s85 offen offset:2048 sc1
  v_mfma_f32_32x32x16_bf16 v[56:71], v[148:151], v[216:219], v[56:71]
  s_waitcnt vmcnt(13) lgkmcnt(4)
  ds_read_b128 v[144:147], v177 offset:6144
  v_mfma_f32_32x32x16_bf16 v[72:87], v[152:155], v[220:223], v[72:87]
  ds_read_b128 v[148:151], v176 offset:6144
  buffer_load_dwordx4 a[212:215], v11, s[40:43], s85 offen offset:2560 sc1
  v_mfma_f32_32x32x16_bf16 v[56:71], v[156:159], v[220:223], v[56:71]
  s_waitcnt vmcnt(13) lgkmcnt(4)
  ds_read_b128 v[152:155], v177 offset:8192
  v_mfma_f32_32x32x16_bf16 v[72:87], v[120:123], v[224:227], v[72:87]
  ds_read_b128 v[156:159], v177 offset:10240
  buffer_load_dwordx4 a[216:219], v11, s[40:43], s85 offen offset:3072 sc1
  v_mfma_f32_32x32x16_bf16 v[56:71], v[124:127], v[224:227], v[56:71]
  s_waitcnt vmcnt(13) lgkmcnt(4)
  ds_read_b128 v[120:123], v177 offset:12288
  v_mfma_f32_32x32x16_bf16 v[72:87], v[128:131], v[228:231], v[72:87]
  ds_read_b128 v[124:127], v177 offset:14336
  buffer_load_dwordx4 a[220:223], v11, s[40:43], s85 offen offset:3584 sc1
  v_mfma_f32_32x32x16_bf16 v[56:71], v[132:135], v[228:231], v[56:71]
  s_waitcnt vmcnt(13) lgkmcnt(4)
  ds_read_b128 v[128:131], v173 offset:49152
  v_mfma_f32_32x32x16_bf16 v[72:87], v[136:139], v[232:235], v[72:87]
  ds_read_b128 v[132:135], v173 offset:51200
  v_mfma_f32_32x32x16_bf16 v[56:71], v[140:143], v[232:235], v[56:71]
  s_waitcnt vmcnt(12) lgkmcnt(4)
  ds_read_b128 v[136:139], v173 offset:53248
  v_mfma_f32_32x32x16_bf16 v[72:87], v[144:147], v[236:239], v[72:87]
  ds_read_b128 v[140:143], v173 offset:55296
  v_mfma_f32_32x32x16_bf16 v[56:71], v[148:151], v[236:239], v[56:71]
  s_waitcnt vmcnt(11) lgkmcnt(4)
  ds_read_b128 v[144:147], v173 offset:57344
  v_mfma_f32_32x32x16_bf16 v[72:87], v[152:155], v[240:243], v[72:87]
  s_waitcnt vmcnt(10) lgkmcnt(4)
  ds_read_b128 v[148:151], v173 offset:59392
  v_mfma_f32_32x32x16_bf16 v[72:87], v[156:159], v[244:247], v[72:87]
  s_waitcnt vmcnt(9) lgkmcnt(4)
  ds_read_b128 v[152:155], v173 offset:61440
  v_mfma_f32_32x32x16_bf16 v[72:87], v[120:123], v[248:251], v[72:87]
  s_waitcnt vmcnt(8) lgkmcnt(4)
  ds_read_b128 v[156:159], v173 offset:63488
  v_mfma_f32_32x32x16_bf16 v[72:87], v[124:127], v[252:255], v[72:87]
  s_waitcnt vmcnt(7) lgkmcnt(4)
  ds_read_b128 v[120:123], v176 offset:8192
  v_mfma_f32_32x32x16_bf16 v[72:87], v[128:131], a[192:195], v[72:87]
  s_waitcnt vmcnt(6) lgkmcnt(4)
  ds_read_b128 v[124:127], v176 offset:10240
  v_mfma_f32_32x32x16_bf16 v[72:87], v[132:135], a[196:199], v[72:87]
  s_waitcnt vmcnt(5) lgkmcnt(4)
  ds_read_b128 v[128:131], v176 offset:12288
  v_mfma_f32_32x32x16_bf16 v[72:87], v[136:139], a[200:203], v[72:87]
  s_waitcnt vmcnt(4) lgkmcnt(4)
  ds_read_b128 v[132:135], v176 offset:14336
  v_mfma_f32_32x32x16_bf16 v[72:87], v[140:143], a[204:207], v[72:87]
  s_waitcnt vmcnt(3) lgkmcnt(4)
  ds_read_b128 v[136:139], v172 offset:49152
  v_mfma_f32_32x32x16_bf16 v[72:87], v[144:147], a[208:211], v[72:87]
  s_waitcnt vmcnt(2) lgkmcnt(4)
  ds_read_b128 v[140:143], v172 offset:51200
  v_mfma_f32_32x32x16_bf16 v[72:87], v[148:151], a[212:215], v[72:87]
  s_waitcnt vmcnt(1) lgkmcnt(4)
  ds_read_b128 v[144:147], v172 offset:53248
  v_mfma_f32_32x32x16_bf16 v[72:87], v[152:155], a[216:219], v[72:87]
  s_waitcnt vmcnt(0) lgkmcnt(4)
  ds_read_b128 v[148:151], v172 offset:55296
  v_mfma_f32_32x32x16_bf16 v[72:87], v[156:159], a[220:223], v[72:87]
  ds_read_b128 v[152:155], v172 offset:57344
  v_mfma_f32_32x32x16_bf16 v[56:71], v[120:123], v[240:243], v[56:71]
  ds_read_b128 v[156:159], v172 offset:59392
  v_mfma_f32_32x32x16_bf16 v[56:71], v[124:127], v[244:247], v[56:71]
  ds_read_b128 v[120:123], v172 offset:61440
  v_mfma_f32_32x32x16_bf16 v[56:71], v[128:131], v[248:251], v[56:71]
  s_waitcnt lgkmcnt(4)
  ds_read_b128 v[124:127], v172 offset:63488
  s_nop 3
  v_cvt_pk_bf16_f32 v104, v72, v73
  v_cvt_pk_bf16_f32 v105, v74, v75
  v_cvt_pk_bf16_f32 v106, v76, v77
  v_cvt_pk_bf16_f32 v107, v78, v79
  v_mfma_f32_32x32x16_bf16 v[56:71], v[132:135], v[252:255], v[56:71]
  buffer_store_dwordx4 v[104:107], v2, s[12:15], s20 offen
  v_cvt_pk_bf16_f32 v108, v80, v81
  v_cvt_pk_bf16_f32 v109, v82, v83
  v_cvt_pk_bf16_f32 v110, v84, v85
  v_cvt_pk_bf16_f32 v111, v86, v87
  v_mfma_f32_32x32x16_bf16 v[56:71], v[136:139], a[192:195], v[56:71]
  buffer_store_dwordx4 v[108:111], v2, s[12:15], s20 offen offset:1024
  s_cmp_lg_u32 s23, 0
  s_cbranch_scc1 L_sl_34
  buffer_store_dwordx4 v[104:107], v2, s[44:47], s20 offen sc1
  buffer_store_dwordx4 v[108:111], v2, s[44:47], s20 offen offset:1024 sc1
L_sl_34:
  v_mfma_f32_32x32x16_bf16 v[56:71], v[140:143], a[196:199], v[56:71]
  v_mfma_f32_32x32x16_bf16 v[56:71], v[144:147], a[200:203], v[56:71]
  s_waitcnt lgkmcnt(1)
  v_mfma_f32_32x32x16_bf16 v[56:71], v[148:151], a[204:207], v[56:71]
  v_mfma_f32_32x32x16_bf16 v[56:71], v[152:155], a[208:211], v[56:71]
  v_mfma_f32_32x32x16_bf16 v[56:71], v[156:159], a[212:215], v[56:71]
  s_add_u32 s27, s37, 2
  v_mov_b32 v27, s27
  s_waitcnt vmcnt(0)
  buffer_store_dword v27, off, s[40:43], s98 offset:1024
  buffer_store_dword v27, off, s[44:47], s98 offset:1536 sc1
  v_mfma_f32_32x32x16_bf16 v[56:71], v[120:123], a[216:219], v[56:71]
  s_waitcnt lgkmcnt(0)
  buffer_load_dword v1, off, s[40:43], s99 offset:1024 sc1
  v_mfma_f32_32x32x16_bf16 v[56:71], v[124:127], a[220:223], v[56:71]
  s_waitcnt vmcnt(0)
  v_cmp_ne_u32 vcc, v1, v27
  s_mov_b32 s7, 0
  s_cbranch_vccz L_exd_36
L_ex_35:
  buffer_load_dword v1, off, s[40:43], s99 offset:1024 sc1
  s_add_u32 s7, s7, 1
  s_waitcnt vmcnt(0)
  v_cmp_ne_u32 vcc, v1, v27
  s_and_b32 s5, s7, s22
  s_cbranch_vccz L_exd_36
  s_cbranch_scc1 L_ex_35
  buffer_load_dword v1, off, s[40:43], s99 offset:1536 sc1
  s_waitcnt vmcnt(0)
  v_cmp_ne_u32 vcc, v1, v27
  s_cmp_lt_u32 s7, 0x40000
  s_cbranch_vccz L_exd_36
  s_cbranch_scc1 L_ex_35
L_exd_36:
  buffer_load_dwordx4 v[96:99], v2, s[40:43], s21 offen sc1
  buffer_load_dwordx4 v[100:103], v2, s[40:43], s21 offen offset:1024 sc1
  s_waitcnt vmcnt(1)
  v_lshlrev_b32 v88, 16, v96
  v_and_b32 v89, 0xffff0000, v96
  v_lshlrev_b32 v90, 16, v97
  v_and_b32 v91, 0xffff0000, v97
  v_lshlrev_b32 v92, 16, v98
  v_and_b32 v93, 0xffff0000, v98
  v_lshlrev_b32 v94, 16, v99
  v_and_b32 v95, 0xffff0000, v99
  s_waitcnt vmcnt(0)
  v_lshlrev_b32 v96, 16, v100
  v_and_b32 v97, 0xffff0000, v100
  v_lshlrev_b32 v98, 16, v101
  v_and_b32 v99, 0xffff0000, v101
  v_lshlrev_b32 v100, 16, v102
  v_and_b32 v101, 0xffff0000, v102
  v_lshlrev_b32 v102, 16, v103
  v_and_b32 v103, 0xffff0000, v103
  v_pk_add_f32 v[56:57], v[56:57], v[88:89] op_sel:[0,0] op_sel_hi:[1,1]
  v_pk_add_f32 v[58:59], v[58:59], v[90:91] op_sel:[0,0] op_sel_hi:[1,1]
  v_pk_add_f32 v[60:61], v[60:61], v[92:93] op_sel:[0,0] op_sel_hi:[1,1]
  v_pk_add_f32 v[62:63], v[62:63], v[94:95] op_sel:[0,0] op_sel_hi:[1,1]
  v_cvt_pk_bf16_f32 v104, v56, v57
  v_cvt_pk_bf16_f32 v105, v58, v59
  v_cvt_pk_bf16_f32 v106, v60, v61
  v_cvt_pk_bf16_f32 v107, v62, v63
  buffer_store_dwordx4 v[104:107], v116, s[32:35], s82 offen offset:0
  v_pk_add_f32 v[64:65], v[64:65], v[96:97] op_sel:[0,0] op_sel_hi:[1,1]
  v_pk_add_f32 v[66:67], v[66:67], v[98:99] op_sel:[0,0] op_sel_hi:[1,1]
  v_pk_add_f32 v[68:69], v[68:69], v[100:101] op_sel:[0,0] op_sel_hi:[1,1]
  v_pk_add_f32 v[70:71], v[70:71], v[102:103] op_sel:[0,0] op_sel_hi:[1,1]
  v_cvt_pk_bf16_f32 v108, v64, v65
  v_cvt_pk_bf16_f32 v109, v66, v67
  v_cvt_pk_bf16_f32 v110, v68, v69
  v_cvt_pk_bf16_f32 v111, v70, v71
  buffer_store_dwordx4 v[108:111], v116, s[32:35], s82 offen offset:16
  s_add_u32 s3, s36, 1
  v_mov_b32 v26, s3
  s_mov_b32 s4, 32768
  s_cmp_lg_u32 s48, 0
  s_cbranch_scc1 L_e_37
  buffer_store_dword v26, v9, s[40:43], s4 offen sc1
L_e_37:
L_end:
  s_endpgm
L_var1:
  s_add_u32 m0, s100, 69632
  s_add_u32 s6, s58, 786432
  buffer_load_dwordx4 v185, s[12:15], s6 offen offset:0 lds
  s_add_u32 s6, s58, 809984
  buffer_load_dwordx4 v186, s[12:15], s6 offen offset:1024 lds
  s_add_u32 m0, s100, 77824
  s_add_u32 s6, s58, 787456
  buffer_load_dwordx4 v185, s[12:15], s6 offen offset:0 lds
  s_add_u32 s6, s58, 811008
  buffer_load_dwordx4 v186, s[12:15], s6 offen offset:1024 lds
  s_add_u32 m0, s100, 86016
  s_add_u32 s6, s58, 788480
  buffer_load_dwordx4 v185, s[12:15], s6 offen offset:0 lds
  s_add_u32 s6, s58, 812032
  buffer_load_dwordx4 v186, s[12:15], s6 offen offset:1024 lds
  s_add_u32 m0, s69, 94208
  s_add_u32 s6, s59, 512
  buffer_load_dwordx4 v187, s[8:11], s6 offen lds
  s_add_u32 m0, s69, 98304
  s_add_u32 s6, s59, 33280
  buffer_load_dwordx4 v187, s[8:11], s6 offen lds
  s_add_u32 m0, s101, 102400
  s_add_u32 s6, s62, 512
  buffer_load_dwordx4 v187, s[8:11], s6 offen lds
  s_waitcnt vmcnt(18)
  s_waitcnt lgkmcnt(0)
  s_mul_i32 s37, s36, 0x9e3779c1
  s_barrier
  ds_read_b64_tr_b16 a[48:49], v174 offset:0
  ds_read_b64_tr_b16 a[50:51], v174 offset:512
  ds_read_b64_tr_b16 a[52:53], v174 offset:8192
  ds_read_b64_tr_b16 a[54:55], v174 offset:8704
  ds_read_b64_tr_b16 a[56:57], v174 offset:16384
  ds_read_b64_tr_b16 a[58:59], v174 offset:16896
  ds_read_b128 v[192:195], v172 offset:0
  ds_read_b128 v[196:199], v172 offset:2048
  ds_read_b128 v[200:203], v172 offset:4096
  ds_read_b128 v[204:207], v172 offset:6144
  ds_read_b128 v[208:211], v172 offset:8192
  ds_read_b64_tr_b16 a[60:61], v174 offset:4096
  s_waitcnt lgkmcnt(10)
  ds_read_b64_tr_b16 a[62:63], v174 offset:4608
  s_add_u32 m0, s55, 147456
  s_add_u32 s6, s22, 0
  buffer_load_dwordx4 v188, s[44:47], s6 offen offset:0 nt lds
  v_mfma_f32_16x16x32_bf16 v[32:35], a[48:51], v[28:31], 0
  s_waitcnt lgkmcnt(9)
  ds_read_b64_tr_b16 a[64:65], v174 offset:12288
  s_add_u32 m0, s55, 147456
  v_mfma_f32_16x16x32_bf16 v[36:39], a[52:55], v[28:31], 0
  s_waitcnt lgkmcnt(8)
  ds_read_b64_tr_b16 a[66:67], v174 offset:12800
  s_add_u32 s6, s22, 13312
  v_mfma_f32_16x16x32_bf16 v[116:119], v[28:31], a[56:59], 0
  s_waitcnt lgkmcnt(8)
  ds_read_b64_tr_b16 a[68:69], v174 offset:20480
  buffer_load_dwordx4 v188, s[44:47], s6 offen offset:1024 nt lds
  s_add_u32 s23, s23, s37
  s_add_u32 s23, s23, 32
  v_mov_b32 v26, s23
  v_mfma_f32_16x16x32_bf16 v[56:59], a[48:51], v[192:195], 0
  ds_read_b64_tr_b16 a[70:71], v174 offset:20992
  s_add_u32 m0, s55, 147456
  v_mfma_f32_16x16x32_bf16 v[60:63], a[52:55], v[192:195], 0
  ds_read_b128 v[212:215], v173 offset:0
  s_add_u32 s6, s22, 26624
  buffer_load_dwordx4 v188, s[44:47], s6 offen offset:2048 nt lds
  v_mfma_f32_16x16x32_bf16 v[64:67], v[192:195], a[56:59], 0
  s_waitcnt lgkmcnt(6)
  ds_read_b128 v[216:219], v173 offset:2048
  s_add_u32 m0, s55, 147456
  v_mfma_f32_16x16x32_bf16 v[68:71], a[48:51], v[196:199], 0
  ds_read_b128 v[220:223], v173 offset:4096
  s_add_u32 s6, s22, 39936
  v_mfma_f32_16x16x32_bf16 v[72:75], a[52:55], v[196:199], 0
  ds_read_b128 v[224:227], v173 offset:6144
  buffer_load_dwordx4 v188, s[44:47], s6 offen offset:3072 nt lds
  v_mfma_f32_16x16x32_bf16 v[76:79], v[196:199], a[56:59], 0
  ds_read_b128 v[228:231], v173 offset:8192
  s_add_u32 m0, s100, 139264
  v_mfma_f32_16x16x32_bf16 v[80:83], a[48:51], v[200:203], 0
  ds_read_b128 v[232:235], v175 offset:0
  v_mfma_f32_16x16x32_bf16 v[84:87], a[52:55], v[200:203], 0
  ds_read_b128 v[236:239], v175 offset:2048
  buffer_load_dwordx4 v2, s[28:31], s27 offen nt lds
  v_mfma_f32_16x16x32_bf16 v[88:91], v[200:203], a[56:59], 0
  ds_read_b128 v[240:243], v176 offset:8192
  v_mfma_f32_16x16x32_bf16 v[92:95], a[48:51], v[204:207], 0
  v_mfma_f32_16x16x32_bf16 v[96:99], a[52:55], v[204:207], 0
  buffer_load_dwordx4 v2, s[28:31], s27 offen offset:1024 nt lds
  v_mfma_f32_16x16x32_bf16 v[100:103], v[204:207], a[56:59], 0
  s_lshl_b32 s6, s48, 11
  v_mfma_f32_16x16x32_bf16 v[108:111], a[52:55], v[208:211], 0
  v_mfma_f32_16x16x32_bf16 v[112:115], v[208:211], a[56:59], 0
  s_waitcnt lgkmcnt(4)
  buffer_load_dword v253, v190, s[16:19], s6 offen
  s_and_b32 s6, s48, 31
  s_lshl_b32 s6, s6, 14
  buffer_load_dword v252, v254, s[16:19], s6 offen offset:384
  s_add_u32 m0, s100, 104448
  s_add_u32 s6, s58, 983040
  buffer_load_dwordx4 v185, s[12:15], s6 offen offset:0 lds
  v_mfma_f32_16x16x32_bf16 v[32:35], a[60:63], v[28:31], v[32:35]
  s_add_u32 s6, s58, 1006592
  v_mfma_f32_16x16x32_bf16 v[36:39], a[64:67], v[28:31], v[36:39]
  v_mfma_f32_16x16x32_bf16 v[116:119], v[28:31], a[68:71], v[116:119]
  buffer_load_dwordx4 v186, s[12:15], s6 offen offset:1024 lds
  v_mfma_f32_16x16x32_bf16 v[56:59], a[60:63], v[212:215], v[56:59]
  s_add_u32 m0, s100, 112640
  s_add_u32 s6, s58, 984064
  v_mfma_f32_16x16x32_bf16 v[60:63], a[64:67], v[212:215], v[60:63]
  v_mfma_f32_16x16x32_bf16 v[64:67], v[212:215], a[68:71], v[64:67]
  buffer_load_dwordx4 v185, s[12:15], s6 offen offset:0 lds
  v_mfma_f32_16x16x32_bf16 v[68:71], a[60:63], v[216:219], v[68:71]
  s_add_u32 s6, s58, 1007616
  v_mfma_f32_16x16x32_bf16 v[72:75], a[64:67], v[216:219], v[72:75]
  v_mfma_f32_16x16x32_bf16 v[76:79], v[216:219], a[68:71], v[76:79]
  s_waitcnt vmcnt(20)
  s_barrier
  ds_read_b64_tr_b16 a[72:73], v174 offset:34816
  buffer_load_dwordx4 v186, s[12:15], s6 offen offset:1024 lds
  v_mfma_f32_16x16x32_bf16 v[80:83], a[60:63], v[220:223], v[80:83]
  ds_read_b64_tr_b16 a[74:75], v174 offset:35328
  s_add_u32 m0, s100, 120832
  v_mfma_f32_16x16x32_bf16 v[84:87], a[64:67], v[220:223], v[84:87]
  ds_read_b64_tr_b16 a[76:77], v174 offset:43008
  s_add_u32 s6, s58, 985088
  v_mfma_f32_16x16x32_bf16 v[88:91], v[220:223], a[68:71], v[88:91]
  ds_read_b64_tr_b16 a[78:79], v174 offset:43520
  buffer_load_dwordx4 v185, s[12:15], s6 offen offset:0 lds
  v_mfma_f32_16x16x32_bf16 v[92:95], a[60:63], v[224:227], v[92:95]
  ds_read_b64_tr_b16 a[80:81], v174 offset:51200
  s_add_u32 s6, s58, 1008640
  v_mfma_f32_16x16x32_bf16 v[96:99], a[64:67], v[224:227], v[96:99]
  ds_read_b64_tr_b16 a[82:83], v174 offset:51712
  v_mfma_f32_16x16x32_bf16 v[100:103], v[224:227], a[68:71], v[100:103]
  s_waitcnt lgkmcnt(6)
  ds_read_b128 v[120:123], v172 offset:34816
  buffer_load_dwordx4 v186, s[12:15], s6 offen offset:1024 lds
  v_mfma_f32_16x16x32_bf16 v[108:111], a[64:67], v[228:231], v[108:111]
  ds_read_b128 v[124:127], v172 offset:36864
  s_add_u32 m0, s69, 129024
  v_mfma_f32_16x16x32_bf16 v[112:115], v[228:231], a[68:71], v[112:115]
  ds_read_b128 v[128:131], v172 offset:38912
  s_add_u32 s6, s59, 640
  v_mfma_f32_16x16x32_bf16 a[192:195], v[28:31], v[232:235], 0
  ds_read_b128 v[132:135], v172 offset:40960
  buffer_load_dwordx4 v187, s[8:11], s6 offen lds
  v_mfma_f32_16x16x32_bf16 a[204:207], v[232:235], v[232:235], 0
  ds_read_b128 v[136:139], v172 offset:43008
  s_add_u32 m0, s69, 133120
  v_mfma_f32_16x16x32_bf16 a[196:199], v[28:31], v[236:239], 0
  ds_read_b64_tr_b16 a[84:85], v174 offset:38912
  s_add_u32 s6, s59, 33408
  v_mfma_f32_16x16x32_bf16 a[208:211], v[236:239], v[236:239], 0
  ds_read_b64_tr_b16 a[86:87], v174 offset:39424
  buffer_load_dwordx4 v187, s[8:11], s6 offen lds
  v_mfma_f32_16x16x32_bf16 a[200:203], v[28:31], v[240:243], 0
  ds_read_b64_tr_b16 a[88:89], v174 offset:47104
  s_add_u32 m0, s101, 137216
  v_mfma_f32_16x16x32_bf16 a[212:215], v[240:243], v[240:243], 0
  s_waitcnt lgkmcnt(7)
  ds_read_b64_tr_b16 a[90:91], v174 offset:47616
  s_add_u32 s6, s62, 640
  v_mfma_f32_16x16x32_bf16 v[32:35], a[72:75], v[28:31], v[32:35]
  ds_read_b64_tr_b16 a[92:93], v174 offset:55296
  buffer_load_dwordx4 v187, s[8:11], s6 offen lds
  v_mfma_f32_16x16x32_bf16 v[36:39], a[76:79], v[28:31], v[36:39]
  ds_read_b64_tr_b16 a[94:95], v174 offset:55808
  v_mfma_f32_16x16x32_bf16 v[116:119], v[28:31], a[80:83], v[116:119]
  ds_read_b128 v[140:143], v173 offset:34816
  v_mfma_f32_16x16x32_bf16 v[56:59], a[72:75], v[120:123], v[56:59]
  ds_read_b128 v[144:147], v173 offset:36864
  buffer_load_dwordx4 v[244:247], v15, s[8:11], s82 offen
  v_mfma_f32_16x16x32_bf16 v[60:63], a[76:79], v[120:123], v[60:63]
  ds_read_b128 v[148:151], v173 offset:38912
  v_mfma_f32_16x16x32_bf16 v[64:67], v[120:123], a[80:83], v[64:67]
  s_waitcnt lgkmcnt(7)
  ds_read_b128 v[152:155], v173 offset:40960
  v_mfma_f32_16x16x32_bf16 v[68:71], a[72:75], v[124:127], v[68:71]
  ds_read_b128 v[156:159], v173 offset:43008
  buffer_load_dwordx4 v[248:251], v15, s[8:11], s82 offen offset:16
  v_mfma_f32_16x16x32_bf16 v[72:75], a[76:79], v[124:127], v[72:75]
  ds_read_b128 v[160:163], v175 offset:34816
  v_mfma_f32_16x16x32_bf16 v[76:79], v[124:127], a[80:83], v[76:79]
  ds_read_b128 v[164:167], v175 offset:36864
  v_mfma_f32_16x16x32_bf16 v[80:83], a[72:75], v[128:131], v[80:83]
  ds_read_b128 v[168:171], v176 offset:43008
  v_mfma_f32_16x16x32_bf16 v[84:87], a[76:79], v[128:131], v[84:87]
  v_mfma_f32_16x16x32_bf16 v[88:91], v[128:131], a[80:83], v[88:91]
  v_mfma_f32_16x16x32_bf16 v[92:95], a[72:75], v[132:135], v[92:95]
  v_mfma_f32_16x16x32_bf16 v[96:99], a[76:79], v[132:135], v[96:99]
  v_mfma_f32_16x16x32_bf16 v[100:103], v[132:135], a[80:83], v[100:103]
  v_mfma_f32_16x16x32_bf16 v[108:111], a[76:79], v[136:139], v[108:111]
  v_mfma_f32_16x16x32_bf16 v[112:115], v[136:139], a[80:83], v[112:115]
  v_mfma_f32_16x16x32_bf16 v[32:35], a[84:87], v[28:31], v[32:35]
  s_waitcnt lgkmcnt(1)
  v_mfma_f32_16x16x32_bf16 v[36:39], a[88:91], v[28:31], v[36:39]
  v_mfma_f32_16x16x32_bf16 v[116:119], v[28:31], a[92:95], v[116:119]
  v_mfma_f32_16x16x32_bf16 v[56:59], a[84:87], v[140:143], v[56:59]
  v_mfma_f32_16x16x32_bf16 v[60:63], a[88:91], v[140:143], v[60:63]
  v_mfma_f32_16x16x32_bf16 v[64:67], v[140:143], a[92:95], v[64:67]
  v_mfma_f32_16x16x32_bf16 v[68:71], a[84:87], v[144:147], v[68:71]
  v_mfma_f32_16x16x32_bf16 v[72:75], a[88:91], v[144:147], v[72:75]
  v_mfma_f32_16x16x32_bf16 v[76:79], v[144:147], a[92:95], v[76:79]
  s_waitcnt vmcnt(19)
  s_barrier
  ds_read_b64_tr_b16 a[96:97], v179 offset:0
  v_mfma_f32_16x16x32_bf16 v[80:83], a[84:87], v[148:151], v[80:83]
  ds_read_b64_tr_b16 a[98:99], v179 offset:512
  s_add_u32 m0, s100, 0
  s_add_u32 s6, s58, 1179648
  buffer_load_dwordx4 v185, s[12:15], s6 offen offset:0 lds
  v_mfma_f32_16x16x32_bf16 v[84:87], a[88:91], v[148:151], v[84:87]
  ds_read_b64_tr_b16 a[100:101], v179 offset:8192
  s_add_u32 s6, s58, 1203200
  v_mfma_f32_16x16x32_bf16 v[88:91], v[148:151], a[92:95], v[88:91]
  ds_read_b64_tr_b16 a[102:103], v179 offset:8704
  v_mfma_f32_16x16x32_bf16 v[92:95], a[84:87], v[152:155], v[92:95]
  ds_read_b64_tr_b16 a[104:105], v179 offset:16384
  buffer_load_dwordx4 v186, s[12:15], s6 offen offset:1024 lds
  v_mfma_f32_16x16x32_bf16 v[96:99], a[88:91], v[152:155], v[96:99]
  ds_read_b64_tr_b16 a[106:107], v179 offset:16896
  s_add_u32 m0, s100, 8192
  v_mfma_f32_16x16x32_bf16 v[100:103], v[152:155], a[92:95], v[100:103]
  ds_read_b128 v[192:195], v177 offset:0
  s_add_u32 s6, s58, 1180672
  v_mfma_f32_16x16x32_bf16 v[108:111], a[88:91], v[156:159], v[108:111]
  ds_read_b128 v[196:199], v177 offset:2048
  buffer_load_dwordx4 v185, s[12:15], s6 offen offset:0 lds
  v_mfma_f32_16x16x32_bf16 v[112:115], v[156:159], a[92:95], v[112:115]
  ds_read_b128 v[200:203], v177 offset:4096
  s_add_u32 s6, s58, 1204224
  v_mfma_f32_16x16x32_bf16 a[192:195], v[28:31], v[160:163], a[192:195]
  ds_read_b128 v[204:207], v177 offset:6144
  v_mfma_f32_16x16x32_bf16 a[204:207], v[160:163], v[160:163], a[204:207]
  ds_read_b128 v[208:211], v177 offset:8192
  buffer_load_dwordx4 v186, s[12:15], s6 offen offset:1024 lds
  v_mfma_f32_16x16x32_bf16 a[196:199], v[28:31], v[164:167], a[196:199]
  ds_read_b64_tr_b16 a[108:109], v179 offset:4096
  s_add_u32 m0, s100, 16384
  v_mfma_f32_16x16x32_bf16 a[208:211], v[164:167], v[164:167], a[208:211]
  s_waitcnt lgkmcnt(7)
  ds_read_b64_tr_b16 a[110:111], v179 offset:4608
  s_add_u32 s6, s58, 1181696
  v_mfma_f32_16x16x32_bf16 a[200:203], v[28:31], v[168:171], a[200:203]
  ds_read_b64_tr_b16 a[112:113], v179 offset:12288
  buffer_load_dwordx4 v185, s[12:15], s6 offen offset:0 lds
  v_mfma_f32_16x16x32_bf16 a[212:215], v[168:171], v[168:171], a[212:215]
  ds_read_b64_tr_b16 a[114:115], v179 offset:12800
  s_add_u32 s6, s58, 1205248
  v_mfma_f32_16x16x32_bf16 v[32:35], a[96:99], v[28:31], v[32:35]
  ds_read_b64_tr_b16 a[116:117], v179 offset:20480
  v_mfma_f32_16x16x32_bf16 v[36:39], a[100:103], v[28:31], v[36:39]
  s_waitcnt lgkmcnt(7)
  ds_read_b64_tr_b16 a[118:119], v179 offset:20992
  buffer_load_dwordx4 v186, s[12:15], s6 offen offset:1024 lds
  v_mfma_f32_16x16x32_bf16 v[116:119], v[28:31], a[104:107], v[116:119]
  ds_read_b128 v[212:215], v178 offset:0
  s_add_u32 m0, s69, 24576
  v_mfma_f32_16x16x32_bf16 v[56:59], a[96:99], v[192:195], v[56:59]
  ds_read_b128 v[216:219], v178 offset:2048
  s_add_u32 s6, s59, 768
  v_mfma_f32_16x16x32_bf16 v[60:63], a[100:103], v[192:195], v[60:63]
  ds_read_b128 v[220:223], v178 offset:4096
  buffer_load_dwordx4 v187, s[8:11], s6 offen lds
  v_mfma_f32_16x16x32_bf16 v[64:67], v[192:195], a[104:107], v[64:67]
  ds_read_b128 v[224:227], v178 offset:6144
  s_add_u32 m0, s69, 28672
  v_mfma_f32_16x16x32_bf16 v[68:71], a[96:99], v[196:199], v[68:71]
  ds_read_b128 v[228:231], v178 offset:8192
  s_add_u32 s6, s59, 33536
  v_mfma_f32_16x16x32_bf16 v[72:75], a[100:103], v[196:199], v[72:75]
  ds_read_b128 v[232:235], v180 offset:0
  buffer_load_dwordx4 v187, s[8:11], s6 offen lds
  v_mfma_f32_16x16x32_bf16 v[76:79], v[196:199], a[104:107], v[76:79]
  ds_read_b128 v[236:239], v180 offset:2048
  s_add_u32 m0, s101, 32768
  v_mfma_f32_16x16x32_bf16 v[80:83], a[96:99], v[200:203], v[80:83]
  s_waitcnt lgkmcnt(7)
  ds_read_b128 v[240:243], v181 offset:8192
  s_add_u32 s6, s62, 768
  v_mfma_f32_16x16x32_bf16 v[84:87], a[100:103], v[200:203], v[84:87]
  buffer_load_dwordx4 v187, s[8:11], s6 offen lds
  v_mfma_f32_16x16x32_bf16 v[88:91], v[200:203], a[104:107], v[88:91]
  v_mfma_f32_16x16x32_bf16 v[92:95], a[96:99], v[204:207], v[92:95]
  v_mfma_f32_16x16x32_bf16 v[96:99], a[100:103], v[204:207], v[96:99]
  v_mfma_f32_16x16x32_bf16 v[100:103], v[204:207], a[104:107], v[100:103]
  v_mfma_f32_16x16x32_bf16 v[108:111], a[100:103], v[208:211], v[108:111]
  v_mfma_f32_16x16x32_bf16 v[112:115], v[208:211], a[104:107], v[112:115]
  v_mfma_f32_16x16x32_bf16 v[32:35], a[108:111], v[28:31], v[32:35]
  v_mfma_f32_16x16x32_bf16 v[36:39], a[112:115], v[28:31], v[36:39]
  v_mfma_f32_16x16x32_bf16 v[116:119], v[28:31], a[116:119], v[116:119]
  s_waitcnt lgkmcnt(0)
  v_mfma_f32_16x16x32_bf16 v[56:59], a[108:111], v[212:215], v[56:59]
  v_mfma_f32_16x16x32_bf16 v[60:63], a[112:115], v[212:215], v[60:63]
  v_mfma_f32_16x16x32_bf16 v[64:67], v[212:215], a[116:119], v[64:67]
  v_mfma_f32_16x16x32_bf16 v[68:71], a[108:111], v[216:219], v[68:71]
  v_mfma_f32_16x16x32_bf16 v[72:75], a[112:115], v[216:219], v[72:75]
  v_mfma_f32_16x16x32_bf16 v[76:79], v[216:219], a[116:119], v[76:79]
  s_waitcnt vmcnt(11)
  s_barrier
  ds_read_b64_tr_b16 a[120:121], v179 offset:34816
  v_mfma_f32_16x16x32_bf16 v[80:83], a[108:111], v[220:223], v[80:83]
  ds_read_b64_tr_b16 a[122:123], v179 offset:35328
  s_add_u32 m0, s100, 34816
  s_add_u32 s6, s58, 1376256
  buffer_load_dwordx4 v185, s[12:15], s6 offen offset:0 lds
  v_mfma_f32_16x16x32_bf16 v[84:87], a[112:115], v[220:223], v[84:87]
  ds_read_b64_tr_b16 a[124:125], v179 offset:43008
  s_add_u32 s6, s58, 1399808
  v_mfma_f32_16x16x32_bf16 v[88:91], v[220:223], a[116:119], v[88:91]
  ds_read_b64_tr_b16 a[126:127], v179 offset:43520
  ds_read_b64_tr_b16 a[216:217], v182 offset:0
  v_mfma_f32_16x16x32_bf16 v[92:95], a[108:111], v[224:227], v[92:95]
  ds_read_b64_tr_b16 a[128:129], v179 offset:51200
  buffer_load_dwordx4 v186, s[12:15], s6 offen offset:1024 lds
  v_mfma_f32_16x16x32_bf16 v[96:99], a[112:115], v[224:227], v[96:99]
  ds_read_b64_tr_b16 a[130:131], v179 offset:51712
  s_add_u32 m0, s100, 43008
  v_mfma_f32_16x16x32_bf16 v[100:103], v[224:227], a[116:119], v[100:103]
  ds_read_b128 v[120:123], v177 offset:34816
  s_add_u32 s6, s58, 1377280
  v_mfma_f32_16x16x32_bf16 v[108:111], a[112:115], v[228:231], v[108:111]
  ds_read_b128 v[124:127], v177 offset:36864
  buffer_load_dwordx4 v185, s[12:15], s6 offen offset:0 lds
  v_mfma_f32_16x16x32_bf16 v[112:115], v[228:231], a[116:119], v[112:115]
  ds_read_b128 v[128:131], v177 offset:38912
  s_add_u32 s6, s58, 1400832
  v_mfma_f32_16x16x32_bf16 a[192:195], v[28:31], v[232:235], a[192:195]
  ds_read_b128 v[132:135], v177 offset:40960
  ds_read_b64_tr_b16 a[218:219], v182 offset:1024
  v_mfma_f32_16x16x32_bf16 a[204:207], v[232:235], v[232:235], a[204:207]
  ds_read_b128 v[136:139], v177 offset:43008
  buffer_load_dwordx4 v186, s[12:15], s6 offen offset:1024 lds
  v_mfma_f32_16x16x32_bf16 a[196:199], v[28:31], v[236:239], a[196:199]
  ds_read_b64_tr_b16 a[132:133], v179 offset:38912
  s_add_u32 m0, s100, 51200
  v_mfma_f32_16x16x32_bf16 a[208:211], v[236:239], v[236:239], a[208:211]
  ds_read_b64_tr_b16 a[134:135], v179 offset:39424
  s_add_u32 s6, s58, 1378304
  v_mfma_f32_16x16x32_bf16 a[200:203], v[28:31], v[240:243], a[200:203]
  s_waitcnt lgkmcnt(8)
  ds_read_b64_tr_b16 a[136:137], v179 offset:47104
  buffer_load_dwordx4 v185, s[12:15], s6 offen offset:0 lds
  v_mfma_f32_16x16x32_bf16 a[212:215], v[240:243], v[240:243], a[212:215]
  ds_read_b64_tr_b16 a[138:139], v179 offset:47616
  s_add_u32 s6, s58, 1401856
  v_mfma_f32_16x16x32_bf16 v[32:35], a[120:123], v[28:31], v[32:35]
  ds_read_b64_tr_b16 a[140:141], v179 offset:55296
  ds_read_b64_tr_b16 a[220:221], v182 offset:4096
  v_mfma_f32_16x16x32_bf16 v[36:39], a[124:127], v[28:31], v[36:39]
  ds_read_b64_tr_b16 a[142:143], v179 offset:55808
  buffer_load_dwordx4 v186, s[12:15], s6 offen offset:1024 lds
  v_mfma_f32_16x16x32_bf16 v[116:119], v[28:31], a[128:131], v[116:119]
  s_waitcnt lgkmcnt(8)
  ds_read_b128 v[140:143], v178 offset:34816
  s_add_u32 m0, s69, 59392
  v_mfma_f32_16x16x32_bf16 v[56:59], a[120:123], v[120:123], v[56:59]
  ds_read_b128 v[144:147], v178 offset:36864
  s_add_u32 s6, s59, 896
  ds_read_b64_tr_b16 a[222:223], v182 offset:5120
  ds_read_b64_tr_b16 a[224:225], v183 offset:0
  buffer_load_dwordx4 v187, s[8:11], s6 offen lds
  v_mfma_f32_16x16x32_bf16 v[60:63], a[124:127], v[120:123], v[60:63]
  ds_read_b128 v[148:151], v178 offset:38912
  s_add_u32 m0, s69, 63488
  ds_read_b64_tr_b16 a[226:227], v183 offset:1024
  v_mfma_f32_16x16x32_bf16 v[64:67], v[120:123], a[128:131], v[64:67]
  ds_read_b128 v[152:155], v178 offset:40960
  s_add_u32 s6, s59, 33664
  s_waitcnt lgkmcnt(10)
  ds_read_b64_tr_b16 a[228:229], v183 offset:4096
  buffer_load_dwordx4 v187, s[8:11], s6 offen lds
  v_mfma_f32_16x16x32_bf16 v[68:71], a[120:123], v[124:127], v[68:71]
  ds_read_b128 v[156:159], v178 offset:43008
  s_add_u32 m0, s101, 67584
  ds_read_b64_tr_b16 a[230:231], v183 offset:5120
  ds_read_b64_tr_b16 a[248:249], v6 offset:0
  v_mfma_f32_16x16x32_bf16 v[72:75], a[124:127], v[124:127], v[72:75]
  ds_read_b128 v[160:163], v180 offset:34816
  s_add_u32 s6, s62, 896
  buffer_load_dwordx4 v187, s[8:11], s6 offen lds
  s_waitcnt lgkmcnt(10)
  ds_read_b64_tr_b16 a[250:251], v6 offset:4096
  v_mfma_f32_16x16x32_bf16 v[76:79], v[124:127], a[128:131], v[76:79]
  ds_read_b128 v[164:167], v180 offset:36864
  ds_read_b64_tr_b16 a[252:253], v6 offset:128
  ds_read_b64_tr_b16 a[254:255], v6 offset:4224
  v_mfma_f32_16x16x32_bf16 v[80:83], a[120:123], v[128:131], v[80:83]
  ds_read_b128 v[168:171], v181 offset:43008
  buffer_store_dwordx4 a[216:219], v2, s[40:43], s96 offen sc1
  v_mfma_f32_16x16x32_bf16 v[84:87], a[124:127], v[128:131], v[84:87]
  s_waitcnt lgkmcnt(12)
  buffer_store_dwordx4 a[220:223], v2, s[40:43], s97 offen sc1
  v_mfma_f32_16x16x32_bf16 v[88:91], v[128:131], a[128:131], v[88:91]
  s_waitcnt lgkmcnt(10)
  buffer_store_dwordx4 a[224:227], v2, s[40:43], s98 offen sc1
  v_mfma_f32_16x16x32_bf16 v[92:95], a[120:123], v[132:135], v[92:95]
  v_mfma_f32_16x16x32_bf16 v[96:99], a[124:127], v[132:135], v[96:99]
  v_mfma_f32_16x16x32_bf16 v[100:103], v[132:135], a[128:131], v[100:103]
  s_waitcnt lgkmcnt(6)
  buffer_store_dwordx4 a[228:231], v2, s[40:43], s98 offen offset:1024 sc1
  v_mfma_f32_16x16x32_bf16 v[108:111], a[124:127], v[136:139], v[108:111]
  v_mfma_f32_16x16x32_bf16 v[112:115], v[136:139], a[128:131], v[112:115]
  s_waitcnt lgkmcnt(3)
  buffer_store_dwordx4 a[248:251], v7, s[40:43], s21 offen sc1
  v_mfma_f32_16x16x32_bf16 v[32:35], a[132:135], v[28:31], v[32:35]
  s_waitcnt lgkmcnt(1)
  buffer_store_dwordx4 a[252:255], v7, s[40:43], s26 offen sc1
  v_mfma_f32_32x32x16_bf16 a[232:247], v[28:31], a[216:219], 0
  v_mfma_f32_32x32x16_bf16 a[232:247], v[28:31], a[220:223], a[232:247]
  v_mfma_f32_16x16x32_bf16 v[36:39], a[136:139], v[28:31], v[36:39]
  v_mfma_f32_16x16x32_bf16 v[116:119], v[28:31], a[140:143], v[116:119]
  v_mfma_f32_16x16x32_bf16 v[56:59], a[132:135], v[140:143], v[56:59]
  v_mfma_f32_16x16x32_bf16 v[60:63], a[136:139], v[140:143], v[60:63]
  s_nop 7
  buffer_store_dword a232, v184, s[40:43], s99 offen sc1
  v_mfma_f32_32x32x16_bf16 a[232:247], v[28:31], a[224:227], 0
  v_mfma_f32_32x32x16_bf16 a[232:247], v[28:31], a[228:231], a[232:247]
  v_mfma_f32_16x16x32_bf16 v[64:67], v[140:143], a[140:143], v[64:67]
  v_mfma_f32_16x16x32_bf16 v[68:71], a[132:135], v[144:147], v[68:71]
  v_mfma_f32_16x16x32_bf16 v[72:75], a[136:139], v[144:147], v[72:75]
  v_mfma_f32_16x16x32_bf16 v[76:79], v[144:147], a[140:143], v[76:79]
  s_nop 7
  buffer_store_dword a232, v184, s[40:43], s20 offen sc1
  s_waitcnt vmcnt(17)
  s_barrier
  ds_read_b64_tr_b16 a[144:145], v174 offset:0
  v_mfma_f32_16x16x32_bf16 v[80:83], a[132:135], v[148:151], v[80:83]
  ds_read_b64_tr_b16 a[146:147], v174 offset:512
  s_add_u32 m0, s100, 69632
  s_add_u32 s6, s58, 0
  buffer_load_dwordx4 v185, s[12:15], s6 offen offset:0 lds
  v_mfma_f32_16x16x32_bf16 v[84:87], a[136:139], v[148:151], v[84:87]
  ds_read_b64_tr_b16 a[148:149], v174 offset:8192
  s_add_u32 s6, s58, 23552
  v_mfma_f32_16x16x32_bf16 v[88:91], v[148:151], a[140:143], v[88:91]
  ds_read_b64_tr_b16 a[150:151], v174 offset:8704
  v_mfma_f32_16x16x32_bf16 v[92:95], a[132:135], v[152:155], v[92:95]
  ds_read_b64_tr_b16 a[152:153], v174 offset:16384
  buffer_load_dwordx4 v186, s[12:15], s6 offen offset:1024 lds
  v_mfma_f32_16x16x32_bf16 v[96:99], a[136:139], v[152:155], v[96:99]
  ds_read_b64_tr_b16 a[154:155], v174 offset:16896
  s_add_u32 m0, s100, 77824
  v_mfma_f32_16x16x32_bf16 v[100:103], v[152:155], a[140:143], v[100:103]
  ds_read_b128 v[192:195], v172 offset:0
  s_add_u32 s6, s58, 1024
  v_mfma_f32_16x16x32_bf16 v[108:111], a[136:139], v[156:159], v[108:111]
  ds_read_b128 v[196:199], v172 offset:2048
  buffer_load_dwordx4 v185, s[12:15], s6 offen offset:0 lds
  v_mfma_f32_16x16x32_bf16 v[112:115], v[156:159], a[140:143], v[112:115]
  ds_read_b128 v[200:203], v172 offset:4096
  s_add_u32 s6, s58, 24576
  v_mfma_f32_16x16x32_bf16 a[192:195], v[28:31], v[160:163], a[192:195]
  ds_read_b128 v[204:207], v172 offset:6144
  v_mfma_f32_16x16x32_bf16 a[204:207], v[160:163], v[160:163], a[204:207]
  ds_read_b128 v[208:211], v172 offset:8192
  buffer_load_dwordx4 v186, s[12:15], s6 offen offset:1024 lds
  v_mfma_f32_16x16x32_bf16 a[196:199], v[28:31], v[164:167], a[196:199]
  ds_read_b64_tr_b16 a[156:157], v174 offset:4096
  s_add_u32 m0, s100, 86016
  v_mfma_f32_16x16x32_bf16 a[208:211], v[164:167], v[164:167], a[208:211]
  s_waitcnt lgkmcnt(7)
  ds_read_b64_tr_b16 a[158:159], v174 offset:4608
  s_add_u32 s6, s58, 2048
  v_mfma_f32_16x16x32_bf16 a[200:203], v[28:31], v[168:171], a[200:203]
  ds_read_b64_tr_b16 a[160:161], v174 offset:12288
  buffer_load_dwordx4 v185, s[12:15], s6 offen offset:0 lds
  v_mfma_f32_16x16x32_bf16 a[212:215], v[168:171], v[168:171], a[212:215]
  ds_read_b64_tr_b16 a[162:163], v174 offset:12800
  s_add_u32 s6, s58, 25600
  v_mfma_f32_16x16x32_bf16 v[32:35], a[144:147], v[28:31], v[32:35]
  ds_read_b64_tr_b16 a[164:165], v174 offset:20480
  v_mfma_f32_16x16x32_bf16 v[36:39], a[148:151], v[28:31], v[36:39]
  s_waitcnt lgkmcnt(7)
  ds_read_b64_tr_b16 a[166:167], v174 offset:20992
  buffer_load_dwordx4 v186, s[12:15], s6 offen offset:1024 lds
  v_mfma_f32_16x16x32_bf16 v[116:119], v[28:31], a[152:155], v[116:119]
  ds_read_b128 v[212:215], v173 offset:0
  s_add_u32 m0, s69, 94208
  v_mfma_f32_16x16x32_bf16 v[56:59], a[144:147], v[192:195], v[56:59]
  ds_read_b128 v[216:219], v173 offset:2048
  s_add_u32 s6, s59, 0
  v_mfma_f32_16x16x32_bf16 v[60:63], a[148:151], v[192:195], v[60:63]
  ds_read_b128 v[220:223], v173 offset:4096
  buffer_load_dwordx4 v187, s[8:11], s6 offen lds
  v_mfma_f32_16x16x32_bf16 v[64:67], v[192:195], a[152:155], v[64:67]
  ds_read_b128 v[224:227], v173 offset:6144
  s_add_u32 m0, s69, 98304
  v_mfma_f32_16x16x32_bf16 v[68:71], a[144:147], v[196:199], v[68:71]
  ds_read_b128 v[228:231], v173 offset:8192
  s_add_u32 s6, s59, 32768
  v_mfma_f32_16x16x32_bf16 v[72:75], a[148:151], v[196:199], v[72:75]
  ds_read_b128 v[232:235], v175 offset:0
  buffer_load_dwordx4 v187, s[8:11], s6 offen lds
  v_mfma_f32_16x16x32_bf16 v[76:79], v[196:199], a[152:155], v[76:79]
  ds_read_b128 v[236:239], v175 offset:2048
  s_add_u32 m0, s101, 102400
  v_mfma_f32_16x16x32_bf16 v[80:83], a[144:147], v[200:203], v[80:83]
  s_waitcnt lgkmcnt(7)
  ds_read_b128 v[240:243], v176 offset:8192
  s_add_u32 s6, s62, 0
  v_mfma_f32_16x16x32_bf16 v[84:87], a[148:151], v[200:203], v[84:87]
  buffer_load_dwordx4 v187, s[8:11], s6 offen lds
  v_mfma_f32_16x16x32_bf16 v[88:91], v[200:203], a[152:155], v[88:91]
  v_mfma_f32_16x16x32_bf16 v[92:95], a[144:147], v[204:207], v[92:95]
  v_lshlrev_b32 v40, 16, v244
  v_and_b32 v41, 0xffff0000, v244
  v_mfma_f32_16x16x32_bf16 v[96:99], a[148:151], v[204:207], v[96:99]
  v_mfma_f32_16x16x32_bf16 v[100:103], v[204:207], a[152:155], v[100:103]
  v_lshlrev_b32 v42, 16, v245
  v_and_b32 v43, 0xffff0000, v245
  v_mfma_f32_16x16x32_bf16 v[108:111], a[148:151], v[208:211], v[108:111]
  v_mfma_f32_16x16x32_bf16 v[112:115], v[208:211], a[152:155], v[112:115]
  v_lshlrev_b32 v44, 16, v246
  v_and_b32 v45, 0xffff0000, v246
  v_mfma_f32_16x16x32_bf16 v[32:35], a[156:159], v[28:31], v[32:35]
  v_mfma_f32_16x16x32_bf16 v[36:39], a[160:163], v[28:31], v[36:39]
  v_lshlrev_b32 v46, 16, v247
  v_and_b32 v47, 0xffff0000, v247
  v_mfma_f32_16x16x32_bf16 v[116:119], v[28:31], a[164:167], v[116:119]
  s_waitcnt lgkmcnt(0)
  v_mfma_f32_16x16x32_bf16 v[56:59], a[156:159], v[212:215], v[56:59]
  v_lshlrev_b32 v48, 16, v248
  v_and_b32 v49, 0xffff0000, v248
  v_mfma_f32_16x16x32_bf16 v[60:63], a[160:163], v[212:215], v[60:63]
  v_mfma_f32_16x16x32_bf16 v[64:67], v[212:215], a[164:167], v[64:67]
  v_lshlrev_b32 v50, 16, v249
  v_and_b32 v51, 0xffff0000, v249
  v_mfma_f32_16x16x32_bf16 v[68:71], a[156:159], v[216:219], v[68:71]
  v_mfma_f32_16x16x32_bf16 v[72:75], a[160:163], v[216:219], v[72:75]
  v_lshlrev_b32 v52, 16, v250
  v_and_b32 v53, 0xffff0000, v250
  v_mfma_f32_16x16x32_bf16 v[76:79], v[216:219], a[164:167], v[76:79]
  s_waitcnt vmcnt(9)
  s_barrier
  ds_read_b64_tr_b16 a[168:169], v174 offset:34816
  v_mfma_f32_16x16x32_bf16 v[80:83], a[156:159], v[220:223], v[80:83]
  ds_read_b64_tr_b16 a[170:171], v174 offset:35328
  s_add_u32 m0, s100, 104448
  s_add_u32 s6, s58, 196608
  buffer_load_dwordx4 v185, s[12:15], s6 offen offset:0 lds
  v_lshlrev_b32 v54, 16, v251
  v_and_b32 v55, 0xffff0000, v251
  v_mfma_f32_16x16x32_bf16 v[84:87], a[160:163], v[220:223], v[84:87]
  ds_read_b64_tr_b16 a[172:173], v174 offset:43008
  s_add_u32 s6, s58, 220160
  buffer_store_dword v26, v9, s[40:43], s87 offen sc1
  v_mfma_f32_16x16x32_bf16 v[88:91], v[220:223], a[164:167], v[88:91]
  ds_read_b64_tr_b16 a[174:175], v174 offset:43520
  buffer_load_dwordx4 v186, s[12:15], s6 offen offset:1024 lds
  v_mfma_f32_16x16x32_bf16 v[92:95], a[156:159], v[224:227], v[92:95]
  ds_read_b64_tr_b16 a[176:177], v174 offset:51200
  s_add_u32 m0, s100, 112640
  v_mfma_f32_16x16x32_bf16 v[96:99], a[160:163], v[224:227], v[96:99]
  ds_read_b64_tr_b16 a[178:179], v174 offset:51712
  s_add_u32 s6, s58, 197632
  v_mfma_f32_16x16x32_bf16 v[100:103], v[224:227], a[164:167], v[100:103]
  ds_read_b128 v[120:123], v172 offset:34816
  buffer_load_dwordx4 v185, s[12:15], s6 offen offset:0 lds
  v_mfma_f32_16x16x32_bf16 v[108:111], a[160:163], v[228:231], v[108:111]
  ds_read_b128 v[124:127], v172 offset:36864
  s_add_u32 s6, s58, 221184
  v_mfma_f32_16x16x32_bf16 v[112:115], v[228:231], a[164:167], v[112:115]
  ds_read_b128 v[128:131], v172 offset:38912
  v_mfma_f32_16x16x32_bf16 a[192:195], v[28:31], v[232:235], a[192:195]
  ds_read_b128 v[132:135], v172 offset:40960
  buffer_load_dwordx4 v186, s[12:15], s6 offen offset:1024 lds
  v_mfma_f32_16x16x32_bf16 a[204:207], v[232:235], v[232:235], a[204:207]
  ds_read_b128 v[136:139], v172 offset:43008
  s_add_u32 m0, s100, 120832
  v_mfma_f32_16x16x32_bf16 a[196:199], v[28:31], v[236:239], a[196:199]
  ds_read_b64_tr_b16 a[180:181], v174 offset:38912
  s_add_u32 s6, s58, 198656
  v_mfma_f32_16x16x32_bf16 a[208:211], v[236:239], v[236:239], a[208:211]
  ds_read_b64_tr_b16 a[182:183], v174 offset:39424
  buffer_load_dwordx4 v185, s[12:15], s6 offen offset:0 lds
  v_mfma_f32_16x16x32_bf16 a[200:203], v[28:31], v[240:243], a[200:203]
  ds_read_b64_tr_b16 a[184:185], v174 offset:47104
  s_add_u32 s6, s58, 222208
  v_mfma_f32_16x16x32_bf16 a[212:215], v[240:243], v[240:243], a[212:215]
  s_waitcnt lgkmcnt(7)
  ds_read_b64_tr_b16 a[186:187], v174 offset:47616
  v_mfma_f32_16x16x32_bf16 v[32:35], a[168:171], v[28:31], v[32:35]
  ds_read_b64_tr_b16 a[188:189], v174 offset:55296
  buffer_load_dwordx4 v186, s[12:15], s6 offen offset:1024 lds
  v_mfma_f32_16x16x32_bf16 v[36:39], a[172:175], v[28:31], v[36:39]
  ds_read_b64_tr_b16 a[190:191], v174 offset:55808
  s_add_u32 m0, s69, 129024
  v_mfma_f32_16x16x32_bf16 v[116:119], v[28:31], a[176:179], v[116:119]
  ds_read_b128 v[140:143], v173 offset:34816
  s_add_u32 s6, s59, 128
  v_mfma_f32_16x16x32_bf16 v[56:59], a[168:171], v[120:123], v[56:59]
  ds_read_b128 v[144:147], v173 offset:36864
  buffer_load_dwordx4 v187, s[8:11], s6 offen lds
  v_mfma_f32_16x16x32_bf16 v[60:63], a[172:175], v[120:123], v[60:63]
  ds_read_b128 v[148:151], v173 offset:38912
  s_add_u32 m0, s69, 133120
  v_mfma_f32_16x16x32_bf16 v[64:67], v[120:123], a[176:179], v[64:67]
  s_waitcnt lgkmcnt(7)
  ds_read_b128 v[152:155], v173 offset:40960
  s_add_u32 s6, s59, 32896
  v_mfma_f32_16x16x32_bf16 v[68:71], a[168:171], v[124:127], v[68:71]
  ds_read_b128 v[156:159], v173 offset:43008
  buffer_load_dwordx4 v187, s[8:11], s6 offen lds
  v_mfma_f32_16x16x32_bf16 v[72:75], a[172:175], v[124:127], v[72:75]
  ds_read_b128 v[160:163], v175 offset:34816
  s_add_u32 m0, s101, 137216
  v_mfma_f32_16x16x32_bf16 v[76:79], v[124:127], a[176:179], v[76:79]
  ds_read_b128 v[164:167], v175 offset:36864
  s_add_u32 s6, s62, 128
  v_mfma_f32_16x16x32_bf16 v[80:83], a[168:171], v[128:131], v[80:83]
  ds_read_b128 v[168:171], v176 offset:43008
  buffer_load_dwordx4 v187, s[8:11], s6 offen lds
  v_mfma_f32_16x16x32_bf16 v[84:87], a[172:175], v[128:131], v[84:87]
  v_mfma_f32_16x16x32_bf16 v[88:91], v[128:131], a[176:179], v[88:91]
  v_mfma_f32_16x16x32_bf16 v[92:95], a[168:171], v[132:135], v[92:95]
  v_mfma_f32_16x16x32_bf16 v[96:99], a[172:175], v[132:135], v[96:99]
  v_mfma_f32_16x16x32_bf16 v[100:103], v[132:135], a[176:179], v[100:103]
  v_mfma_f32_16x16x32_bf16 v[108:111], a[172:175], v[136:139], v[108:111]
  v_mfma_f32_16x16x32_bf16 v[112:115], v[136:139], a[176:179], v[112:115]
  v_mfma_f32_16x16x32_bf16 v[32:35], a[180:183], v[28:31], v[32:35]
  s_waitcnt lgkmcnt(1)
  v_mfma_f32_16x16x32_bf16 v[36:39], a[184:187], v[28:31], v[36:39]
  v_mfma_f32_16x16x32_bf16 v[116:119], v[28:31], a[188:191], v[116:119]
  v_mfma_f32_16x16x32_bf16 v[56:59], a[180:183], v[140:143], v[56:59]
  v_mfma_f32_16x16x32_bf16 v[60:63], a[184:187], v[140:143], v[60:63]
  v_mfma_f32_16x16x32_bf16 v[64:67], v[140:143], a[188:191], v[64:67]
  v_mfma_f32_16x16x32_bf16 v[68:71], a[180:183], v[144:147], v[68:71]
  v_mfma_f32_16x16x32_bf16 v[72:75], a[184:187], v[144:147], v[72:75]
  v_mfma_f32_16x16x32_bf16 v[76:79], v[144:147], a[188:191], v[76:79]
  s_waitcnt vmcnt(10)
  s_barrier
  ds_read_b64_tr_b16 a[0:1], v179 offset:0
  v_mfma_f32_16x16x32_bf16 v[80:83], a[180:183], v[148:151], v[80:83]
  ds_read_b64_tr_b16 a[2:3], v179 offset:512
  s_add_u32 m0, s55, 0
  s_add_u32 s6, s56, 0
  buffer_load_dwordx4 v4, s[16:19], s6 offen offset:0 lds
  v_mfma_f32_16x16x32_bf16 v[84:87], a[184:187], v[148:151], v[84:87]
  ds_read_b64_tr_b16 a[4:5], v179 offset:8192
  s_add_u32 s6, s56, 7168
  v_mfma_f32_16x16x32_bf16 v[88:91], v[148:151], a[188:191], v[88:91]
  ds_read_b64_tr_b16 a[6:7], v179 offset:8704
  v_mfma_f32_16x16x32_bf16 v[92:95], a[180:183], v[152:155], v[92:95]
  ds_read_b64_tr_b16 a[8:9], v179 offset:16384
  buffer_load_dwordx4 v4, s[16:19], s6 offen offset:1024 lds
  v_mfma_f32_16x16x32_bf16 v[96:99], a[184:187], v[152:155], v[96:99]
  ds_read_b64_tr_b16 a[10:11], v179 offset:16896
  s_add_u32 s6, s56, 14336
  v_mfma_f32_16x16x32_bf16 v[100:103], v[152:155], a[188:191], v[100:103]
  ds_read_b128 v[192:195], v177 offset:0
  v_mfma_f32_16x16x32_bf16 v[108:111], a[184:187], v[156:159], v[108:111]
  ds_read_b128 v[196:199], v177 offset:2048
  buffer_load_dwordx4 v4, s[16:19], s6 offen offset:2048 lds
  v_mfma_f32_16x16x32_bf16 v[112:115], v[156:159], a[188:191], v[112:115]
  ds_read_b128 v[200:203], v177 offset:4096
  s_add_u32 s6, s56, 21504
  v_mfma_f32_16x16x32_bf16 a[192:195], v[28:31], v[160:163], a[192:195]
  ds_read_b128 v[204:207], v177 offset:6144
  v_mfma_f32_16x16x32_bf16 a[204:207], v[160:163], v[160:163], a[204:207]
  ds_read_b128 v[208:211], v177 offset:8192
  buffer_load_dwordx4 v4, s[16:19], s6 offen offset:3072 lds
  v_mfma_f32_16x16x32_bf16 a[196:199], v[28:31], v[164:167], a[196:199]
  ds_read_b64_tr_b16 a[12:13], v179 offset:4096
  s_add_u32 m0, s55, 16384
  v_mfma_f32_16x16x32_bf16 a[208:211], v[164:167], v[164:167], a[208:211]
  s_waitcnt lgkmcnt(7)
  ds_read_b64_tr_b16 a[14:15], v179 offset:4608
  s_add_u32 s6, s56, 65536
  v_mfma_f32_16x16x32_bf16 a[200:203], v[28:31], v[168:171], a[200:203]
  ds_read_b64_tr_b16 a[16:17], v179 offset:12288
  buffer_load_dwordx4 v4, s[16:19], s6 offen offset:0 lds
  v_mfma_f32_16x16x32_bf16 a[212:215], v[168:171], v[168:171], a[212:215]
  ds_read_b64_tr_b16 a[18:19], v179 offset:12800
  s_add_u32 s6, s56, 72704
  v_mfma_f32_16x16x32_bf16 v[32:35], a[0:3], v[28:31], v[32:35]
  ds_read_b64_tr_b16 a[20:21], v179 offset:20480
  v_mfma_f32_16x16x32_bf16 v[36:39], a[4:7], v[28:31], v[36:39]
  s_waitcnt lgkmcnt(7)
  ds_read_b64_tr_b16 a[22:23], v179 offset:20992
  buffer_load_dwordx4 v4, s[16:19], s6 offen offset:1024 lds
  v_mfma_f32_16x16x32_bf16 v[116:119], v[28:31], a[8:11], v[116:119]
  ds_read_b128 v[212:215], v178 offset:0
  s_add_u32 s6, s56, 79872
  v_mfma_f32_16x16x32_bf16 v[56:59], a[0:3], v[192:195], v[56:59]
  ds_read_b128 v[216:219], v178 offset:2048
  v_mfma_f32_16x16x32_bf16 v[60:63], a[4:7], v[192:195], v[60:63]
  ds_read_b128 v[220:223], v178 offset:4096
  buffer_load_dwordx4 v4, s[16:19], s6 offen offset:2048 lds
  v_mfma_f32_16x16x32_bf16 v[64:67], v[192:195], a[8:11], v[64:67]
  ds_read_b128 v[224:227], v178 offset:6144
  s_add_u32 s6, s56, 87040
  v_mfma_f32_16x16x32_bf16 v[68:71], a[0:3], v[196:199], v[68:71]
  ds_read_b128 v[228:231], v178 offset:8192
  v_mfma_f32_16x16x32_bf16 v[72:75], a[4:7], v[196:199], v[72:75]
  ds_read_b128 v[232:235], v180 offset:0
  buffer_load_dwordx4 v4, s[16:19], s6 offen offset:3072 lds
  v_mfma_f32_16x16x32_bf16 v[76:79], v[196:199], a[8:11], v[76:79]
  ds_read_b128 v[236:239], v180 offset:2048
  v_mfma_f32_16x16x32_bf16 v[80:83], a[0:3], v[200:203], v[80:83]
  s_waitcnt lgkmcnt(7)
  ds_read_b128 v[240:243], v181 offset:8192
  v_mfma_f32_16x16x32_bf16 v[84:87], a[4:7], v[200:203], v[84:87]
  v_mfma_f32_16x16x32_bf16 v[88:91], v[200:203], a[8:11], v[88:91]
  v_mfma_f32_16x16x32_bf16 v[92:95], a[0:3], v[204:207], v[92:95]
  v_mfma_f32_16x16x32_bf16 v[96:99], a[4:7], v[204:207], v[96:99]
  v_mfma_f32_16x16x32_bf16 v[100:103], v[204:207], a[8:11], v[100:103]
  v_mfma_f32_16x16x32_bf16 v[108:111], a[4:7], v[208:211], v[108:111]
  v_mfma_f32_16x16x32_bf16 v[112:115], v[208:211], a[8:11], v[112:115]
  v_mfma_f32_16x16x32_bf16 v[32:35], a[12:15], v[28:31], v[32:35]
  v_mfma_f32_16x16x32_bf16 v[36:39], a[16:19], v[28:31], v[36:39]
  v_mfma_f32_16x16x32_bf16 v[116:119], v[28:31], a[20:23], v[116:119]
  s_waitcnt lgkmcnt(0)
  v_mfma_f32_16x16x32_bf16 v[56:59], a[12:15], v[212:215], v[56:59]
  v_mfma_f32_16x16x32_bf16 v[60:63], a[16:19], v[212:215], v[60:63]
  v_mfma_f32_16x16x32_bf16 v[64:67], v[212:215], a[20:23], v[64:67]
  v_mfma_f32_16x16x32_bf16 v[68:71], a[12:15], v[216:219], v[68:71]
  v_mfma_f32_16x16x32_bf16 v[72:75], a[16:19], v[216:219], v[72:75]
  v_mfma_f32_16x16x32_bf16 v[76:79], v[216:219], a[20:23], v[76:79]
  s_waitcnt vmcnt(8)
  s_barrier
  ds_read_b128 v[160:163], v180 offset:34816
  v_mfma_f32_16x16x32_bf16 v[80:83], a[12:15], v[220:223], v[80:83]
  ds_read_b128 v[164:167], v180 offset:36864
  v_mov_b32 v7, L_join-L_pc
  v_add_u32 v7, s39, v7
  global_load_dword v6, v7, s[90:91]
  s_add_u32 m0, s55, 32768
  s_add_u32 s6, s56, 131072
  v_mfma_f32_16x16x32_bf16 v[84:87], a[16:19], v[220:223], v[84:87]
  ds_read_b128 v[168:171], v181 offset:43008
  buffer_load_dwordx4 v4, s[16:19], s6 offen offset:0 lds
  v_mfma_f32_16x16x32_bf16 v[88:91], v[220:223], a[20:23], v[88:91]
  ds_read_b64_tr_b16 a[24:25], v179 offset:34816
  s_add_u32 s6, s56, 138240
  v_mfma_f32_16x16x32_bf16 v[92:95], a[12:15], v[224:227], v[92:95]
  ds_read_b64_tr_b16 a[26:27], v179 offset:35328
  v_mfma_f32_16x16x32_bf16 v[96:99], a[16:19], v[224:227], v[96:99]
  ds_read_b64_tr_b16 a[28:29], v179 offset:43008
  buffer_load_dwordx4 v4, s[16:19], s6 offen offset:1024 lds
  v_mfma_f32_16x16x32_bf16 v[100:103], v[224:227], a[20:23], v[100:103]
  ds_read_b64_tr_b16 a[30:31], v179 offset:43520
  s_add_u32 s6, s56, 145408
  v_mfma_f32_16x16x32_bf16 v[108:111], a[16:19], v[228:231], v[108:111]
  ds_read_b64_tr_b16 a[32:33], v179 offset:51200
  v_mfma_f32_16x16x32_bf16 v[112:115], v[228:231], a[20:23], v[112:115]
  ds_read_b64_tr_b16 a[34:35], v179 offset:51712
  buffer_load_dwordx4 v4, s[16:19], s6 offen offset:2048 lds
  v_mfma_f32_16x16x32_bf16 a[192:195], v[28:31], v[232:235], a[192:195]
  ds_read_b128 v[120:123], v177 offset:34816
  s_add_u32 s6, s56, 152576
  v_mfma_f32_16x16x32_bf16 a[204:207], v[232:235], v[232:235], a[204:207]
  ds_read_b128 v[124:127], v177 offset:36864
  v_mfma_f32_16x16x32_bf16 a[196:199], v[28:31], v[236:239], a[196:199]
  ds_read_b128 v[128:131], v177 offset:38912
  buffer_load_dwordx4 v4, s[16:19], s6 offen offset:3072 lds
  v_mfma_f32_16x16x32_bf16 a[208:211], v[236:239], v[236:239], a[208:211]
  ds_read_b128 v[132:135], v177 offset:40960
  s_add_u32 m0, s55, 49152
  v_mfma_f32_16x16x32_bf16 a[200:203], v[28:31], v[240:243], a[200:203]
  ds_read_b128 v[136:139], v177 offset:43008
  s_add_u32 s6, s56, 196608
  v_mfma_f32_16x16x32_bf16 a[212:215], v[240:243], v[240:243], a[212:215]
  s_waitcnt lgkmcnt(7)
  ds_read_b64_tr_b16 a[36:37], v179 offset:38912
  buffer_load_dwordx4 v4, s[16:19], s6 offen offset:0 lds
  v_mfma_f32_16x16x32_bf16 a[192:195], v[28:31], v[160:163], a[192:195]
  ds_read_b64_tr_b16 a[38:39], v179 offset:39424
  s_add_u32 s6, s56, 203776
  s_mul_i32 s3, s83, 768
  s_lshl_b32 s4, s84, 8
  s_add_u32 s3, s3, 148480
  v_add_u32 v201, s3, v17
  v_add_u32 v200, s4, v201
  v_mfma_f32_16x16x32_bf16 a[204:207], v[160:163], v[160:163], a[204:207]
  ds_read_b64_tr_b16 a[40:41], v179 offset:47104
  buffer_load_dwordx4 v4, s[16:19], s6 offen offset:1024 lds
  s_min_u32 s3, s53, 2
  s_lshl_b32 s3, s3, 8
  s_add_u32 s3, s3, 147456
  v_add_u32 v202, s3, v3
  v_mfma_f32_16x16x32_bf16 a[196:199], v[28:31], v[164:167], a[196:199]
  ds_read_b64_tr_b16 a[42:43], v179 offset:47616
  s_add_u32 s6, s56, 210944
  v_mfma_f32_16x16x32_bf16 a[208:211], v[164:167], v[164:167], a[208:211]
  ds_read_b64_tr_b16 a[44:45], v179 offset:55296
  buffer_load_dwordx4 v4, s[16:19], s6 offen offset:2048 lds
  v_mfma_f32_16x16x32_bf16 a[200:203], v[28:31], v[168:171], a[200:203]
  ds_read_b64_tr_b16 a[46:47], v179 offset:55808
  s_add_u32 s6, s56, 218112
  v_mfma_f32_16x16x32_bf16 a[212:215], v[168:171], v[168:171], a[212:215]
  ds_read_b128 v[140:143], v178 offset:34816
  v_accvgpr_read_b32 v205, a204
  v_accvgpr_read_b32 v206, a205
  v_accvgpr_read_b32 v207, a206
  v_accvgpr_read_b32 v208, a207
  v_mfma_f32_16x16x32_bf16 v[32:35], a[24:27], v[28:31], v[32:35]
  ds_read_b128 v[144:147], v178 offset:36864
  buffer_load_dwordx4 v4, s[16:19], s6 offen offset:3072 lds
  v_accvgpr_read_b32 v204, a192
  v_accvgpr_read_b32 v213, a208
  v_mfma_f32_16x16x32_bf16 v[36:39], a[28:31], v[28:31], v[36:39]
  s_waitcnt lgkmcnt(5)
  ds_read_b128 v[148:151], v178 offset:38912
  v_accvgpr_read_b32 v214, a209
  v_accvgpr_read_b32 v215, a210
  v_accvgpr_read_b32 v216, a211
  v_accvgpr_read_b32 v212, a196
  v_mfma_f32_16x16x32_bf16 v[116:119], v[28:31], a[32:35], v[116:119]
  ds_read_b128 v[152:155], v178 offset:40960
  v_accvgpr_read_b32 v221, a212
  v_accvgpr_read_b32 v222, a213
  v_mfma_f32_16x16x32_bf16 v[56:59], a[24:27], v[120:123], v[56:59]
  ds_read_b128 v[156:159], v178 offset:43008
  v_accvgpr_read_b32 v223, a214
  v_accvgpr_read_b32 v224, a215
  v_mfma_f32_16x16x32_bf16 v[60:63], a[28:31], v[120:123], v[60:63]
  v_accvgpr_read_b32 v220, a200
  v_cndmask_b32 v205, v205, v206, s[72:73]
  v_mfma_f32_16x16x32_bf16 v[64:67], v[120:123], a[32:35], v[64:67]
  v_cndmask_b32 v207, v207, v208, s[72:73]
  v_cndmask_b32 v213, v213, v214, s[72:73]
  v_mfma_f32_16x16x32_bf16 v[68:71], a[24:27], v[124:127], v[68:71]
  v_cndmask_b32 v215, v215, v216, s[72:73]
  v_cndmask_b32 v221, v221, v222, s[72:73]
  v_mfma_f32_16x16x32_bf16 v[72:75], a[28:31], v[124:127], v[72:75]
  v_cndmask_b32 v223, v223, v224, s[72:73]
  v_cndmask_b32 v205, v205, v207, s[80:81]
  v_mfma_f32_16x16x32_bf16 v[76:79], v[124:127], a[32:35], v[76:79]
  v_cndmask_b32 v213, v213, v215, s[80:81]
  v_cndmask_b32 v221, v221, v223, s[80:81]
  v_mfma_f32_16x16x32_bf16 v[80:83], a[24:27], v[128:131], v[80:83]
  v_mfma_f32_16x16x32_bf16 v[84:87], a[28:31], v[128:131], v[84:87]
  buffer_load_dword v189, v27, s[40:43], 0 offen sc1
  v_mfma_f32_16x16x32_bf16 v[88:91], v[128:131], a[32:35], v[88:91]
  s_mov_b32 exec_lo, 0x00f0000f
  s_mov_b32 exec_hi, 0xf0000f00
  ds_write2_b32 v200, v204, v205 offset0:0 offset1:32
  ds_write2_b32 v200, v212, v213 offset0:16 offset1:48
  ds_write2_b32 v201, v220, v221 offset0:144 offset1:176
  s_mov_b64 exec, -1
  v_mfma_f32_16x16x32_bf16 v[92:95], a[24:27], v[132:135], v[92:95]
  v_mfma_f32_16x16x32_bf16 v[96:99], a[28:31], v[132:135], v[96:99]
  v_mfma_f32_16x16x32_bf16 v[100:103], v[132:135], a[32:35], v[100:103]
  v_mfma_f32_16x16x32_bf16 v[108:111], a[28:31], v[136:139], v[108:111]
  v_mfma_f32_16x16x32_bf16 v[112:115], v[136:139], a[32:35], v[112:115]
  v_mfma_f32_16x16x32_bf16 v[32:35], a[36:39], v[28:31], v[32:35]
  s_waitcnt lgkmcnt(3)
  s_waitcnt lgkmcnt(0)
  s_barrier
  v_mfma_f32_16x16x32_bf16 v[36:39], a[40:43], v[28:31], v[36:39]
  ds_read_b32 v204, v202 offset:1024
  ds_read_b32 v205, v202 offset:1792
  v_mfma_f32_16x16x32_bf16 v[116:119], v[28:31], a[44:47], v[116:119]
  v_mfma_f32_16x16x32_bf16 v[56:59], a[36:39], v[140:143], v[56:59]
  v_mfma_f32_16x16x32_bf16 v[60:63], a[40:43], v[140:143], v[60:63]
  v_mfma_f32_16x16x32_bf16 v[64:67], v[140:143], a[44:47], v[64:67]
  v_mfma_f32_16x16x32_bf16 v[68:71], a[36:39], v[144:147], v[68:71]
  v_mfma_f32_16x16x32_bf16 v[72:75], a[40:43], v[144:147], v[72:75]
  v_mfma_f32_16x16x32_bf16 v[76:79], v[144:147], a[44:47], v[76:79]
  v_mfma_f32_16x16x32_bf16 v[80:83], a[36:39], v[148:151], v[80:83]
  v_mfma_f32_16x16x32_bf16 v[84:87], a[40:43], v[148:151], v[84:87]
  s_waitcnt lgkmcnt(0)
  v_add_f32 v204, v204, v205
  v_mfma_f32_16x16x32_bf16 v[88:91], v[148:151], a[44:47], v[88:91]
  v_mov_b32 v205, v204
  v_mfma_f32_16x16x32_bf16 v[92:95], a[36:39], v[152:155], v[92:95]
  s_nop 0
  v_permlane32_swap_b32 v204, v205
  v_mfma_f32_16x16x32_bf16 v[96:99], a[40:43], v[152:155], v[96:99]
  v_mul_f32 v206, 0x3b000000, v204
  v_mul_f32 v205, 0x3b000000, v205
  v_mfma_f32_16x16x32_bf16 v[100:103], v[152:155], a[44:47], v[100:103]
  v_fma_f32 v205, -v206, v206, v205
  v_mfma_f32_16x16x32_bf16 v[108:111], a[40:43], v[156:159], v[108:111]
  v_max_f32 v205, 0, v205
  v_mfma_f32_16x16x32_bf16 v[112:115], v[156:159], a[44:47], v[112:115]
  v_add_f32 v207, 0x3727c5ac, v205
  v_rsq_f32 v208, v207
  s_nop 0
  v_cndmask_b32 v206, v206, v208, s[78:79]
  ds_write_b32 v202, v206
  s_branch L_join
L_var2:
  s_add_u32 m0, s100, 69632
  s_add_u32 s6, s58, 1179648
  buffer_load_dwordx4 v185, s[12:15], s6 offen offset:0 lds
  s_add_u32 s6, s58, 1203200
  buffer_load_dwordx4 v186, s[12:15], s6 offen offset:1024 lds
  s_add_u32 m0, s100, 77824
  s_add_u32 s6, s58, 1180672
  buffer_load_dwordx4 v185, s[12:15], s6 offen offset:0 lds
  s_add_u32 s6, s58, 1204224
  buffer_load_dwordx4 v186, s[12:15], s6 offen offset:1024 lds
  s_add_u32 m0, s100, 86016
  s_add_u32 s6, s58, 1181696
  buffer_load_dwordx4 v185, s[12:15], s6 offen offset:0 lds
  s_add_u32 s6, s58, 1205248
  buffer_load_dwordx4 v186, s[12:15], s6 offen offset:1024 lds
  s_add_u32 m0, s69, 94208
  s_add_u32 s6, s59, 768
  buffer_load_dwordx4 v187, s[8:11], s6 offen lds
  s_add_u32 m0, s69, 98304
  s_add_u32 s6, s59, 33536
  buffer_load_dwordx4 v187, s[8:11], s6 offen lds
  s_add_u32 m0, s101, 102400
  s_add_u32 s6, s62, 768
  buffer_load_dwordx4 v187, s[8:11], s6 offen lds
  s_waitcnt vmcnt(18)
  s_waitcnt lgkmcnt(0)
  s_mul_i32 s37, s36, 0x9e3779c1
  s_barrier
  ds_read_b64_tr_b16 a[96:97], v174 offset:0
  ds_read_b64_tr_b16 a[98:99], v174 offset:512
  ds_read_b64_tr_b16 a[100:101], v174 offset:8192
  ds_read_b64_tr_b16 a[102:103], v174 offset:8704
  ds_read_b64_tr_b16 a[104:105], v174 offset:16384
  ds_read_b64_tr_b16 a[106:107], v174 offset:16896
  ds_read_b128 v[192:195], v172 offset:0
  ds_read_b128 v[196:199], v172 offset:2048
  ds_read_b128 v[200:203], v172 offset:4096
  ds_read_b128 v[204:207], v172 offset:6144
  ds_read_b128 v[208:211], v172 offset:8192
  ds_read_b64_tr_b16 a[108:109], v174 offset:4096
  s_waitcnt lgkmcnt(10)
  ds_read_b64_tr_b16 a[110:111], v174 offset:4608
  s_add_u32 m0, s55, 147456
  s_add_u32 s6, s22, 0
  buffer_load_dwordx4 v188, s[44:47], s6 offen offset:0 nt lds
  v_mfma_f32_16x16x32_bf16 v[32:35], a[96:99], v[28:31], 0
  s_waitcnt lgkmcnt(9)
  ds_read_b64_tr_b16 a[112:113], v174 offset:12288
  s_add_u32 m0, s55, 147456
  v_mfma_f32_16x16x32_bf16 v[36:39], a[100:103], v[28:31], 0
  s_waitcnt lgkmcnt(8)
  ds_read_b64_tr_b16 a[114:115], v174 offset:12800
  s_add_u32 s6, s22, 13312
  v_mfma_f32_16x16x32_bf16 v[116:119], v[28:31], a[104:107], 0
  s_waitcnt lgkmcnt(8)
  ds_read_b64_tr_b16 a[116:117], v174 offset:20480
  buffer_load_dwordx4 v188, s[44:47], s6 offen offset:1024 nt lds
  s_add_u32 s23, s23, s37
  s_add_u32 s23, s23, 32
  v_mov_b32 v26, s23
  v_mfma_f32_16x16x32_bf16 v[56:59], a[96:99], v[192:195], 0
  ds_read_b64_tr_b16 a[118:119], v174 offset:20992
  s_add_u32 m0, s55, 147456
  v_mfma_f32_16x16x32_bf16 v[60:63], a[100:103], v[192:195], 0
  ds_read_b128 v[212:215], v173 offset:0
  s_add_u32 s6, s22, 26624
  buffer_load_dwordx4 v188, s[44:47], s6 offen offset:2048 nt lds
  v_mfma_f32_16x16x32_bf16 v[64:67], v[192:195], a[104:107], 0
  s_waitcnt lgkmcnt(6)
  ds_read_b128 v[216:219], v173 offset:2048
  s_add_u32 m0, s55, 147456
  v_mfma_f32_16x16x32_bf16 v[68:71], a[96:99], v[196:199], 0
  ds_read_b128 v[220:223], v173 offset:4096
  s_add_u32 s6, s22, 39936
  v_mfma_f32_16x16x32_bf16 v[72:75], a[100:103], v[196:199], 0
  ds_read_b128 v[224:227], v173 offset:6144
  buffer_load_dwordx4 v188, s[44:47], s6 offen offset:3072 nt lds
  v_mfma_f32_16x16x32_bf16 v[76:79], v[196:199], a[104:107], 0
  ds_read_b128 v[228:231], v173 offset:8192
  s_add_u32 m0, s100, 139264
  v_mfma_f32_16x16x32_bf16 v[80:83], a[96:99], v[200:203], 0
  ds_read_b128 v[232:235], v175 offset:0
  v_mfma_f32_16x16x32_bf16 v[84:87], a[100:103], v[200:203], 0
  ds_read_b128 v[236:239], v175 offset:2048
  buffer_load_dwordx4 v2, s[28:31], s27 offen nt lds
  v_mfma_f32_16x16x32_bf16 v[88:91], v[200:203], a[104:107], 0
  ds_read_b128 v[240:243], v176 offset:8192
  v_mfma_f32_16x16x32_bf16 v[92:95], a[96:99], v[204:207], 0
  v_mfma_f32_16x16x32_bf16 v[96:99], a[100:103], v[204:207], 0
  buffer_load_dwordx4 v2, s[28:31], s27 offen offset:1024 nt lds
  v_mfma_f32_16x16x32_bf16 v[100:103], v[204:207], a[104:107], 0
  s_lshl_b32 s6, s48, 11
  v_mfma_f32_16x16x32_bf16 v[108:111], a[100:103], v[208:211], 0
  v_mfma_f32_16x16x32_bf16 v[112:115], v[208:211], a[104:107], 0
  s_waitcnt lgkmcnt(4)
  buffer_load_dword v253, v190, s[16:19], s6 offen
  s_and_b32 s6, s48, 31
  s_lshl_b32 s6, s6, 14
  buffer_load_dword v252, v254, s[16:19], s6 offen offset:384
  s_add_u32 m0, s100, 104448
  s_add_u32 s6, s58, 1376256
  buffer_load_dwordx4 v185, s[12:15], s6 offen offset:0 lds
  v_mfma_f32_16x16x32_bf16 v[32:35], a[108:111], v[28:31], v[32:35]
  s_add_u32 s6, s58, 1399808
  v_mfma_f32_16x16x32_bf16 v[36:39], a[112:115], v[28:31], v[36:39]
  v_mfma_f32_16x16x32_bf16 v[116:119], v[28:31], a[116:119], v[116:119]
  buffer_load_dwordx4 v186, s[12:15], s6 offen offset:1024 lds
  v_mfma_f32_16x16x32_bf16 v[56:59], a[108:111], v[212:215], v[56:59]
  s_add_u32 m0, s100, 112640
  s_add_u32 s6, s58, 1377280
  v_mfma_f32_16x16x32_bf16 v[60:63], a[112:115], v[212:215], v[60:63]
  v_mfma_f32_16x16x32_bf16 v[64:67], v[212:215], a[116:119], v[64:67]
  buffer_load_dwordx4 v185, s[12:15], s6 offen offset:0 lds
  v_mfma_f32_16x16x32_bf16 v[68:71], a[108:111], v[216:219], v[68:71]
  s_add_u32 s6, s58, 1400832
  v_mfma_f32_16x16x32_bf16 v[72:75], a[112:115], v[216:219], v[72:75]
  v_mfma_f32_16x16x32_bf16 v[76:79], v[216:219], a[116:119], v[76:79]
  s_waitcnt vmcnt(20)
  s_barrier
  ds_read_b64_tr_b16 a[120:121], v174 offset:34816
  buffer_load_dwordx4 v186, s[12:15], s6 offen offset:1024 lds
  v_mfma_f32_16x16x32_bf16 v[80:83], a[108:111], v[220:223], v[80:83]
  ds_read_b64_tr_b16 a[122:123], v174 offset:35328
  s_add_u32 m0, s100, 120832
  v_mfma_f32_16x16x32_bf16 v[84:87], a[112:115], v[220:223], v[84:87]
  ds_read_b64_tr_b16 a[124:125], v174 offset:43008
  s_add_u32 s6, s58, 1378304
  v_mfma_f32_16x16x32_bf16 v[88:91], v[220:223], a[116:119], v[88:91]
  ds_read_b64_tr_b16 a[126:127], v174 offset:43520
  buffer_load_dwordx4 v185, s[12:15], s6 offen offset:0 lds
  v_mfma_f32_16x16x32_bf16 v[92:95], a[108:111], v[224:227], v[92:95]
  ds_read_b64_tr_b16 a[128:129], v174 offset:51200
  s_add_u32 s6, s58, 1401856
  v_mfma_f32_16x16x32_bf16 v[96:99], a[112:115], v[224:227], v[96:99]
  ds_read_b64_tr_b16 a[130:131], v174 offset:51712
  v_mfma_f32_16x16x32_bf16 v[100:103], v[224:227], a[116:119], v[100:103]
  s_waitcnt lgkmcnt(6)
  ds_read_b128 v[120:123], v172 offset:34816
  buffer_load_dwordx4 v186, s[12:15], s6 offen offset:1024 lds
  v_mfma_f32_16x16x32_bf16 v[108:111], a[112:115], v[228:231], v[108:111]
  ds_read_b128 v[124:127], v172 offset:36864
  s_add_u32 m0, s69, 129024
  v_mfma_f32_16x16x32_bf16 v[112:115], v[228:231], a[116:119], v[112:115]
  ds_read_b128 v[128:131], v172 offset:38912
  s_add_u32 s6, s59, 896
  v_mfma_f32_16x16x32_bf16 a[192:195], v[28:31], v[232:235], 0
  ds_read_b128 v[132:135], v172 offset:40960
  buffer_load_dwordx4 v187, s[8:11], s6 offen lds
  v_mfma_f32_16x16x32_bf16 a[204:207], v[232:235], v[232:235], 0
  ds_read_b128 v[136:139], v172 offset:43008
  s_add_u32 m0, s69, 133120
  v_mfma_f32_16x16x32_bf16 a[196:199], v[28:31], v[236:239], 0
  ds_read_b64_tr_b16 a[132:133], v174 offset:38912
  s_add_u32 s6, s59, 33664
  v_mfma_f32_16x16x32_bf16 a[208:211], v[236:239], v[236:239], 0
  ds_read_b64_tr_b16 a[134:135], v174 offset:39424
  buffer_load_dwordx4 v187, s[8:11], s6 offen lds
  v_mfma_f32_16x16x32_bf16 a[200:203], v[28:31], v[240:243], 0
  ds_read_b64_tr_b16 a[136:137], v174 offset:47104
  s_add_u32 m0, s101, 137216
  v_mfma_f32_16x16x32_bf16 a[212:215], v[240:243], v[240:243], 0
  s_waitcnt lgkmcnt(7)
  ds_read_b64_tr_b16 a[138:139], v174 offset:47616
  s_add_u32 s6, s62, 896
  v_mfma_f32_16x16x32_bf16 v[32:35], a[120:123], v[28:31], v[32:35]
  ds_read_b64_tr_b16 a[140:141], v174 offset:55296
  buffer_load_dwordx4 v187, s[8:11], s6 offen lds
  v_mfma_f32_16x16x32_bf16 v[36:39], a[124:127], v[28:31], v[36:39]
  ds_read_b64_tr_b16 a[142:143], v174 offset:55808
  v_mfma_f32_16x16x32_bf16 v[116:119], v[28:31], a[128:131], v[116:119]
  ds_read_b128 v[140:143], v173 offset:34816
  v_mfma_f32_16x16x32_bf16 v[56:59], a[120:123], v[120:123], v[56:59]
  ds_read_b128 v[144:147], v173 offset:36864
  buffer_load_dwordx4 v[244:247], v15, s[8:11], s82 offen
  v_mfma_f32_16x16x32_bf16 v[60:63], a[124:127], v[120:123], v[60:63]
  ds_read_b128 v[148:151], v173 offset:38912
  v_mfma_f32_16x16x32_bf16 v[64:67], v[120:123], a[128:131], v[64:67]
  s_waitcnt lgkmcnt(7)
  ds_read_b128 v[152:155], v173 offset:40960
  v_mfma_f32_16x16x32_bf16 v[68:71], a[120:123], v[124:127], v[68:71]
  ds_read_b128 v[156:159], v173 offset:43008
  buffer_load_dwordx4 v[248:251], v15, s[8:11], s82 offen offset:16
  v_mfma_f32_16x16x32_bf16 v[72:75], a[124:127], v[124:127], v[72:75]
  ds_read_b128 v[160:163], v175 offset:34816
  v_mfma_f32_16x16x32_bf16 v[76:79], v[124:127], a[128:131], v[76:79]
  ds_read_b128 v[164:167], v175 offset:36864
  v_mfma_f32_16x16x32_bf16 v[80:83], a[120:123], v[128:131], v[80:83]
  ds_read_b128 v[168:171], v176 offset:43008
  v_mfma_f32_16x16x32_bf16 v[84:87], a[124:127], v[128:131], v[84:87]
  v_mfma_f32_16x16x32_bf16 v[88:91], v[128:131], a[128:131], v[88:91]
  v_mfma_f32_16x16x32_bf16 v[92:95], a[120:123], v[132:135], v[92:95]
  v_mfma_f32_16x16x32_bf16 v[96:99], a[124:127], v[132:135], v[96:99]
  v_mfma_f32_16x16x32_bf16 v[100:103], v[132:135], a[128:131], v[100:103]
  v_mfma_f32_16x16x32_bf16 v[108:111], a[124:127], v[136:139], v[108:111]
  v_mfma_f32_16x16x32_bf16 v[112:115], v[136:139], a[128:131], v[112:115]
  v_mfma_f32_16x16x32_bf16 v[32:35], a[132:135], v[28:31], v[32:35]
  s_waitcnt lgkmcnt(1)
  v_mfma_f32_16x16x32_bf16 v[36:39], a[136:139], v[28:31], v[36:39]
  v_mfma_f32_16x16x32_bf16 v[116:119], v[28:31], a[140:143], v[116:119]
  v_mfma_f32_16x16x32_bf16 v[56:59], a[132:135], v[140:143], v[56:59]
  v_mfma_f32_16x16x32_bf16 v[60:63], a[136:139], v[140:143], v[60:63]
  v_mfma_f32_16x16x32_bf16 v[64:67], v[140:143], a[140:143], v[64:67]
  v_mfma_f32_16x16x32_bf16 v[68:71], a[132:135], v[144:147], v[68:71]
  v_mfma_f32_16x16x32_bf16 v[72:75], a[136:139], v[144:147], v[72:75]
  v_mfma_f32_16x16x32_bf16 v[76:79], v[144:147], a[140:143], v[76:79]
  s_waitcnt vmcnt(19)
  s_barrier
  ds_read_b64_tr_b16 a[144:145], v179 offset:0
  v_mfma_f32_16x16x32_bf16 v[80:83], a[132:135], v[148:151], v[80:83]
  ds_read_b64_tr_b16 a[146:147], v179 offset:512
  s_add_u32 m0, s100, 0
  s_add_u32 s6, s58, 0
  buffer_load_dwordx4 v185, s[12:15], s6 offen offset:0 lds
  v_mfma_f32_16x16x32_bf16 v[84:87], a[136:139], v[148:151], v[84:87]
  ds_read_b64_tr_b16 a[148:149], v179 offset:8192
  s_add_u32 s6, s58, 23552
  v_mfma_f32_16x16x32_bf16 v[88:91], v[148:151], a[140:143], v[88:91]
  ds_read_b64_tr_b16 a[150:151], v179 offset:8704
  v_mfma_f32_16x16x32_bf16 v[92:95], a[132:135], v[152:155], v[92:95]
  ds_read_b64_tr_b16 a[152:153], v179 offset:16384
  buffer_load_dwordx4 v186, s[12:15], s6 offen offset:1024 lds
  v_mfma_f32_16x16x32_bf16 v[96:99], a[136:139], v[152:155], v[96:99]
  ds_read_b64_tr_b16 a[154:155], v179 offset:16896
  s_add_u32 m0, s100, 8192
  v_mfma_f32_16x16x32_bf16 v[100:103], v[152:155], a[140:143], v[100:103]
  ds_read_b128 v[192:195], v177 offset:0
  s_add_u32 s6, s58, 1024
  v_mfma_f32_16x16x32_bf16 v[108:111], a[136:139], v[156:159], v[108:111]
  ds_read_b128 v[196:199], v177 offset:2048
  buffer_load_dwordx4 v185, s[12:15], s6 offen offset:0 lds
  v_mfma_f32_16x16x32_bf16 v[112:115], v[156:159], a[140:143], v[112:115]
  ds_read_b128 v[200:203], v177 offset:4096
  s_add_u32 s6, s58, 24576
  v_mfma_f32_16x16x32_bf16 a[192:195], v[28:31], v[160:163], a[192:195]
  ds_read_b128 v[204:207], v177 offset:6144
  v_mfma_f32_16x16x32_bf16 a[204:207], v[160:163], v[160:163], a[204:207]
  ds_read_b128 v[208:211], v177 offset:8192
  buffer_load_dwordx4 v186, s[12:15], s6 offen offset:1024 lds
  v_mfma_f32_16x16x32_bf16 a[196:199], v[28:31], v[164:167], a[196:199]
  ds_read_b64_tr_b16 a[156:157], v179 offset:4096
  s_add_u32 m0, s100, 16384
  v_mfma_f32_16x16x32_bf16 a[208:211], v[164:167], v[164:167], a[208:211]
  s_waitcnt lgkmcnt(7)
  ds_read_b64_tr_b16 a[158:159], v179 offset:4608
  s_add_u32 s6, s58, 2048
  v_mfma_f32_16x16x32_bf16 a[200:203], v[28:31], v[168:171], a[200:203]
  ds_read_b64_tr_b16 a[160:161], v179 offset:12288
  buffer_load_dwordx4 v185, s[12:15], s6 offen offset:0 lds
  v_mfma_f32_16x16x32_bf16 a[212:215], v[168:171], v[168:171], a[212:215]
  ds_read_b64_tr_b16 a[162:163], v179 offset:12800
  s_add_u32 s6, s58, 25600
  v_mfma_f32_16x16x32_bf16 v[32:35], a[144:147], v[28:31], v[32:35]
  ds_read_b64_tr_b16 a[164:165], v179 offset:20480
  v_mfma_f32_16x16x32_bf16 v[36:39], a[148:151], v[28:31], v[36:39]
  s_waitcnt lgkmcnt(7)
  ds_read_b64_tr_b16 a[166:167], v179 offset:20992
  buffer_load_dwordx4 v186, s[12:15], s6 offen offset:1024 lds
  v_mfma_f32_16x16x32_bf16 v[116:119], v[28:31], a[152:155], v[116:119]
  ds_read_b128 v[212:215], v178 offset:0
  s_add_u32 m0, s69, 24576
  v_mfma_f32_16x16x32_bf16 v[56:59], a[144:147], v[192:195], v[56:59]
  ds_read_b128 v[216:219], v178 offset:2048
  s_add_u32 s6, s59, 0
  v_mfma_f32_16x16x32_bf16 v[60:63], a[148:151], v[192:195], v[60:63]
  ds_read_b128 v[220:223], v178 offset:4096
  buffer_load_dwordx4 v187, s[8:11], s6 offen lds
  v_mfma_f32_16x16x32_bf16 v[64:67], v[192:195], a[152:155], v[64:67]
  ds_read_b128 v[224:227], v178 offset:6144
  s_add_u32 m0, s69, 28672
  v_mfma_f32_16x16x32_bf16 v[68:71], a[144:147], v[196:199], v[68:71]
  ds_read_b128 v[228:231], v178 offset:8192
  s_add_u32 s6, s59, 32768
  v_mfma_f32_16x16x32_bf16 v[72:75], a[148:151], v[196:199], v[72:75]
  ds_read_b128 v[232:235], v180 offset:0
  buffer_load_dwordx4 v187, s[8:11], s6 offen lds
  v_mfma_f32_16x16x32_bf16 v[76:79], v[196:199], a[152:155], v[76:79]
  ds_read_b128 v[236:239], v180 offset:2048
  s_add_u32 m0, s101, 32768
  v_mfma_f32_16x16x32_bf16 v[80:83], a[144:147], v[200:203], v[80:83]
  s_waitcnt lgkmcnt(7)
  ds_read_b128 v[240:243], v181 offset:8192
  s_add_u32 s6, s62, 0
  v_mfma_f32_16x16x32_bf16 v[84:87], a[148:151], v[200:203], v[84:87]
  buffer_load_dwordx4 v187, s[8:11], s6 offen lds
  v_mfma_f32_16x16x32_bf16 v[88:91], v[200:203], a[152:155], v[88:91]
  v_mfma_f32_16x16x32_bf16 v[92:95], a[144:147], v[204:207], v[92:95]
  v_mfma_f32_16x16x32_bf16 v[96:99], a[148:151], v[204:207], v[96:99]
  v_mfma_f32_16x16x32_bf16 v[100:103], v[204:207], a[152:155], v[100:103]
  v_mfma_f32_16x16x32_bf16 v[108:111], a[148:151], v[208:211], v[108:111]
  v_mfma_f32_16x16x32_bf16 v[112:115], v[208:211], a[152:155], v[112:115]
  v_mfma_f32_16x16x32_bf16 v[32:35], a[156:159], v[28:31], v[32:35]
  v_mfma_f32_16x16x32_bf16 v[36:39], a[160:163], v[28:31], v[36:39]
  v_mfma_f32_16x16x32_bf16 v[116:119], v[28:31], a[164:167], v[116:119]
  s_waitcnt lgkmcnt(0)
  v_mfma_f32_16x16x32_bf16 v[56:59], a[156:159], v[212:215], v[56:59]
  v_mfma_f32_16x16x32_bf16 v[60:63], a[160:163], v[212:215], v[60:63]
  v_mfma_f32_16x16x32_bf16 v[64:67], v[212:215], a[164:167], v[64:67]
  v_mfma_f32_16x16x32_bf16 v[68:71], a[156:159], v[216:219], v[68:71]
  v_mfma_f32_16x16x32_bf16 v[72:75], a[160:163], v[216:219], v[72:75]
  v_mfma_f32_16x16x32_bf16 v[76:79], v[216:219], a[164:167], v[76:79]
  s_waitcnt vmcnt(11)
  s_barrier
  ds_read_b64_tr_b16 a[168:169], v179 offset:34816
  v_mfma_f32_16x16x32_bf16 v[80:83], a[156:159], v[220:223], v[80:83]
  ds_read_b64_tr_b16 a[170:171], v179 offset:35328
  s_add_u32 m0, s100, 34816
  s_add_u32 s6, s58, 196608
  buffer_load_dwordx4 v185, s[12:15], s6 offen offset:0 lds
  v_mfma_f32_16x16x32_bf16 v[84:87], a[160:163], v[220:223], v[84:87]
  ds_read_b64_tr_b16 a[172:173], v179 offset:43008
  s_add_u32 s6, s58, 220160
  v_mfma_f32_16x16x32_bf16 v[88:91], v[220:223], a[164:167], v[88:91]
  ds_read_b64_tr_b16 a[174:175], v179 offset:43520
  ds_read_b64_tr_b16 a[216:217], v182 offset:0
  v_mfma_f32_16x16x32_bf16 v[92:95], a[156:159], v[224:227], v[92:95]
  ds_read_b64_tr_b16 a[176:177], v179 offset:51200
  buffer_load_dwordx4 v186, s[12:15], s6 offen offset:1024 lds
  v_mfma_f32_16x16x32_bf16 v[96:99], a[160:163], v[224:227], v[96:99]
  ds_read_b64_tr_b16 a[178:179], v179 offset:51712
  s_add_u32 m0, s100, 43008
  v_mfma_f32_16x16x32_bf16 v[100:103], v[224:227], a[164:167], v[100:103]
  ds_read_b128 v[120:123], v177 offset:34816
  s_add_u32 s6, s58, 197632
  v_mfma_f32_16x16x32_bf16 v[108:111], a[160:163], v[228:231], v[108:111]
  ds_read_b128 v[124:127], v177 offset:36864
  buffer_load_dwordx4 v185, s[12:15], s6 offen offset:0 lds
  v_mfma_f32_16x16x32_bf16 v[112:115], v[228:231], a[164:167], v[112:115]
  ds_read_b128 v[128:131], v177 offset:38912
  s_add_u32 s6, s58, 221184
  v_mfma_f32_16x16x32_bf16 a[192:195], v[28:31], v[232:235], a[192:195]
  ds_read_b128 v[132:135], v177 offset:40960
  ds_read_b64_tr_b16 a[218:219], v182 offset:1024
  v_mfma_f32_16x16x32_bf16 a[204:207], v[232:235], v[232:235], a[204:207]
  ds_read_b128 v[136:139], v177 offset:43008
  buffer_load_dwordx4 v186, s[12:15], s6 offen offset:1024 lds
  v_mfma_f32_16x16x32_bf16 a[196:199], v[28:31], v[236:239], a[196:199]
  ds_read_b64_tr_b16 a[180:181], v179 offset:38912
  s_add_u32 m0, s100, 51200
  v_mfma_f32_16x16x32_bf16 a[208:211], v[236:239], v[236:239], a[208:211]
  ds_read_b64_tr_b16 a[182:183], v179 offset:39424
  s_add_u32 s6, s58, 198656
  v_mfma_f32_16x16x32_bf16 a[200:203], v[28:31], v[240:243], a[200:203]
  s_waitcnt lgkmcnt(8)
  ds_read_b64_tr_b16 a[184:185], v179 offset:47104
  buffer_load_dwordx4 v185, s[12:15], s6 offen offset:0 lds
  v_mfma_f32_16x16x32_bf16 a[212:215], v[240:243], v[240:243], a[212:215]
  ds_read_b64_tr_b16 a[186:187], v179 offset:47616
  s_add_u32 s6, s58, 222208
  v_mfma_f32_16x16x32_bf16 v[32:35], a[168:171], v[28:31], v[32:35]
  ds_read_b64_tr_b16 a[188:189], v179 offset:55296
  ds_read_b64_tr_b16 a[220:221], v182 offset:4096
  v_mfma_f32_16x16x32_bf16 v[36:39], a[172:175], v[28:31], v[36:39]
  ds_read_b64_tr_b16 a[190:191], v179 offset:55808
  buffer_load_dwordx4 v186, s[12:15], s6 offen offset:1024 lds
  v_mfma_f32_16x16x32_bf16 v[116:119], v[28:31], a[176:179], v[116:119]
  s_waitcnt lgkmcnt(8)
  ds_read_b128 v[140:143], v178 offset:34816
  s_add_u32 m0, s69, 59392
  v_mfma_f32_16x16x32_bf16 v[56:59], a[168:171], v[120:123], v[56:59]
  ds_read_b128 v[144:147], v178 offset:36864
  s_add_u32 s6, s59, 128
  ds_read_b64_tr_b16 a[222:223], v182 offset:5120
  ds_read_b64_tr_b16 a[224:225], v183 offset:0
  buffer_load_dwordx4 v187, s[8:11], s6 offen lds
  v_mfma_f32_16x16x32_bf16 v[60:63], a[172:175], v[120:123], v[60:63]
  ds_read_b128 v[148:151], v178 offset:38912
  s_add_u32 m0, s69, 63488
  ds_read_b64_tr_b16 a[226:227], v183 offset:1024
  v_mfma_f32_16x16x32_bf16 v[64:67], v[120:123], a[176:179], v[64:67]
  ds_read_b128 v[152:155], v178 offset:40960
  s_add_u32 s6, s59, 32896
  s_waitcnt lgkmcnt(10)
  ds_read_b64_tr_b16 a[228:229], v183 offset:4096
  buffer_load_dwordx4 v187, s[8:11], s6 offen lds
  v_mfma_f32_16x16x32_bf16 v[68:71], a[168:171], v[124:127], v[68:71]
  ds_read_b128 v[156:159], v178 offset:43008
  s_add_u32 m0, s101, 67584
  ds_read_b64_tr_b16 a[230:231], v183 offset:5120
  ds_read_b64_tr_b16 a[248:249], v6 offset:0
  v_mfma_f32_16x16x32_bf16 v[72:75], a[172:175], v[124:127], v[72:75]
  ds_read_b128 v[160:163], v180 offset:34816
  s_add_u32 s6, s62, 128
  buffer_load_dwordx4 v187, s[8:11], s6 offen lds
  s_waitcnt lgkmcnt(10)
  ds_read_b64_tr_b16 a[250:251], v6 offset:4096
  v_mfma_f32_16x16x32_bf16 v[76:79], v[124:127], a[176:179], v[76:79]
  ds_read_b128 v[164:167], v180 offset:36864
  ds_read_b64_tr_b16 a[252:253], v6 offset:128
  ds_read_b64_tr_b16 a[254:255], v6 offset:4224
  v_mfma_f32_16x16x32_bf16 v[80:83], a[168:171], v[128:131], v[80:83]
  ds_read_b128 v[168:171], v181 offset:43008
  buffer_store_dwordx4 a[216:219], v2, s[40:43], s96 offen sc1
  v_mfma_f32_16x16x32_bf16 v[84:87], a[172:175], v[128:131], v[84:87]
  s_waitcnt lgkmcnt(12)
  buffer_store_dwordx4 a[220:223], v2, s[40:43], s97 offen sc1
  v_mfma_f32_16x16x32_bf16 v[88:91], v[128:131], a[176:179], v[88:91]
  s_waitcnt lgkmcnt(10)
  buffer_store_dwordx4 a[224:227], v2, s[40:43], s98 offen sc1
  v_mfma_f32_16x16x32_bf16 v[92:95], a[168:171], v[132:135], v[92:95]
  v_mfma_f32_16x16x32_bf16 v[96:99], a[172:175], v[132:135], v[96:99]
  v_mfma_f32_16x16x32_bf16 v[100:103], v[132:135], a[176:179], v[100:103]
  s_waitcnt lgkmcnt(6)
  buffer_store_dwordx4 a[228:231], v2, s[40:43], s98 offen offset:1024 sc1
  v_mfma_f32_16x16x32_bf16 v[108:111], a[172:175], v[136:139], v[108:111]
  v_mfma_f32_16x16x32_bf16 v[112:115], v[136:139], a[176:179], v[112:115]
  s_waitcnt lgkmcnt(3)
  buffer_store_dwordx4 a[248:251], v7, s[40:43], s21 offen sc1
  v_mfma_f32_16x16x32_bf16 v[32:35], a[180:183], v[28:31], v[32:35]
  s_waitcnt lgkmcnt(1)
  buffer_store_dwordx4 a[252:255], v7, s[40:43], s26 offen sc1
  v_mfma_f32_32x32x16_bf16 a[232:247], v[28:31], a[216:219], 0
  v_mfma_f32_32x32x16_bf16 a[232:247], v[28:31], a[220:223], a[232:247]
  v_mfma_f32_16x16x32_bf16 v[36:39], a[184:187], v[28:31], v[36:39]
  v_mfma_f32_16x16x32_bf16 v[116:119], v[28:31], a[188:191], v[116:119]
  v_mfma_f32_16x16x32_bf16 v[56:59], a[180:183], v[140:143], v[56:59]
  v_mfma_f32_16x16x32_bf16 v[60:63], a[184:187], v[140:143], v[60:63]
  s_nop 7
  buffer_store_dword a232, v184, s[40:43], s99 offen sc1
  v_mfma_f32_32x32x16_bf16 a[232:247], v[28:31], a[224:227], 0
  v_mfma_f32_32x32x16_bf16 a[232:247], v[28:31], a[228:231], a[232:247]
  v_mfma_f32_16x16x32_bf16 v[64:67], v[140:143], a[188:191], v[64:67]
  v_mfma_f32_16x16x32_bf16 v[68:71], a[180:183], v[144:147], v[68:71]
  v_mfma_f32_16x16x32_bf16 v[72:75], a[184:187], v[144:147], v[72:75]
  v_mfma_f32_16x16x32_bf16 v[76:79], v[144:147], a[188:191], v[76:79]
  s_nop 7
  buffer_store_dword a232, v184, s[40:43], s20 offen sc1
  s_waitcnt vmcnt(17)
  s_barrier
  ds_read_b64_tr_b16 a[0:1], v174 offset:0
  v_mfma_f32_16x16x32_bf16 v[80:83], a[180:183], v[148:151], v[80:83]
  ds_read_b64_tr_b16 a[2:3], v174 offset:512
  s_add_u32 m0, s100, 69632
  s_add_u32 s6, s58, 393216
  buffer_load_dwordx4 v185, s[12:15], s6 offen offset:0 lds
  v_mfma_f32_16x16x32_bf16 v[84:87], a[184:187], v[148:151], v[84:87]
  ds_read_b64_tr_b16 a[4:5], v174 offset:8192
  s_add_u32 s6, s58, 416768
  v_mfma_f32_16x16x32_bf16 v[88:91], v[148:151], a[188:191], v[88:91]
  ds_read_b64_tr_b16 a[6:7], v174 offset:8704
  v_mfma_f32_16x16x32_bf16 v[92:95], a[180:183], v[152:155], v[92:95]
  ds_read_b64_tr_b16 a[8:9], v174 offset:16384
  buffer_load_dwordx4 v186, s[12:15], s6 offen offset:1024 lds
  v_mfma_f32_16x16x32_bf16 v[96:99], a[184:187], v[152:155], v[96:99]
  ds_read_b64_tr_b16 a[10:11], v174 offset:16896
  s_add_u32 m0, s100, 77824
  v_mfma_f32_16x16x32_bf16 v[100:103], v[152:155], a[188:191], v[100:103]
  ds_read_b128 v[192:195], v172 offset:0
  s_add_u32 s6, s58, 394240
  v_mfma_f32_16x16x32_bf16 v[108:111], a[184:187], v[156:159], v[108:111]
  ds_read_b128 v[196:199], v172 offset:2048
  buffer_load_dwordx4 v185, s[12:15], s6 offen offset:0 lds
  v_mfma_f32_16x16x32_bf16 v[112:115], v[156:159], a[188:191], v[112:115]
  ds_read_b128 v[200:203], v172 offset:4096
  s_add_u32 s6, s58, 417792
  v_mfma_f32_16x16x32_bf16 a[192:195], v[28:31], v[160:163], a[192:195]
  ds_read_b128 v[204:207], v172 offset:6144
  v_mfma_f32_16x16x32_bf16 a[204:207], v[160:163], v[160:163], a[204:207]
  ds_read_b128 v[208:211], v172 offset:8192
  buffer_load_dwordx4 v186, s[12:15], s6 offen offset:1024 lds
  v_mfma_f32_16x16x32_bf16 a[196:199], v[28:31], v[164:167], a[196:199]
  ds_read_b64_tr_b16 a[12:13], v174 offset:4096
  s_add_u32 m0, s100, 86016
  v_mfma_f32_16x16x32_bf16 a[208:211], v[164:167], v[164:167], a[208:211]
  s_waitcnt lgkmcnt(7)
  ds_read_b64_tr_b16 a[14:15], v174 offset:4608
  s_add_u32 s6, s58, 395264
  v_mfma_f32_16x16x32_bf16 a[200:203], v[28:31], v[168:171], a[200:203]
  ds_read_b64_tr_b16 a[16:17], v174 offset:12288
  buffer_load_dwordx4 v185, s[12:15], s6 offen offset:0 lds
  v_mfma_f32_16x16x32_bf16 a[212:215], v[168:171], v[168:171], a[212:215]
  ds_read_b64_tr_b16 a[18:19], v174 offset:12800
  s_add_u32 s6, s58, 418816
  v_mfma_f32_16x16x32_bf16 v[32:35], a[0:3], v[28:31], v[32:35]
  ds_read_b64_tr_b16 a[20:21], v174 offset:20480
  v_mfma_f32_16x16x32_bf16 v[36:39], a[4:7], v[28:31], v[36:39]
  s_waitcnt lgkmcnt(7)
  ds_read_b64_tr_b16 a[22:23], v174 offset:20992
  buffer_load_dwordx4 v186, s[12:15], s6 offen offset:1024 lds
  v_mfma_f32_16x16x32_bf16 v[116:119], v[28:31], a[8:11], v[116:119]
  ds_read_b128 v[212:215], v173 offset:0
  s_add_u32 m0, s69, 94208
  v_mfma_f32_16x16x32_bf16 v[56:59], a[0:3], v[192:195], v[56:59]
  ds_read_b128 v[216:219], v173 offset:2048
  s_add_u32 s6, s59, 256
  v_mfma_f32_16x16x32_bf16 v[60:63], a[4:7], v[192:195], v[60:63]
  ds_read_b128 v[220:223], v173 offset:4096
  buffer_load_dwordx4 v187, s[8:11], s6 offen lds
  v_mfma_f32_16x16x32_bf16 v[64:67], v[192:195], a[8:11], v[64:67]
  ds_read_b128 v[224:227], v173 offset:6144
  s_add_u32 m0, s69, 98304
  v_mfma_f32_16x16x32_bf16 v[68:71], a[0:3], v[196:199], v[68:71]
  ds_read_b128 v[228:231], v173 offset:8192
  s_add_u32 s6, s59, 33024
  v_mfma_f32_16x16x32_bf16 v[72:75], a[4:7], v[196:199], v[72:75]
  ds_read_b128 v[232:235], v175 offset:0
  buffer_load_dwordx4 v187, s[8:11], s6 offen lds
  v_mfma_f32_16x16x32_bf16 v[76:79], v[196:199], a[8:11], v[76:79]
  ds_read_b128 v[236:239], v175 offset:2048
  s_add_u32 m0, s101, 102400
  v_mfma_f32_16x16x32_bf16 v[80:83], a[0:3], v[200:203], v[80:83]
  s_waitcnt lgkmcnt(7)
  ds_read_b128 v[240:243], v176 offset:8192
  s_add_u32 s6, s62, 256
  v_mfma_f32_16x16x32_bf16 v[84:87], a[4:7], v[200:203], v[84:87]
  buffer_load_dwordx4 v187, s[8:11], s6 offen lds
  v_mfma_f32_16x16x32_bf16 v[88:91], v[200:203], a[8:11], v[88:91]
  v_mfma_f32_16x16x32_bf16 v[92:95], a[0:3], v[204:207], v[92:95]
  v_lshlrev_b32 v40, 16, v244
  v_and_b32 v41, 0xffff0000, v244
  v_mfma_f32_16x16x32_bf16 v[96:99], a[4:7], v[204:207], v[96:99]
  v_mfma_f32_16x16x32_bf16 v[100:103], v[204:207], a[8:11], v[100:103]
  v_lshlrev_b32 v42, 16, v245
  v_and_b32 v43, 0xffff0000, v245
  v_mfma_f32_16x16x32_bf16 v[108:111], a[4:7], v[208:211], v[108:111]
  v_mfma_f32_16x16x32_bf16 v[112:115], v[208:211], a[8:11], v[112:115]
  v_lshlrev_b32 v44, 16, v246
  v_and_b32 v45, 0xffff0000, v246
  v_mfma_f32_16x16x32_bf16 v[32:35], a[12:15], v[28:31], v[32:35]
  v_mfma_f32_16x16x32_bf16 v[36:39], a[16:19], v[28:31], v[36:39]
  v_lshlrev_b32 v46, 16, v247
  v_and_b32 v47, 0xffff0000, v247
  v_mfma_f32_16x16x32_bf16 v[116:119], v[28:31], a[20:23], v[116:119]
  s_waitcnt lgkmcnt(0)
  v_mfma_f32_16x16x32_bf16 v[56:59], a[12:15], v[212:215], v[56:59]
  v_lshlrev_b32 v48, 16, v248
  v_and_b32 v49, 0xffff0000, v248
  v_mfma_f32_16x16x32_bf16 v[60:63], a[16:19], v[212:215], v[60:63]
  v_mfma_f32_16x16x32_bf16 v[64:67], v[212:215], a[20:23], v[64:67]
  v_lshlrev_b32 v50, 16, v249
  v_and_b32 v51, 0xffff0000, v249
  v_mfma_f32_16x16x32_bf16 v[68:71], a[12:15], v[216:219], v[68:71]
  v_mfma_f32_16x16x32_bf16 v[72:75], a[16:19], v[216:219], v[72:75]
  v_lshlrev_b32 v52, 16, v250
  v_and_b32 v53, 0xffff0000, v250
  v_mfma_f32_16x16x32_bf16 v[76:79], v[216:219], a[20:23], v[76:79]
  s_waitcnt vmcnt(9)
  s_barrier
  ds_read_b64_tr_b16 a[24:25], v174 offset:34816
  v_mfma_f32_16x16x32_bf16 v[80:83], a[12:15], v[220:223], v[80:83]
  ds_read_b64_tr_b16 a[26:27], v174 offset:35328
  s_add_u32 m0, s100, 104448
  s_add_u32 s6, s58, 589824
  buffer_load_dwordx4 v185, s[12:15], s6 offen offset:0 lds
  v_lshlrev_b32 v54, 16, v251
  v_and_b32 v55, 0xffff0000, v251
  v_mfma_f32_16x16x32_bf16 v[84:87], a[16:19], v[220:223], v[84:87]
  ds_read_b64_tr_b16 a[28:29], v174 offset:43008
  s_add_u32 s6, s58, 613376
  buffer_store_dword v26, v9, s[40:43], s87 offen sc1
  v_mfma_f32_16x16x32_bf16 v[88:91], v[220:223], a[20:23], v[88:91]
  ds_read_b64_tr_b16 a[30:31], v174 offset:43520
  buffer_load_dwordx4 v186, s[12:15], s6 offen offset:1024 lds
  v_mfma_f32_16x16x32_bf16 v[92:95], a[12:15], v[224:227], v[92:95]
  ds_read_b64_tr_b16 a[32:33], v174 offset:51200
  s_add_u32 m0, s100, 112640
  v_mfma_f32_16x16x32_bf16 v[96:99], a[16:19], v[224:227], v[96:99]
  ds_read_b64_tr_b16 a[34:35], v174 offset:51712
  s_add_u32 s6, s58, 590848
  v_mfma_f32_16x16x32_bf16 v[100:103], v[224:227], a[20:23], v[100:103]
  ds_read_b128 v[120:123], v172 offset:34816
  buffer_load_dwordx4 v185, s[12:15], s6 offen offset:0 lds
  v_mfma_f32_16x16x32_bf16 v[108:111], a[16:19], v[228:231], v[108:111]
  ds_read_b128 v[124:127], v172 offset:36864
  s_add_u32 s6, s58, 614400
  v_mfma_f32_16x16x32_bf16 v[112:115], v[228:231], a[20:23], v[112:115]
  ds_read_b128 v[128:131], v172 offset:38912
  v_mfma_f32_16x16x32_bf16 a[192:195], v[28:31], v[232:235], a[192:195]
  ds_read_b128 v[132:135], v172 offset:40960
  buffer_load_dwordx4 v186, s[12:15], s6 offen offset:1024 lds
  v_mfma_f32_16x16x32_bf16 a[204:207], v[232:235], v[232:235], a[204:207]
  ds_read_b128 v[136:139], v172 offset:43008
  s_add_u32 m0, s100, 120832
  v_mfma_f32_16x16x32_bf16 a[196:199], v[28:31], v[236:239], a[196:199]
  ds_read_b64_tr_b16 a[36:37], v174 offset:38912
  s_add_u32 s6, s58, 591872
  v_mfma_f32_16x16x32_bf16 a[208:211], v[236:239], v[236:239], a[208:211]
  ds_read_b64_tr_b16 a[38:39], v174 offset:39424
  buffer_load_dwordx4 v185, s[12:15], s6 offen offset:0 lds
  v_mfma_f32_16x16x32_bf16 a[200:203], v[28:31], v[240:243], a[200:203]
  ds_read_b64_tr_b16 a[40:41], v174 offset:47104
  s_add_u32 s6, s58, 615424
  v_mfma_f32_16x16x32_bf16 a[212:215], v[240:243], v[240:243], a[212:215]
  s_waitcnt lgkmcnt(7)
  ds_read_b64_tr_b16 a[42:43], v174 offset:47616
  v_mfma_f32_16x16x32_bf16 v[32:35], a[24:27], v[28:31], v[32:35]
  ds_read_b64_tr_b16 a[44:45], v174 offset:55296
  buffer_load_dwordx4 v186, s[12:15], s6 offen offset:1024 lds
  v_mfma_f32_16x16x32_bf16 v[36:39], a[28:31], v[28:31], v[36:39]
  ds_read_b64_tr_b16 a[46:47], v174 offset:55808
  s_add_u32 m0, s69, 129024
  v_mfma_f32_16x16x32_bf16 v[116:119], v[28:31], a[32:35], v[116:119]
  ds_read_b128 v[140:143], v173 offset:34816
  s_add_u32 s6, s59, 384
  v_mfma_f32_16x16x32_bf16 v[56:59], a[24:27], v[120:123], v[56:59]
  ds_read_b128 v[144:147], v173 offset:36864
  buffer_load_dwordx4 v187, s[8:11], s6 offen lds
  v_mfma_f32_16x16x32_bf16 v[60:63], a[28:31], v[120:123], v[60:63]
  ds_read_b128 v[148:151], v173 offset:38912
  s_add_u32 m0, s69, 133120
  v_mfma_f32_16x16x32_bf16 v[64:67], v[120:123], a[32:35], v[64:67]
  s_waitcnt lgkmcnt(7)
  ds_read_b128 v[152:155], v173 offset:40960
  s_add_u32 s6, s59, 33152
  v_mfma_f32_16x16x32_bf16 v[68:71], a[24:27], v[124:127], v[68:71]
  ds_read_b128 v[156:159], v173 offset:43008
  buffer_load_dwordx4 v187, s[8:11], s6 offen lds
  v_mfma_f32_16x16x32_bf16 v[72:75], a[28:31], v[124:127], v[72:75]
  ds_read_b128 v[160:163], v175 offset:34816
  s_add_u32 m0, s101, 137216
  v_mfma_f32_16x16x32_bf16 v[76:79], v[124:127], a[32:35], v[76:79]
  ds_read_b128 v[164:167], v175 offset:36864
  s_add_u32 s6, s62, 384
  v_mfma_f32_16x16x32_bf16 v[80:83], a[24:27], v[128:131], v[80:83]
  ds_read_b128 v[168:171], v176 offset:43008
  buffer_load_dwordx4 v187, s[8:11], s6 offen lds
  v_mfma_f32_16x16x32_bf16 v[84:87], a[28:31], v[128:131], v[84:87]
  v_mfma_f32_16x16x32_bf16 v[88:91], v[128:131], a[32:35], v[88:91]
  v_mfma_f32_16x16x32_bf16 v[92:95], a[24:27], v[132:135], v[92:95]
  v_mfma_f32_16x16x32_bf16 v[96:99], a[28:31], v[132:135], v[96:99]
  v_mfma_f32_16x16x32_bf16 v[100:103], v[132:135], a[32:35], v[100:103]
  v_mfma_f32_16x16x32_bf16 v[108:111], a[28:31], v[136:139], v[108:111]
  v_mfma_f32_16x16x32_bf16 v[112:115], v[136:139], a[32:35], v[112:115]
  v_mfma_f32_16x16x32_bf16 v[32:35], a[36:39], v[28:31], v[32:35]
  s_waitcnt lgkmcnt(1)
  v_mfma_f32_16x16x32_bf16 v[36:39], a[40:43], v[28:31], v[36:39]
  v_mfma_f32_16x16x32_bf16 v[116:119], v[28:31], a[44:47], v[116:119]
  v_mfma_f32_16x16x32_bf16 v[56:59], a[36:39], v[140:143], v[56:59]
  v_mfma_f32_16x16x32_bf16 v[60:63], a[40:43], v[140:143], v[60:63]
  v_mfma_f32_16x16x32_bf16 v[64:67], v[140:143], a[44:47], v[64:67]
  v_mfma_f32_16x16x32_bf16 v[68:71], a[36:39], v[144:147], v[68:71]
  v_mfma_f32_16x16x32_bf16 v[72:75], a[40:43], v[144:147], v[72:75]
  v_mfma_f32_16x16x32_bf16 v[76:79], v[144:147], a[44:47], v[76:79]
  s_waitcnt vmcnt(10)
  s_barrier
  ds_read_b64_tr_b16 a[48:49], v179 offset:0
  v_mfma_f32_16x16x32_bf16 v[80:83], a[36:39], v[148:151], v[80:83]
  ds_read_b64_tr_b16 a[50:51], v179 offset:512
  s_add_u32 m0, s55, 0
  s_add_u32 s6, s56, 0
  buffer_load_dwordx4 v4, s[16:19], s6 offen offset:0 lds
  v_mfma_f32_16x16x32_bf16 v[84:87], a[40:43], v[148:151], v[84:87]
  ds_read_b64_tr_b16 a[52:53], v179 offset:8192
  s_add_u32 s6, s56, 7168
  v_mfma_f32_16x16x32_bf16 v[88:91], v[148:151], a[44:47], v[88:91]
  ds_read_b64_tr_b16 a[54:55], v179 offset:8704
  v_mfma_f32_16x16x32_bf16 v[92:95], a[36:39], v[152:155], v[92:95]
  ds_read_b64_tr_b16 a[56:57], v179 offset:16384
  buffer_load_dwordx4 v4, s[16:19], s6 offen offset:1024 lds
  v_mfma_f32_16x16x32_bf16 v[96:99], a[40:43], v[152:155], v[96:99]
  ds_read_b64_tr_b16 a[58:59], v179 offset:16896
  s_add_u32 s6, s56, 14336
  v_mfma_f32_16x16x32_bf16 v[100:103], v[152:155], a[44:47], v[100:103]
  ds_read_b128 v[192:195], v177 offset:0
  v_mfma_f32_16x16x32_bf16 v[108:111], a[40:43], v[156:159], v[108:111]
  ds_read_b128 v[196:199], v177 offset:2048
  buffer_load_dwordx4 v4, s[16:19], s6 offen offset:2048 lds
  v_mfma_f32_16x16x32_bf16 v[112:115], v[156:159], a[44:47], v[112:115]
  ds_read_b128 v[200:203], v177 offset:4096
  s_add_u32 s6, s56, 21504
  v_mfma_f32_16x16x32_bf16 a[192:195], v[28:31], v[160:163], a[192:195]
  ds_read_b128 v[204:207], v177 offset:6144
  v_mfma_f32_16x16x32_bf16 a[204:207], v[160:163], v[160:163], a[204:207]
  ds_read_b128 v[208:211], v177 offset:8192
  buffer_load_dwordx4 v4, s[16:19], s6 offen offset:3072 lds
  v_mfma_f32_16x16x32_bf16 a[196:199], v[28:31], v[164:167], a[196:199]
  ds_read_b64_tr_b16 a[60:61], v179 offset:4096
  s_add_u32 m0, s55, 16384
  v_mfma_f32_16x16x32_bf16 a[208:211], v[164:167], v[164:167], a[208:211]
  s_waitcnt lgkmcnt(7)
  ds_read_b64_tr_b16 a[62:63], v179 offset:4608
  s_add_u32 s6, s56, 65536
  v_mfma_f32_16x16x32_bf16 a[200:203], v[28:31], v[168:171], a[200:203]
  ds_read_b64_tr_b16 a[64:65], v179 offset:12288
  buffer_load_dwordx4 v4, s[16:19], s6 offen offset:0 lds
  v_mfma_f32_16x16x32_bf16 a[212:215], v[168:171], v[168:171], a[212:215]
  ds_read_b64_tr_b16 a[66:67], v179 offset:12800
  s_add_u32 s6, s56, 72704
  v_mfma_f32_16x16x32_bf16 v[32:35], a[48:51], v[28:31], v[32:35]
  ds_read_b64_tr_b16 a[68:69], v179 offset:20480
  v_mfma_f32_16x16x32_bf16 v[36:39], a[52:55], v[28:31], v[36:39]
  s_waitcnt lgkmcnt(7)
  ds_read_b64_tr_b16 a[70:71], v179 offset:20992
  buffer_load_dwordx4 v4, s[16:19], s6 offen offset:1024 lds
  v_mfma_f32_16x16x32_bf16 v[116:119], v[28:31], a[56:59], v[116:119]
  ds_read_b128 v[212:215], v178 offset:0
  s_add_u32 s6, s56, 79872
  v_mfma_f32_16x16x32_bf16 v[56:59], a[48:51], v[192:195], v[56:59]
  ds_read_b128 v[216:219], v178 offset:2048
  v_mfma_f32_16x16x32_bf16 v[60:63], a[52:55], v[192:195], v[60:63]
  ds_read_b128 v[220:223], v178 offset:4096
  buffer_load_dwordx4 v4, s[16:19], s6 offen offset:2048 lds
  v_mfma_f32_16x16x32_bf16 v[64:67], v[192:195], a[56:59], v[64:67]
  ds_read_b128 v[224:227], v178 offset:6144
  s_add_u32 s6, s56, 87040
  v_mfma_f32_16x16x32_bf16 v[68:71], a[48:51], v[196:199], v[68:71]
  ds_read_b128 v[228:231], v178 offset:8192
  v_mfma_f32_16x16x32_bf16 v[72:75], a[52:55], v[196:199], v[72:75]
  ds_read_b128 v[232:235], v180 offset:0
  buffer_load_dwordx4 v4, s[16:19], s6 offen offset:3072 lds
  v_mfma_f32_16x16x32_bf16 v[76:79], v[196:199], a[56:59], v[76:79]
  ds_read_b128 v[236:239], v180 offset:2048
  v_mfma_f32_16x16x32_bf16 v[80:83], a[48:51], v[200:203], v[80:83]
  s_waitcnt lgkmcnt(7)
  ds_read_b128 v[240:243], v181 offset:8192
  v_mfma_f32_16x16x32_bf16 v[84:87], a[52:55], v[200:203], v[84:87]
  v_mfma_f32_16x16x32_bf16 v[88:91], v[200:203], a[56:59], v[88:91]
  v_mfma_f32_16x16x32_bf16 v[92:95], a[48:51], v[204:207], v[92:95]
  v_mfma_f32_16x16x32_bf16 v[96:99], a[52:55], v[204:207], v[96:99]
  v_mfma_f32_16x16x32_bf16 v[100:103], v[204:207], a[56:59], v[100:103]
  v_mfma_f32_16x16x32_bf16 v[108:111], a[52:55], v[208:211], v[108:111]
  v_mfma_f32_16x16x32_bf16 v[112:115], v[208:211], a[56:59], v[112:115]
  v_mfma_f32_16x16x32_bf16 v[32:35], a[60:63], v[28:31], v[32:35]
  v_mfma_f32_16x16x32_bf16 v[36:39], a[64:67], v[28:31], v[36:39]
  v_mfma_f32_16x16x32_bf16 v[116:119], v[28:31], a[68:71], v[116:119]
  s_waitcnt lgkmcnt(0)
  v_mfma_f32_16x16x32_bf16 v[56:59], a[60:63], v[212:215], v[56:59]
  v_mfma_f32_16x16x32_bf16 v[60:63], a[64:67], v[212:215], v[60:63]
  v_mfma_f32_16x16x32_bf16 v[64:67], v[212:215], a[68:71], v[64:67]
  v_mfma_f32_16x16x32_bf16 v[68:71], a[60:63], v[216:219], v[68:71]
  v_mfma_f32_16x16x32_bf16 v[72:75], a[64:67], v[216:219], v[72:75]
  v_mfma_f32_16x16x32_bf16 v[76:79], v[216:219], a[68:71], v[76:79]
  s_waitcnt vmcnt(8)
  s_barrier
  ds_read_b128 v[160:163], v180 offset:34816
  v_mfma_f32_16x16x32_bf16 v[80:83], a[60:63], v[220:223], v[80:83]
  ds_read_b128 v[164:167], v180 offset:36864
  v_mov_b32 v7, L_join-L_pc
  v_add_u32 v7, s39, v7
  global_load_dword v6, v7, s[90:91]
  s_add_u32 m0, s55, 32768
  s_add_u32 s6, s56, 131072
  v_mfma_f32_16x16x32_bf16 v[84:87], a[64:67], v[220:223], v[84:87]
  ds_read_b128 v[168:171], v181 offset:43008
  buffer_load_dwordx4 v4, s[16:19], s6 offen offset:0 lds
  v_mfma_f32_16x16x32_bf16 v[88:91], v[220:223], a[68:71], v[88:91]
  ds_read_b64_tr_b16 a[72:73], v179 offset:34816
  s_add_u32 s6, s56, 138240
  v_mfma_f32_16x16x32_bf16 v[92:95], a[60:63], v[224:227], v[92:95]
  ds_read_b64_tr_b16 a[74:75], v179 offset:35328
  v_mfma_f32_16x16x32_bf16 v[96:99], a[64:67], v[224:227], v[96:99]
  ds_read_b64_tr_b16 a[76:77], v179 offset:43008
  buffer_load_dwordx4 v4, s[16:19], s6 offen offset:1024 lds
  v_mfma_f32_16x16x32_bf16 v[100:103], v[224:227], a[68:71], v[100:103]
  ds_read_b64_tr_b16 a[78:79], v179 offset:43520
  s_add_u32 s6, s56, 145408
  v_mfma_f32_16x16x32_bf16 v[108:111], a[64:67], v[228:231], v[108:111]
  ds_read_b64_tr_b16 a[80:81], v179 offset:51200
  v_mfma_f32_16x16x32_bf16 v[112:115], v[228:231], a[68:71], v[112:115]
  ds_read_b64_tr_b16 a[82:83], v179 offset:51712
  buffer_load_dwordx4 v4, s[16:19], s6 offen offset:2048 lds
  v_mfma_f32_16x16x32_bf16 a[192:195], v[28:31], v[232:235], a[192:195]
  ds_read_b128 v[120:123], v177 offset:34816
  s_add_u32 s6, s56, 152576
  v_mfma_f32_16x16x32_bf16 a[204:207], v[232:235], v[232:235], a[204:207]
  ds_read_b128 v[124:127], v177 offset:36864
  v_mfma_f32_16x16x32_bf16 a[196:199], v[28:31], v[236:239], a[196:199]
  ds_read_b128 v[128:131], v177 offset:38912
  buffer_load_dwordx4 v4, s[16:19], s6 offen offset:3072 lds
  v_mfma_f32_16x16x32_bf16 a[208:211], v[236:239], v[236:239], a[208:211]
  ds_read_b128 v[132:135], v177 offset:40960
  s_add_u32 m0, s55, 49152
  v_mfma_f32_16x16x32_bf16 a[200:203], v[28:31], v[240:243], a[200:203]
  ds_read_b128 v[136:139], v177 offset:43008
  s_add_u32 s6, s56, 196608
  v_mfma_f32_16x16x32_bf16 a[212:215], v[240:243], v[240:243], a[212:215]
  s_waitcnt lgkmcnt(7)
  ds_read_b64_tr_b16 a[84:85], v179 offset:38912
  buffer_load_dwordx4 v4, s[16:19], s6 offen offset:0 lds
  v_mfma_f32_16x16x32_bf16 a[192:195], v[28:31], v[160:163], a[192:195]
  ds_read_b64_tr_b16 a[86:87], v179 offset:39424
  s_add_u32 s6, s56, 203776
  s_mul_i32 s3, s83, 768
  s_lshl_b32 s4, s84, 8
  s_add_u32 s3, s3, 148480
  v_add_u32 v201, s3, v17
  v_add_u32 v200, s4, v201
  v_mfma_f32_16x16x32_bf16 a[204:207], v[160:163], v[160:163], a[204:207]
  ds_read_b64_tr_b16 a[88:89], v179 offset:47104
  buffer_load_dwordx4 v4, s[16:19], s6 offen offset:1024 lds
  s_min_u32 s3, s53, 2
  s_lshl_b32 s3, s3, 8
  s_add_u32 s3, s3, 147456
  v_add_u32 v202, s3, v3
  v_mfma_f32_16x16x32_bf16 a[196:199], v[28:31], v[164:167], a[196:199]
  ds_read_b64_tr_b16 a[90:91], v179 offset:47616
  s_add_u32 s6, s56, 210944
  v_mfma_f32_16x16x32_bf16 a[208:211], v[164:167], v[164:167], a[208:211]
  ds_read_b64_tr_b16 a[92:93], v179 offset:55296
  buffer_load_dwordx4 v4, s[16:19], s6 offen offset:2048 lds
  v_mfma_f32_16x16x32_bf16 a[200:203], v[28:31], v[168:171], a[200:203]
  ds_read_b64_tr_b16 a[94:95], v179 offset:55808
  s_add_u32 s6, s56, 218112
  v_mfma_f32_16x16x32_bf16 a[212:215], v[168:171], v[168:171], a[212:215]
  ds_read_b128 v[140:143], v178 offset:34816
  v_accvgpr_read_b32 v205, a204
  v_accvgpr_read_b32 v206, a205
  v_accvgpr_read_b32 v207, a206
  v_accvgpr_read_b32 v208, a207
  v_mfma_f32_16x16x32_bf16 v[32:35], a[72:75], v[28:31], v[32:35]
  ds_read_b128 v[144:147], v178 offset:36864
  buffer_load_dwordx4 v4, s[16:19], s6 offen offset:3072 lds
  v_accvgpr_read_b32 v204, a192
  v_accvgpr_read_b32 v213, a208
  v_mfma_f32_16x16x32_bf16 v[36:39], a[76:79], v[28:31], v[36:39]
  s_waitcnt lgkmcnt(5)
  ds_read_b128 v[148:151], v178 offset:38912
  v_accvgpr_read_b32 v214, a209
  v_accvgpr_read_b32 v215, a210
  v_accvgpr_read_b32 v216, a211
  v_accvgpr_read_b32 v212, a196
  v_mfma_f32_16x16x32_bf16 v[116:119], v[28:31], a[80:83], v[116:119]
  ds_read_b128 v[152:155], v178 offset:40960
  v_accvgpr_read_b32 v221, a212
  v_accvgpr_read_b32 v222, a213
  v_mfma_f32_16x16x32_bf16 v[56:59], a[72:75], v[120:123], v[56:59]
  ds_read_b128 v[156:159], v178 offset:43008
  v_accvgpr_read_b32 v223, a214
  v_accvgpr_read_b32 v224, a215
  v_mfma_f32_16x16x32_bf16 v[60:63], a[76:79], v[120:123], v[60:63]
  v_accvgpr_read_b32 v220, a200
  v_cndmask_b32 v205, v205, v206, s[72:73]
  v_mfma_f32_16x16x32_bf16 v[64:67], v[120:123], a[80:83], v[64:67]
  v_cndmask_b32 v207, v207, v208, s[72:73]
  v_cndmask_b32 v213, v213, v214, s[72:73]
  v_mfma_f32_16x16x32_bf16 v[68:71], a[72:75], v[124:127], v[68:71]
  v_cndmask_b32 v215, v215, v216, s[72:73]
  v_cndmask_b32 v221, v221, v222, s[72:73]
  v_mfma_f32_16x16x32_bf16 v[72:75], a[76:79], v[124:127], v[72:75]
  v_cndmask_b32 v223, v223, v224, s[72:73]
  v_cndmask_b32 v205, v205, v207, s[80:81]
  v_mfma_f32_16x16x32_bf16 v[76:79], v[124:127], a[80:83], v[76:79]
  v_cndmask_b32 v213, v213, v215, s[80:81]
  v_cndmask_b32 v221, v221, v223, s[80:81]
  v_mfma_f32_16x16x32_bf16 v[80:83], a[72:75], v[128:131], v[80:83]
  v_mfma_f32_16x16x32_bf16 v[84:87], a[76:79], v[128:131], v[84:87]
  buffer_load_dword v189, v27, s[40:43], 0 offen sc1
  v_mfma_f32_16x16x32_bf16 v[88:91], v[128:131], a[80:83], v[88:91]
  s_mov_b32 exec_lo, 0x00f0000f
  s_mov_b32 exec_hi, 0xf0000f00
  ds_write2_b32 v200, v204, v205 offset0:0 offset1:32
  ds_write2_b32 v200, v212, v213 offset0:16 offset1:48
  ds_write2_b32 v201, v220, v221 offset0:144 offset1:176
  s_mov_b64 exec, -1
  v_mfma_f32_16x16x32_bf16 v[92:95], a[72:75], v[132:135], v[92:95]
  v_mfma_f32_16x16x32_bf16 v[96:99], a[76:79], v[132:135], v[96:99]
  v_mfma_f32_16x16x32_bf16 v[100:103], v[132:135], a[80:83], v[100:103]
  v_mfma_f32_16x16x32_bf16 v[108:111], a[76:79], v[136:139], v[108:111]
  v_mfma_f32_16x16x32_bf16 v[112:115], v[136:139], a[80:83], v[112:115]
  v_mfma_f32_16x16x32_bf16 v[32:35], a[84:87], v[28:31], v[32:35]
  s_waitcnt lgkmcnt(3)
  s_waitcnt lgkmcnt(0)
  s_barrier
  v_mfma_f32_16x16x32_bf16 v[36:39], a[88:91], v[28:31], v[36:39]
  ds_read_b32 v204, v202 offset:1024
  ds_read_b32 v205, v202 offset:1792
  v_mfma_f32_16x16x32_bf16 v[116:119], v[28:31], a[92:95], v[116:119]
  v_mfma_f32_16x16x32_bf16 v[56:59], a[84:87], v[140:143], v[56:59]
  v_mfma_f32_16x16x32_bf16 v[60:63], a[88:91], v[140:143], v[60:63]
  v_mfma_f32_16x16x32_bf16 v[64:67], v[140:143], a[92:95], v[64:67]
  v_mfma_f32_16x16x32_bf16 v[68:71], a[84:87], v[144:147], v[68:71]
  v_mfma_f32_16x16x32_bf16 v[72:75], a[88:91], v[144:147], v[72:75]
  v_mfma_f32_16x16x32_bf16 v[76:79], v[144:147], a[92:95], v[76:79]
  v_mfma_f32_16x16x32_bf16 v[80:83], a[84:87], v[148:151], v[80:83]
  v_mfma_f32_16x16x32_bf16 v[84:87], a[88:91], v[148:151], v[84:87]
  s_waitcnt lgkmcnt(0)
  v_add_f32 v204, v204, v205
  v_mfma_f32_16x16x32_bf16 v[88:91], v[148:151], a[92:95], v[88:91]
  v_mov_b32 v205, v204
  v_mfma_f32_16x16x32_bf16 v[92:95], a[84:87], v[152:155], v[92:95]
  s_nop 0
  v_permlane32_swap_b32 v204, v205
  v_mfma_f32_16x16x32_bf16 v[96:99], a[88:91], v[152:155], v[96:99]
  v_mul_f32 v206, 0x3b000000, v204
  v_mul_f32 v205, 0x3b000000, v205
  v_mfma_f32_16x16x32_bf16 v[100:103], v[152:155], a[92:95], v[100:103]
  v_fma_f32 v205, -v206, v206, v205
  v_mfma_f32_16x16x32_bf16 v[108:111], a[88:91], v[156:159], v[108:111]
  v_max_f32 v205, 0, v205
  v_mfma_f32_16x16x32_bf16 v[112:115], v[156:159], a[92:95], v[112:115]
  v_add_f32 v207, 0x3727c5ac, v205
  v_rsq_f32 v208, v207
  s_nop 0
  v_cndmask_b32 v206, v206, v208, s[78:79]
  ds_write_b32 v202, v206
  s_branch L_join
L_var3:
  s_add_u32 m0, s100, 69632
  s_add_u32 s6, s58, 0
  buffer_load_dwordx4 v185, s[12:15], s6 offen offset:0 lds
  s_add_u32 s6, s58, 23552
  buffer_load_dwordx4 v186, s[12:15], s6 offen offset:1024 lds
  s_add_u32 m0, s100, 77824
  s_add_u32 s6, s58, 1024
  buffer_load_dwordx4 v185, s[12:15], s6 offen offset:0 lds
  s_add_u32 s6, s58, 24576
  buffer_load_dwordx4 v186, s[12:15], s6 offen offset:1024 lds
  s_add_u32 m0, s100, 86016
  s_add_u32 s6, s58, 2048
  buffer_load_dwordx4 v185, s[12:15], s6 offen offset:0 lds
  s_add_u32 s6, s58, 25600
  buffer_load_dwordx4 v186, s[12:15], s6 offen offset:1024 lds
  s_add_u32 m0, s69, 94208
  s_add_u32 s6, s59, 0
  buffer_load_dwordx4 v187, s[8:11], s6 offen lds
  s_add_u32 m0, s69, 98304
  s_add_u32 s6, s59, 32768
  buffer_load_dwordx4 v187, s[8:11], s6 offen lds
  s_add_u32 m0, s101, 102400
  s_add_u32 s6, s62, 0
  buffer_load_dwordx4 v187, s[8:11], s6 offen lds
  s_waitcnt vmcnt(18)
  s_waitcnt lgkmcnt(0)
  s_mul_i32 s37, s36, 0x9e3779c1
  s_barrier
  ds_read_b64_tr_b16 a[144:145], v174 offset:0
  ds_read_b64_tr_b16 a[146:147], v174 offset:512
  ds_read_b64_tr_b16 a[148:149], v174 offset:8192
  ds_read_b64_tr_b16 a[150:151], v174 offset:8704
  ds_read_b64_tr_b16 a[152:153], v174 offset:16384
  ds_read_b64_tr_b16 a[154:155], v174 offset:16896
  ds_read_b128 v[192:195], v172 offset:0
  ds_read_b128 v[196:199], v172 offset:2048
  ds_read_b128 v[200:203], v172 offset:4096
  ds_read_b128 v[204:207], v172 offset:6144
  ds_read_b128 v[208:211], v172 offset:8192
  ds_read_b64_tr_b16 a[156:157], v174 offset:4096
  s_waitcnt lgkmcnt(10)
  ds_read_b64_tr_b16 a[158:159], v174 offset:4608
  s_lshl_b32 s6, s48, 11
  buffer_load_dword v253, v190, s[16:19], s6 offen
  s_and_b32 s6, s48, 31
  s_lshl_b32 s6, s6, 14
  buffer_load_dword v252, v254, s[16:19], s6 offen offset:384
  s_add_u32 m0, s100, 104448
  s_add_u32 s6, s58, 196608
  buffer_load_dwordx4 v185, s[12:15], s6 offen offset:0 lds
  v_mfma_f32_16x16x32_bf16 v[32:35], a[144:147], v[28:31], 0
  s_waitcnt lgkmcnt(9)
  ds_read_b64_tr_b16 a[160:161], v174 offset:12288
  s_add_u32 s6, s58, 220160
  v_mfma_f32_16x16x32_bf16 v[36:39], a[148:151], v[28:31], 0
  s_waitcnt lgkmcnt(8)
  ds_read_b64_tr_b16 a[162:163], v174 offset:12800
  v_mfma_f32_16x16x32_bf16 v[116:119], v[28:31], a[152:155], 0
  s_waitcnt lgkmcnt(8)
  ds_read_b64_tr_b16 a[164:165], v174 offset:20480
  buffer_load_dwordx4 v186, s[12:15], s6 offen offset:1024 lds
  s_add_u32 s23, s23, s37
  s_add_u32 s23, s23, 32
  v_mov_b32 v26, s23
  v_mfma_f32_16x16x32_bf16 v[56:59], a[144:147], v[192:195], 0
  ds_read_b64_tr_b16 a[166:167], v174 offset:20992
  s_add_u32 m0, s100, 112640
  v_mfma_f32_16x16x32_bf16 v[60:63], a[148:151], v[192:195], 0
  ds_read_b128 v[212:215], v173 offset:0
  s_add_u32 s6, s58, 197632
  buffer_load_dwordx4 v185, s[12:15], s6 offen offset:0 lds
  v_mfma_f32_16x16x32_bf16 v[64:67], v[192:195], a[152:155], 0
  s_waitcnt lgkmcnt(5)
  ds_read_b128 v[216:219], v173 offset:2048
  s_add_u32 s6, s58, 221184
  v_mfma_f32_16x16x32_bf16 v[68:71], a[144:147], v[196:199], 0
  ds_read_b128 v[220:223], v173 offset:4096
  v_mfma_f32_16x16x32_bf16 v[72:75], a[148:151], v[196:199], 0
  ds_read_b128 v[224:227], v173 offset:6144
  buffer_load_dwordx4 v186, s[12:15], s6 offen offset:1024 lds
  v_mfma_f32_16x16x32_bf16 v[76:79], v[196:199], a[152:155], 0
  ds_read_b128 v[228:231], v173 offset:8192
  s_add_u32 m0, s100, 120832
  v_mfma_f32_16x16x32_bf16 v[80:83], a[144:147], v[200:203], 0
  ds_read_b128 v[232:235], v175 offset:0
  s_add_u32 s6, s58, 198656
  v_mfma_f32_16x16x32_bf16 v[84:87], a[148:151], v[200:203], 0
  ds_read_b128 v[236:239], v175 offset:2048
  buffer_load_dwordx4 v185, s[12:15], s6 offen offset:0 lds
  v_mfma_f32_16x16x32_bf16 v[88:91], v[200:203], a[152:155], 0
  ds_read_b128 v[240:243], v176 offset:8192
  s_add_u32 s6, s58, 222208
  v_mfma_f32_16x16x32_bf16 v[92:95], a[144:147], v[204:207], 0
  v_mfma_f32_16x16x32_bf16 v[96:99], a[148:151], v[204:207], 0
  buffer_load_dwordx4 v186, s[12:15], s6 offen offset:1024 lds
  v_mfma_f32_16x16x32_bf16 v[100:103], v[204:207], a[152:155], 0
  s_add_u32 m0, s69, 129024
  s_add_u32 s6, s59, 128
  v_mfma_f32_16x16x32_bf16 v[108:111], a[148:151], v[208:211], 0
  v_mfma_f32_16x16x32_bf16 v[112:115], v[208:211], a[152:155], 0
  buffer_load_dwordx4 v187, s[8:11], s6 offen lds
  v_mfma_f32_16x16x32_bf16 v[32:35], a[156:159], v[28:31], v[32:35]
  s_waitcnt lgkmcnt(3)
  s_add_u32 m0, s69, 133120
  s_add_u32 s6, s59, 32896
  v_mfma_f32_16x16x32_bf16 v[36:39], a[160:163], v[28:31], v[36:39]
  v_mfma_f32_16x16x32_bf16 v[116:119], v[28:31], a[164:167], v[116:119]
  buffer_load_dwordx4 v187, s[8:11], s6 offen lds
  v_mfma_f32_16x16x32_bf16 v[56:59], a[156:159], v[212:215], v[56:59]
  s_add_u32 m0, s101, 137216
  s_add_u32 s6, s62, 128
  v_mfma_f32_16x16x32_bf16 v[60:63], a[160:163], v[212:215], v[60:63]
  v_mfma_f32_16x16x32_bf16 v[64:67], v[212:215], a[164:167], v[64:67]
  buffer_load_dwordx4 v187, s[8:11], s6 offen lds
  v_mfma_f32_16x16x32_bf16 v[68:71], a[156:159], v[216:219], v[68:71]
  v_mfma_f32_16x16x32_bf16 v[72:75], a[160:163], v[216:219], v[72:75]
  v_mfma_f32_16x16x32_bf16 v[76:79], v[216:219], a[164:167], v[76:79]
  s_waitcnt vmcnt(20)
  s_barrier
  ds_read_b64_tr_b16 a[168:169], v174 offset:34816
  buffer_load_dwordx4 v[244:247], v15, s[8:11], s82 offen
  v_mfma_f32_16x16x32_bf16 v[80:83], a[156:159], v[220:223], v[80:83]
  ds_read_b64_tr_b16 a[170:171], v174 offset:35328
  ds_read_b64_tr_b16 a[216:217], v182 offset:0
  v_mfma_f32_16x16x32_bf16 v[84:87], a[160:163], v[220:223], v[84:87]
  ds_read_b64_tr_b16 a[172:173], v174 offset:43008
  ds_read_b64_tr_b16 a[218:219], v182 offset:1024
  v_mfma_f32_16x16x32_bf16 v[88:91], v[220:223], a[164:167], v[88:91]
  ds_read_b64_tr_b16 a[174:175], v174 offset:43520
  buffer_load_dwordx4 v[248:251], v15, s[8:11], s82 offen offset:16
  v_mfma_f32_16x16x32_bf16 v[92:95], a[156:159], v[224:227], v[92:95]
  ds_read_b64_tr_b16 a[176:177], v174 offset:51200
  ds_read_b64_tr_b16 a[220:221], v182 offset:4096
  v_mfma_f32_16x16x32_bf16 v[96:99], a[160:163], v[224:227], v[96:99]
  ds_read_b64_tr_b16 a[178:179], v174 offset:51712
  ds_read_b64_tr_b16 a[222:223], v182 offset:5120
  v_mfma_f32_16x16x32_bf16 v[100:103], v[224:227], a[164:167], v[100:103]
  ds_read_b128 v[120:123], v172 offset:34816
  ds_read_b64_tr_b16 a[224:225], v183 offset:0
  v_mfma_f32_16x16x32_bf16 v[108:111], a[160:163], v[228:231], v[108:111]
  s_waitcnt lgkmcnt(10)
  ds_read_b128 v[124:127], v172 offset:36864
  ds_read_b64_tr_b16 a[226:227], v183 offset:1024
  v_mfma_f32_16x16x32_bf16 v[112:115], v[228:231], a[164:167], v[112:115]
  ds_read_b128 v[128:131], v172 offset:38912
  ds_read_b64_tr_b16 a[228:229], v183 offset:4096
  v_mfma_f32_16x16x32_bf16 a[192:195], v[28:31], v[232:235], 0
  ds_read_b128 v[132:135], v172 offset:40960
  s_waitcnt lgkmcnt(10)
  ds_read_b64_tr_b16 a[230:231], v183 offset:5120
  v_mfma_f32_16x16x32_bf16 a[204:207], v[232:235], v[232:235], 0
  ds_read_b128 v[136:139], v172 offset:43008
  ds_read_b64_tr_b16 a[248:249], v6 offset:0
  v_mfma_f32_16x16x32_bf16 a[196:199], v[28:31], v[236:239], 0
  ds_read_b64_tr_b16 a[180:181], v174 offset:38912
  ds_read_b64_tr_b16 a[250:251], v6 offset:4096
  v_mfma_f32_16x16x32_bf16 a[208:211], v[236:239], v[236:239], 0
  s_waitcnt lgkmcnt(10)
  ds_read_b64_tr_b16 a[182:183], v174 offset:39424
  ds_read_b64_tr_b16 a[252:253], v6 offset:128
  v_mfma_f32_16x16x32_bf16 a[200:203], v[28:31], v[240:243], 0
  ds_read_b64_tr_b16 a[184:185], v174 offset:47104
  ds_read_b64_tr_b16 a[254:255], v6 offset:4224
  v_mfma_f32_16x16x32_bf16 a[212:215], v[240:243], v[240:243], 0
  ds_read_b64_tr_b16 a[186:187], v174 offset:47616
  buffer_store_dwordx4 a[216:219], v2, s[40:43], s96 offen sc1
  v_mfma_f32_16x16x32_bf16 v[32:35], a[168:171], v[28:31], v[32:35]
  s_waitcnt lgkmcnt(10)
  ds_read_b64_tr_b16 a[188:189], v174 offset:55296
  buffer_store_dwordx4 a[220:223], v2, s[40:43], s97 offen sc1
  v_mfma_f32_16x16x32_bf16 v[36:39], a[172:175], v[28:31], v[36:39]
  ds_read_b64_tr_b16 a[190:191], v174 offset:55808
  buffer_store_dwordx4 a[224:227], v2, s[40:43], s98 offen sc1
  v_mfma_f32_16x16x32_bf16 v[116:119], v[28:31], a[176:179], v[116:119]
  ds_read_b128 v[140:143], v173 offset:34816
  s_waitcnt lgkmcnt(12)
  buffer_store_dwordx4 a[228:231], v2, s[40:43], s98 offen offset:1024 sc1
  v_mfma_f32_16x16x32_bf16 v[56:59], a[168:171], v[120:123], v[56:59]
  ds_read_b128 v[144:147], v173 offset:36864
  v_mfma_f32_16x16x32_bf16 v[60:63], a[172:175], v[120:123], v[60:63]
  ds_read_b128 v[148:151], v173 offset:38912
  s_waitcnt lgkmcnt(10)
  buffer_store_dwordx4 a[248:251], v7, s[40:43], s21 offen sc1
  v_mfma_f32_16x16x32_bf16 v[64:67], v[120:123], a[176:179], v[64:67]
  ds_read_b128 v[152:155], v173 offset:40960
  v_mfma_f32_16x16x32_bf16 v[68:71], a[168:171], v[124:127], v[68:71]
  ds_read_b128 v[156:159], v173 offset:43008
  s_waitcnt lgkmcnt(7)
  buffer_store_dwordx4 a[252:255], v7, s[40:43], s26 offen sc1
  v_mfma_f32_32x32x16_bf16 a[232:247], v[28:31], a[216:219], 0
  v_mfma_f32_32x32x16_bf16 a[232:247], v[28:31], a[220:223], a[232:247]
  v_mfma_f32_16x16x32_bf16 v[72:75], a[172:175], v[124:127], v[72:75]
  ds_read_b128 v[160:163], v175 offset:34816
  v_mfma_f32_16x16x32_bf16 v[76:79], v[124:127], a[176:179], v[76:79]
  ds_read_b128 v[164:167], v175 offset:36864
  v_mfma_f32_16x16x32_bf16 v[80:83], a[168:171], v[128:131], v[80:83]
  ds_read_b128 v[168:171], v176 offset:43008
  v_mfma_f32_16x16x32_bf16 v[84:87], a[172:175], v[128:131], v[84:87]
  s_nop 4
  buffer_store_dword a232, v184, s[40:43], s99 offen sc1
  v_mfma_f32_32x32x16_bf16 a[232:247], v[28:31], a[224:227], 0
  v_mfma_f32_32x32x16_bf16 a[232:247], v[28:31], a[228:231], a[232:247]
  v_mfma_f32_16x16x32_bf16 v[88:91], v[128:131], a[176:179], v[88:91]
  v_mfma_f32_16x16x32_bf16 v[92:95], a[168:171], v[132:135], v[92:95]
  v_mfma_f32_16x16x32_bf16 v[96:99], a[172:175], v[132:135], v[96:99]
  v_mfma_f32_16x16x32_bf16 v[100:103], v[132:135], a[176:179], v[100:103]
  s_nop 7
  buffer_store_dword a232, v184, s[40:43], s20 offen sc1
  v_mfma_f32_16x16x32_bf16 v[108:111], a[172:175], v[136:139], v[108:111]
  v_mfma_f32_16x16x32_bf16 v[112:115], v[136:139], a[176:179], v[112:115]
  v_mfma_f32_16x16x32_bf16 v[32:35], a[180:183], v[28:31], v[32:35]
  v_mfma_f32_16x16x32_bf16 v[36:39], a[184:187], v[28:31], v[36:39]
  s_waitcnt lgkmcnt(0)
  v_mfma_f32_16x16x32_bf16 v[116:119], v[28:31], a[188:191], v[116:119]
  v_mfma_f32_16x16x32_bf16 v[56:59], a[180:183], v[140:143], v[56:59]
  v_mfma_f32_16x16x32_bf16 v[60:63], a[184:187], v[140:143], v[60:63]
  v_mfma_f32_16x16x32_bf16 v[64:67], v[140:143], a[188:191], v[64:67]
  v_mfma_f32_16x16x32_bf16 v[68:71], a[180:183], v[144:147], v[68:71]
  v_mfma_f32_16x16x32_bf16 v[72:75], a[184:187], v[144:147], v[72:75]
  v_mfma_f32_16x16x32_bf16 v[76:79], v[144:147], a[188:191], v[76:79]
  s_waitcnt vmcnt(21)
  s_barrier
  ds_read_b64_tr_b16 a[0:1], v179 offset:0
  v_mfma_f32_16x16x32_bf16 v[80:83], a[180:183], v[148:151], v[80:83]
  ds_read_b64_tr_b16 a[2:3], v179 offset:512
  s_add_u32 m0, s100, 0
  s_add_u32 s6, s58, 393216
  buffer_load_dwordx4 v185, s[12:15], s6 offen offset:0 lds
  v_mfma_f32_16x16x32_bf16 v[84:87], a[184:187], v[148:151], v[84:87]
  ds_read_b64_tr_b16 a[4:5], v179 offset:8192
  s_add_u32 s6, s58, 416768
  v_mfma_f32_16x16x32_bf16 v[88:91], v[148:151], a[188:191], v[88:91]
  ds_read_b64_tr_b16 a[6:7], v179 offset:8704
  v_mfma_f32_16x16x32_bf16 v[92:95], a[180:183], v[152:155], v[92:95]
  ds_read_b64_tr_b16 a[8:9], v179 offset:16384
  buffer_load_dwordx4 v186, s[12:15], s6 offen offset:1024 lds
  v_mfma_f32_16x16x32_bf16 v[96:99], a[184:187], v[152:155], v[96:99]
  ds_read_b64_tr_b16 a[10:11], v179 offset:16896
  s_add_u32 m0, s100, 8192
  v_mfma_f32_16x16x32_bf16 v[100:103], v[152:155], a[188:191], v[100:103]
  ds_read_b128 v[192:195], v177 offset:0
  s_add_u32 s6, s58, 394240
  v_mfma_f32_16x16x32_bf16 v[108:111], a[184:187], v[156:159], v[108:111]
  ds_read_b128 v[196:199], v177 offset:2048
  buffer_load_dwordx4 v185, s[12:15], s6 offen offset:0 lds
  v_mfma_f32_16x16x32_bf16 v[112:115], v[156:159], a[188:191], v[112:115]
  ds_read_b128 v[200:203], v177 offset:4096
  s_add_u32 s6, s58, 417792
  v_mfma_f32_16x16x32_bf16 a[192:195], v[28:31], v[160:163], a[192:195]
  ds_read_b128 v[204:207], v177 offset:6144
  v_mfma_f32_16x16x32_bf16 a[204:207], v[160:163], v[160:163], a[204:207]
  ds_read_b128 v[208:211], v177 offset:8192
  buffer_load_dwordx4 v186, s[12:15], s6 offen offset:1024 lds
  v_mfma_f32_16x16x32_bf16 a[196:199], v[28:31], v[164:167], a[196:199]
  ds_read_b64_tr_b16 a[12:13], v179 offset:4096
  s_add_u32 m0, s100, 16384
  v_mfma_f32_16x16x32_bf16 a[208:211], v[164:167], v[164:167], a[208:211]
  ds_read_b64_tr_b16 a[14:15], v179 offset:4608
  s_add_u32 s6, s58, 395264
  v_mfma_f32_16x16x32_bf16 a[200:203], v[28:31], v[168:171], a[200:203]
  ds_read_b64_tr_b16 a[16:17], v179 offset:12288
  buffer_load_dwordx4 v185, s[12:15], s6 offen offset:0 lds
  v_mfma_f32_16x16x32_bf16 a[212:215], v[168:171], v[168:171], a[212:215]
  s_waitcnt lgkmcnt(7)
  ds_read_b64_tr_b16 a[18:19], v179 offset:12800
  s_add_u32 s6, s58, 418816
  v_mfma_f32_16x16x32_bf16 v[32:35], a[0:3], v[28:31], v[32:35]
  ds_read_b64_tr_b16 a[20:21], v179 offset:20480
  v_mfma_f32_16x16x32_bf16 v[36:39], a[4:7], v[28:31], v[36:39]
  ds_read_b64_tr_b16 a[22:23], v179 offset:20992
  buffer_load_dwordx4 v186, s[12:15], s6 offen offset:1024 lds
  v_mfma_f32_16x16x32_bf16 v[116:119], v[28:31], a[8:11], v[116:119]
  ds_read_b128 v[212:215], v178 offset:0
  s_add_u32 m0, s69, 24576
  v_mfma_f32_16x16x32_bf16 v[56:59], a[0:3], v[192:195], v[56:59]
  ds_read_b128 v[216:219], v178 offset:2048
  s_add_u32 s6, s59, 256
  v_mfma_f32_16x16x32_bf16 v[60:63], a[4:7], v[192:195], v[60:63]
  ds_read_b128 v[220:223], v178 offset:4096
  buffer_load_dwordx4 v187, s[8:11], s6 offen lds
  v_mfma_f32_16x16x32_bf16 v[64:67], v[192:195], a[8:11], v[64:67]
  s_waitcnt lgkmcnt(7)
  ds_read_b128 v[224:227], v178 offset:6144
  s_add_u32 m0, s69, 28672
  v_mfma_f32_16x16x32_bf16 v[68:71], a[0:3], v[196:199], v[68:71]
  ds_read_b128 v[228:231], v178 offset:8192
  s_add_u32 s6, s59, 33024
  v_mfma_f32_16x16x32_bf16 v[72:75], a[4:7], v[196:199], v[72:75]
  ds_read_b128 v[232:235], v180 offset:0
  buffer_load_dwordx4 v187, s[8:11], s6 offen lds
  v_mfma_f32_16x16x32_bf16 v[76:79], v[196:199], a[8:11], v[76:79]
  ds_read_b128 v[236:239], v180 offset:2048
  s_add_u32 m0, s101, 32768
  v_mfma_f32_16x16x32_bf16 v[80:83], a[0:3], v[200:203], v[80:83]
  ds_read_b128 v[240:243], v181 offset:8192
  s_add_u32 s6, s62, 256
  v_mfma_f32_16x16x32_bf16 v[84:87], a[4:7], v[200:203], v[84:87]
  buffer_load_dwordx4 v187, s[8:11], s6 offen lds
  v_mfma_f32_16x16x32_bf16 v[88:91], v[200:203], a[8:11], v[88:91]
  v_mfma_f32_16x16x32_bf16 v[92:95], a[0:3], v[204:207], v[92:95]
  v_mfma_f32_16x16x32_bf16 v[96:99], a[4:7], v[204:207], v[96:99]
  v_mfma_f32_16x16x32_bf16 v[100:103], v[204:207], a[8:11], v[100:103]
  v_mfma_f32_16x16x32_bf16 v[108:111], a[4:7], v[208:211], v[108:111]
  v_mfma_f32_16x16x32_bf16 v[112:115], v[208:211], a[8:11], v[112:115]
  v_mfma_f32_16x16x32_bf16 v[32:35], a[12:15], v[28:31], v[32:35]
  s_waitcnt lgkmcnt(1)
  v_mfma_f32_16x16x32_bf16 v[36:39], a[16:19], v[28:31], v[36:39]
  v_mfma_f32_16x16x32_bf16 v[116:119], v[28:31], a[20:23], v[116:119]
  v_mfma_f32_16x16x32_bf16 v[56:59], a[12:15], v[212:215], v[56:59]
  v_mfma_f32_16x16x32_bf16 v[60:63], a[16:19], v[212:215], v[60:63]
  v_mfma_f32_16x16x32_bf16 v[64:67], v[212:215], a[20:23], v[64:67]
  v_mfma_f32_16x16x32_bf16 v[68:71], a[12:15], v[216:219], v[68:71]
  v_mfma_f32_16x16x32_bf16 v[72:75], a[16:19], v[216:219], v[72:75]
  v_mfma_f32_16x16x32_bf16 v[76:79], v[216:219], a[20:23], v[76:79]
  s_waitcnt vmcnt(9)
  s_barrier
  ds_read_b64_tr_b16 a[24:25], v179 offset:34816
  v_mfma_f32_16x16x32_bf16 v[80:83], a[12:15], v[220:223], v[80:83]
  ds_read_b64_tr_b16 a[26:27], v179 offset:35328
  s_add_u32 m0, s100, 34816
  s_add_u32 s6, s58, 589824
  buffer_load_dwordx4 v185, s[12:15], s6 offen offset:0 lds
  buffer_store_dword v26, v9, s[40:43], s87 offen sc1
  v_mfma_f32_16x16x32_bf16 v[84:87], a[16:19], v[220:223], v[84:87]
  ds_read_b64_tr_b16 a[28:29], v179 offset:43008
  s_add_u32 s6, s58, 613376
  v_mfma_f32_16x16x32_bf16 v[88:91], v[220:223], a[20:23], v[88:91]
  ds_read_b64_tr_b16 a[30:31], v179 offset:43520
  v_mfma_f32_16x16x32_bf16 v[92:95], a[12:15], v[224:227], v[92:95]
  ds_read_b64_tr_b16 a[32:33], v179 offset:51200
  buffer_load_dwordx4 v186, s[12:15], s6 offen offset:1024 lds
  v_mfma_f32_16x16x32_bf16 v[96:99], a[16:19], v[224:227], v[96:99]
  ds_read_b64_tr_b16 a[34:35], v179 offset:51712
  s_add_u32 m0, s100, 43008
  v_mfma_f32_16x16x32_bf16 v[100:103], v[224:227], a[20:23], v[100:103]
  ds_read_b128 v[120:123], v177 offset:34816
  s_add_u32 s6, s58, 590848
  v_mfma_f32_16x16x32_bf16 v[108:111], a[16:19], v[228:231], v[108:111]
  ds_read_b128 v[124:127], v177 offset:36864
  buffer_load_dwordx4 v185, s[12:15], s6 offen offset:0 lds
  v_mfma_f32_16x16x32_bf16 v[112:115], v[228:231], a[20:23], v[112:115]
  ds_read_b128 v[128:131], v177 offset:38912
  s_add_u32 s6, s58, 614400
  v_mfma_f32_16x16x32_bf16 a[192:195], v[28:31], v[232:235], a[192:195]
  ds_read_b128 v[132:135], v177 offset:40960
  v_mfma_f32_16x16x32_bf16 a[204:207], v[232:235], v[232:235], a[204:207]
  ds_read_b128 v[136:139], v177 offset:43008
  buffer_load_dwordx4 v186, s[12:15], s6 offen offset:1024 lds
  v_mfma_f32_16x16x32_bf16 a[196:199], v[28:31], v[236:239], a[196:199]
  ds_read_b64_tr_b16 a[36:37], v179 offset:38912
  s_add_u32 m0, s100, 51200
  v_mfma_f32_16x16x32_bf16 a[208:211], v[236:239], v[236:239], a[208:211]
  s_waitcnt lgkmcnt(7)
  ds_read_b64_tr_b16 a[38:39], v179 offset:39424
  s_add_u32 s6, s58, 591872
  v_mfma_f32_16x16x32_bf16 a[200:203], v[28:31], v[240:243], a[200:203]
  ds_read_b64_tr_b16 a[40:41], v179 offset:47104
  buffer_load_dwordx4 v185, s[12:15], s6 offen offset:0 lds
  v_mfma_f32_16x16x32_bf16 a[212:215], v[240:243], v[240:243], a[212:215]
  ds_read_b64_tr_b16 a[42:43], v179 offset:47616
  s_add_u32 s6, s58, 615424
  v_mfma_f32_16x16x32_bf16 v[32:35], a[24:27], v[28:31], v[32:35]
  ds_read_b64_tr_b16 a[44:45], v179 offset:55296
  v_mfma_f32_16x16x32_bf16 v[36:39], a[28:31], v[28:31], v[36:39]
  s_waitcnt lgkmcnt(7)
  ds_read_b64_tr_b16 a[46:47], v179 offset:55808
  buffer_load_dwordx4 v186, s[12:15], s6 offen offset:1024 lds
  v_mfma_f32_16x16x32_bf16 v[116:119], v[28:31], a[32:35], v[116:119]
  ds_read_b128 v[140:143], v178 offset:34816
  s_add_u32 m0, s69, 59392
  v_mfma_f32_16x16x32_bf16 v[56:59], a[24:27], v[120:123], v[56:59]
  ds_read_b128 v[144:147], v178 offset:36864
  s_add_u32 s6, s59, 384
  v_mfma_f32_16x16x32_bf16 v[60:63], a[28:31], v[120:123], v[60:63]
  ds_read_b128 v[148:151], v178 offset:38912
  buffer_load_dwordx4 v187, s[8:11], s6 offen lds
  v_mfma_f32_16x16x32_bf16 v[64:67], v[120:123], a[32:35], v[64:67]
  ds_read_b128 v[152:155], v178 offset:40960
  s_add_u32 m0, s69, 63488
  v_mfma_f32_16x16x32_bf16 v[68:71], a[24:27], v[124:127], v[68:71]
  ds_read_b128 v[156:159], v178 offset:43008
  s_add_u32 s6, s59, 33152
  v_mfma_f32_16x16x32_bf16 v[72:75], a[28:31], v[124:127], v[72:75]
  ds_read_b128 v[160:163], v180 offset:34816
  buffer_load_dwordx4 v187, s[8:11], s6 offen lds
  v_mfma_f32_16x16x32_bf16 v[76:79], v[124:127], a[32:35], v[76:79]
  ds_read_b128 v[164:167], v180 offset:36864
  s_add_u32 m0, s101, 67584
  v_mfma_f32_16x16x32_bf16 v[80:83], a[24:27], v[128:131], v[80:83]
  s_waitcnt lgkmcnt(7)
  ds_read_b128 v[168:171], v181 offset:43008
  s_add_u32 s6, s62, 384
  v_mfma_f32_16x16x32_bf16 v[84:87], a[28:31], v[128:131], v[84:87]
  buffer_load_dwordx4 v187, s[8:11], s6 offen lds
  v_mfma_f32_16x16x32_bf16 v[88:91], v[128:131], a[32:35], v[88:91]
  v_mfma_f32_16x16x32_bf16 v[92:95], a[24:27], v[132:135], v[92:95]
  v_mfma_f32_16x16x32_bf16 v[96:99], a[28:31], v[132:135], v[96:99]
  v_mfma_f32_16x16x32_bf16 v[100:103], v[132:135], a[32:35], v[100:103]
  v_mfma_f32_16x16x32_bf16 v[108:111], a[28:31], v[136:139], v[108:111]
  v_mfma_f32_16x16x32_bf16 v[112:115], v[136:139], a[32:35], v[112:115]
  v_mfma_f32_16x16x32_bf16 v[32:35], a[36:39], v[28:31], v[32:35]
  v_mfma_f32_16x16x32_bf16 v[36:39], a[40:43], v[28:31], v[36:39]
  v_mfma_f32_16x16x32_bf16 v[116:119], v[28:31], a[44:47], v[116:119]
  s_waitcnt lgkmcnt(0)
  v_mfma_f32_16x16x32_bf16 v[56:59], a[36:39], v[140:143], v[56:59]
  v_mfma_f32_16x16x32_bf16 v[60:63], a[40:43], v[140:143], v[60:63]
  v_mfma_f32_16x16x32_bf16 v[64:67], v[140:143], a[44:47], v[64:67]
  v_mfma_f32_16x16x32_bf16 v[68:71], a[36:39], v[144:147], v[68:71]
  v_mfma_f32_16x16x32_bf16 v[72:75], a[40:43], v[144:147], v[72:75]
  v_mfma_f32_16x16x32_bf16 v[76:79], v[144:147], a[44:47], v[76:79]
  s_waitcnt vmcnt(10)
  s_barrier
  ds_read_b64_tr_b16 a[48:49], v174 offset:0
  v_mfma_f32_16x16x32_bf16 v[80:83], a[36:39], v[148:151], v[80:83]
  ds_read_b64_tr_b16 a[50:51], v174 offset:512
  s_add_u32 m0, s100, 69632
  s_add_u32 s6, s58, 786432
  buffer_load_dwordx4 v185, s[12:15], s6 offen offset:0 lds
  v_mfma_f32_16x16x32_bf16 v[84:87], a[40:43], v[148:151], v[84:87]
  ds_read_b64_tr_b16 a[52:53], v174 offset:8192
  s_add_u32 s6, s58, 809984
  v_mfma_f32_16x16x32_bf16 v[88:91], v[148:151], a[44:47], v[88:91]
  ds_read_b64_tr_b16 a[54:55], v174 offset:8704
  v_mfma_f32_16x16x32_bf16 v[92:95], a[36:39], v[152:155], v[92:95]
  ds_read_b64_tr_b16 a[56:57], v174 offset:16384
  buffer_load_dwordx4 v186, s[12:15], s6 offen offset:1024 lds
  v_mfma_f32_16x16x32_bf16 v[96:99], a[40:43], v[152:155], v[96:99]
  ds_read_b64_tr_b16 a[58:59], v174 offset:16896
  s_add_u32 m0, s100, 77824
  v_mfma_f32_16x16x32_bf16 v[100:103], v[152:155], a[44:47], v[100:103]
  ds_read_b128 v[192:195], v172 offset:0
  s_add_u32 s6, s58, 787456
  v_mfma_f32_16x16x32_bf16 v[108:111], a[40:43], v[156:159], v[108:111]
  ds_read_b128 v[196:199], v172 offset:2048
  buffer_load_dwordx4 v185, s[12:15], s6 offen offset:0 lds
  v_mfma_f32_16x16x32_bf16 v[112:115], v[156:159], a[44:47], v[112:115]
  ds_read_b128 v[200:203], v172 offset:4096
  s_add_u32 s6, s58, 811008
  v_mfma_f32_16x16x32_bf16 a[192:195], v[28:31], v[160:163], a[192:195]
  ds_read_b128 v[204:207], v172 offset:6144
  v_mfma_f32_16x16x32_bf16 a[204:207], v[160:163], v[160:163], a[204:207]
  ds_read_b128 v[208:211], v172 offset:8192
  buffer_load_dwordx4 v186, s[12:15], s6 offen offset:1024 lds
  v_mfma_f32_16x16x32_bf16 a[196:199], v[28:31], v[164:167], a[196:199]
  ds_read_b64_tr_b16 a[60:61], v174 offset:4096
  s_add_u32 m0, s100, 86016
  v_mfma_f32_16x16x32_bf16 a[208:211], v[164:167], v[164:167], a[208:211]
  ds_read_b64_tr_b16 a[62:63], v174 offset:4608
  s_add_u32 s6, s58, 788480
  v_mfma_f32_16x16x32_bf16 a[200:203], v[28:31], v[168:171], a[200:203]
  ds_read_b64_tr_b16 a[64:65], v174 offset:12288
  buffer_load_dwordx4 v185, s[12:15], s6 offen offset:0 lds
  v_mfma_f32_16x16x32_bf16 a[212:215], v[168:171], v[168:171], a[212:215]
  s_waitcnt lgkmcnt(7)
  ds_read_b64_tr_b16 a[66:67], v174 offset:12800
  s_add_u32 s6, s58, 812032
  v_mfma_f32_16x16x32_bf16 v[32:35], a[48:51], v[28:31], v[32:35]
  ds_read_b64_tr_b16 a[68:69], v174 offset:20480
  v_mfma_f32_16x16x32_bf16 v[36:39], a[52:55], v[28:31], v[36:39]
  ds_read_b64_tr_b16 a[70:71], v174 offset:20992
  buffer_load_dwordx4 v186, s[12:15], s6 offen offset:1024 lds
  v_mfma_f32_16x16x32_bf16 v[116:119], v[28:31], a[56:59], v[116:119]
  ds_read_b128 v[212:215], v173 offset:0
  s_add_u32 m0, s69, 94208
  v_mfma_f32_16x16x32_bf16 v[56:59], a[48:51], v[192:195], v[56:59]
  ds_read_b128 v[216:219], v173 offset:2048
  s_add_u32 s6, s59, 512
  v_mfma_f32_16x16x32_bf16 v[60:63], a[52:55], v[192:195], v[60:63]
  ds_read_b128 v[220:223], v173 offset:4096
  buffer_load_dwordx4 v187, s[8:11], s6 offen lds
  v_mfma_f32_16x16x32_bf16 v[64:67], v[192:195], a[56:59], v[64:67]
  s_waitcnt lgkmcnt(7)
  ds_read_b128 v[224:227], v173 offset:6144
  s_add_u32 m0, s69, 98304
  v_mfma_f32_16x16x32_bf16 v[68:71], a[48:51], v[196:199], v[68:71]
  ds_read_b128 v[228:231], v173 offset:8192
  s_add_u32 s6, s59, 33280
  v_mfma_f32_16x16x32_bf16 v[72:75], a[52:55], v[196:199], v[72:75]
  ds_read_b128 v[232:235], v175 offset:0
  buffer_load_dwordx4 v187, s[8:11], s6 offen lds
  v_mfma_f32_16x16x32_bf16 v[76:79], v[196:199], a[56:59], v[76:79]
  ds_read_b128 v[236:239], v175 offset:2048
  s_add_u32 m0, s101, 102400
  v_mfma_f32_16x16x32_bf16 v[80:83], a[48:51], v[200:203], v[80:83]
  ds_read_b128 v[240:243], v176 offset:8192
  s_add_u32 s6, s62, 512
  v_mfma_f32_16x16x32_bf16 v[84:87], a[52:55], v[200:203], v[84:87]
  buffer_load_dwordx4 v187, s[8:11], s6 offen lds
  v_mfma_f32_16x16x32_bf16 v[88:91], v[200:203], a[56:59], v[88:91]
  v_mfma_f32_16x16x32_bf16 v[92:95], a[48:51], v[204:207], v[92:95]
  v_lshlrev_b32 v40, 16, v244
  v_and_b32 v41, 0xffff0000, v244
  v_mfma_f32_16x16x32_bf16 v[96:99], a[52:55], v[204:207], v[96:99]
  v_mfma_f32_16x16x32_bf16 v[100:103], v[204:207], a[56:59], v[100:103]
  v_lshlrev_b32 v42, 16, v245
  v_and_b32 v43, 0xffff0000, v245
  v_mfma_f32_16x16x32_bf16 v[108:111], a[52:55], v[208:211], v[108:111]
  v_mfma_f32_16x16x32_bf16 v[112:115], v[208:211], a[56:59], v[112:115]
  v_lshlrev_b32 v44, 16, v246
  v_and_b32 v45, 0xffff0000, v246
  v_mfma_f32_16x16x32_bf16 v[32:35], a[60:63], v[28:31], v[32:35]
  s_waitcnt lgkmcnt(1)
  v_mfma_f32_16x16x32_bf16 v[36:39], a[64:67], v[28:31], v[36:39]
  v_lshlrev_b32 v46, 16, v247
  v_and_b32 v47, 0xffff0000, v247
  v_mfma_f32_16x16x32_bf16 v[116:119], v[28:31], a[68:71], v[116:119]
  v_mfma_f32_16x16x32_bf16 v[56:59], a[60:63], v[212:215], v[56:59]
  v_lshlrev_b32 v48, 16, v248
  v_and_b32 v49, 0xffff0000, v248
  v_mfma_f32_16x16x32_bf16 v[60:63], a[64:67], v[212:215], v[60:63]
  v_mfma_f32_16x16x32_bf16 v[64:67], v[212:215], a[68:71], v[64:67]
  v_lshlrev_b32 v50, 16, v249
  v_and_b32 v51, 0xffff0000, v249
  v_mfma_f32_16x16x32_bf16 v[68:71], a[60:63], v[216:219], v[68:71]
  v_mfma_f32_16x16x32_bf16 v[72:75], a[64:67], v[216:219], v[72:75]
  v_lshlrev_b32 v52, 16, v250
  v_and_b32 v53, 0xffff0000, v250
  v_mfma_f32_16x16x32_bf16 v[76:79], v[216:219], a[68:71], v[76:79]
  s_waitcnt vmcnt(9)
  s_barrier
  ds_read_b64_tr_b16 a[72:73], v174 offset:34816
  v_mfma_f32_16x16x32_bf16 v[80:83], a[60:63], v[220:223], v[80:83]
  ds_read_b64_tr_b16 a[74:75], v174 offset:35328
  s_add_u32 m0, s100, 104448
  s_add_u32 s6, s58, 983040
  buffer_load_dwordx4 v185, s[12:15], s6 offen offset:0 lds
  v_lshlrev_b32 v54, 16, v251
  v_and_b32 v55, 0xffff0000, v251
  v_mfma_f32_16x16x32_bf16 v[84:87], a[64:67], v[220:223], v[84:87]
  ds_read_b64_tr_b16 a[76:77], v174 offset:43008
  s_add_u32 s6, s58, 1006592
  v_mfma_f32_16x16x32_bf16 v[88:91], v[220:223], a[68:71], v[88:91]
  ds_read_b64_tr_b16 a[78:79], v174 offset:43520
  v_mfma_f32_16x16x32_bf16 v[92:95], a[60:63], v[224:227], v[92:95]
  ds_read_b64_tr_b16 a[80:81], v174 offset:51200
  buffer_load_dwordx4 v186, s[12:15], s6 offen offset:1024 lds
  v_mfma_f32_16x16x32_bf16 v[96:99], a[64:67], v[224:227], v[96:99]
  ds_read_b64_tr_b16 a[82:83], v174 offset:51712
  s_add_u32 m0, s100, 112640
  v_mfma_f32_16x16x32_bf16 v[100:103], v[224:227], a[68:71], v[100:103]
  ds_read_b128 v[120:123], v172 offset:34816
  s_add_u32 s6, s58, 984064
  v_mfma_f32_16x16x32_bf16 v[108:111], a[64:67], v[228:231], v[108:111]
  ds_read_b128 v[124:127], v172 offset:36864
  buffer_load_dwordx4 v185, s[12:15], s6 offen offset:0 lds
  v_mfma_f32_16x16x32_bf16 v[112:115], v[228:231], a[68:71], v[112:115]
  ds_read_b128 v[128:131], v172 offset:38912
  s_add_u32 s6, s58, 1007616
  v_mfma_f32_16x16x32_bf16 a[192:195], v[28:31], v[232:235], a[192:195]
  ds_read_b128 v[132:135], v172 offset:40960
  v_mfma_f32_16x16x32_bf16 a[204:207], v[232:235], v[232:235], a[204:207]
  ds_read_b128 v[136:139], v172 offset:43008
  buffer_load_dwordx4 v186, s[12:15], s6 offen offset:1024 lds
  v_mfma_f32_16x16x32_bf16 a[196:199], v[28:31], v[236:239], a[196:199]
  ds_read_b64_tr_b16 a[84:85], v174 offset:38912
  s_add_u32 m0, s100, 120832
  v_mfma_f32_16x16x32_bf16 a[208:211], v[236:239], v[236:239], a[208:211]
  s_waitcnt lgkmcnt(7)
  ds_read_b64_tr_b16 a[86:87], v174 offset:39424
  s_add_u32 s6, s58, 985088
  v_mfma_f32_16x16x32_bf16 a[200:203], v[28:31], v[240:243], a[200:203]
  ds_read_b64_tr_b16 a[88:89], v174 offset:47104
  buffer_load_dwordx4 v185, s[12:15], s6 offen offset:0 lds
  v_mfma_f32_16x16x32_bf16 a[212:215], v[240:243], v[240:243], a[212:215]
  ds_read_b64_tr_b16 a[90:91], v174 offset:47616
  s_add_u32 s6, s58, 1008640
  v_mfma_f32_16x16x32_bf16 v[32:35], a[72:75], v[28:31], v[32:35]
  ds_read_b64_tr_b16 a[92:93], v174 offset:55296
  v_mfma_f32_16x16x32_bf16 v[36:39], a[76:79], v[28:31], v[36:39]
  s_waitcnt lgkmcnt(7)
  ds_read_b64_tr_b16 a[94:95], v174 offset:55808
  buffer_load_dwordx4 v186, s[12:15], s6 offen offset:1024 lds
  v_mfma_f32_16x16x32_bf16 v[116:119], v[28:31], a[80:83], v[116:119]
  ds_read_b128 v[140:143], v173 offset:34816
  s_add_u32 m0, s69, 129024
  v_mfma_f32_16x16x32_bf16 v[56:59], a[72:75], v[120:123], v[56:59]
  ds_read_b128 v[144:147], v173 offset:36864
  s_add_u32 s6, s59, 640
  v_mfma_f32_16x16x32_bf16 v[60:63], a[76:79], v[120:123], v[60:63]
  ds_read_b128 v[148:151], v173 offset:38912
  buffer_load_dwordx4 v187, s[8:11], s6 offen lds
  v_mfma_f32_16x16x32_bf16 v[64:67], v[120:123], a[80:83], v[64:67]
  ds_read_b128 v[152:155], v173 offset:40960
  s_add_u32 m0, s69, 133120
  v_mfma_f32_16x16x32_bf16 v[68:71], a[72:75], v[124:127], v[68:71]
  ds_read_b128 v[156:159], v173 offset:43008
  s_add_u32 s6, s59, 33408
  v_mfma_f32_16x16x32_bf16 v[72:75], a[76:79], v[124:127], v[72:75]
  ds_read_b128 v[160:163], v175 offset:34816
  buffer_load_dwordx4 v187, s[8:11], s6 offen lds
  v_mfma_f32_16x16x32_bf16 v[76:79], v[124:127], a[80:83], v[76:79]
  ds_read_b128 v[164:167], v175 offset:36864
  s_add_u32 m0, s101, 137216
  v_mfma_f32_16x16x32_bf16 v[80:83], a[72:75], v[128:131], v[80:83]
  s_waitcnt lgkmcnt(7)
  ds_read_b128 v[168:171], v176 offset:43008
  s_add_u32 s6, s62, 640
  v_mfma_f32_16x16x32_bf16 v[84:87], a[76:79], v[128:131], v[84:87]
  buffer_load_dwordx4 v187, s[8:11], s6 offen lds
  v_mfma_f32_16x16x32_bf16 v[88:91], v[128:131], a[80:83], v[88:91]
  v_mfma_f32_16x16x32_bf16 v[92:95], a[72:75], v[132:135], v[92:95]
  v_mfma_f32_16x16x32_bf16 v[96:99], a[76:79], v[132:135], v[96:99]
  v_mfma_f32_16x16x32_bf16 v[100:103], v[132:135], a[80:83], v[100:103]
  v_mfma_f32_16x16x32_bf16 v[108:111], a[76:79], v[136:139], v[108:111]
  v_mfma_f32_16x16x32_bf16 v[112:115], v[136:139], a[80:83], v[112:115]
  v_mfma_f32_16x16x32_bf16 v[32:35], a[84:87], v[28:31], v[32:35]
  v_mfma_f32_16x16x32_bf16 v[36:39], a[88:91], v[28:31], v[36:39]
  v_mfma_f32_16x16x32_bf16 v[116:119], v[28:31], a[92:95], v[116:119]
  s_waitcnt lgkmcnt(0)
  v_mfma_f32_16x16x32_bf16 v[56:59], a[84:87], v[140:143], v[56:59]
  v_mfma_f32_16x16x32_bf16 v[60:63], a[88:91], v[140:143], v[60:63]
  v_mfma_f32_16x16x32_bf16 v[64:67], v[140:143], a[92:95], v[64:67]
  v_mfma_f32_16x16x32_bf16 v[68:71], a[84:87], v[144:147], v[68:71]
  v_mfma_f32_16x16x32_bf16 v[72:75], a[88:91], v[144:147], v[72:75]
  v_mfma_f32_16x16x32_bf16 v[76:79], v[144:147], a[92:95], v[76:79]
  s_waitcnt vmcnt(9)
  s_barrier
  ds_read_b64_tr_b16 a[96:97], v179 offset:0
  v_mfma_f32_16x16x32_bf16 v[80:83], a[84:87], v[148:151], v[80:83]
  ds_read_b64_tr_b16 a[98:99], v179 offset:512
  s_add_u32 m0, s55, 0
  s_add_u32 s6, s56, 0
  buffer_load_dwordx4 v4, s[16:19], s6 offen offset:0 lds
  v_mfma_f32_16x16x32_bf16 v[84:87], a[88:91], v[148:151], v[84:87]
  ds_read_b64_tr_b16 a[100:101], v179 offset:8192
  s_add_u32 s6, s56, 7168
  v_mfma_f32_16x16x32_bf16 v[88:91], v[148:151], a[92:95], v[88:91]
  ds_read_b64_tr_b16 a[102:103], v179 offset:8704
  v_mfma_f32_16x16x32_bf16 v[92:95], a[84:87], v[152:155], v[92:95]
  ds_read_b64_tr_b16 a[104:105], v179 offset:16384
  buffer_load_dwordx4 v4, s[16:19], s6 offen offset:1024 lds
  v_mfma_f32_16x16x32_bf16 v[96:99], a[88:91], v[152:155], v[96:99]
  ds_read_b64_tr_b16 a[106:107], v179 offset:16896
  s_add_u32 s6, s56, 14336
  v_mfma_f32_16x16x32_bf16 v[100:103], v[152:155], a[92:95], v[100:103]
  ds_read_b128 v[192:195], v177 offset:0
  v_mfma_f32_16x16x32_bf16 v[108:111], a[88:91], v[156:159], v[108:111]
  ds_read_b128 v[196:199], v177 offset:2048
  buffer_load_dwordx4 v4, s[16:19], s6 offen offset:2048 lds
  v_mfma_f32_16x16x32_bf16 v[112:115], v[156:159], a[92:95], v[112:115]
  ds_read_b128 v[200:203], v177 offset:4096
  s_add_u32 s6, s56, 21504
  v_mfma_f32_16x16x32_bf16 a[192:195], v[28:31], v[160:163], a[192:195]
  ds_read_b128 v[204:207], v177 offset:6144
  v_mfma_f32_16x16x32_bf16 a[204:207], v[160:163], v[160:163], a[204:207]
  ds_read_b128 v[208:211], v177 offset:8192
  buffer_load_dwordx4 v4, s[16:19], s6 offen offset:3072 lds
  v_mfma_f32_16x16x32_bf16 a[196:199], v[28:31], v[164:167], a[196:199]
  ds_read_b64_tr_b16 a[108:109], v179 offset:4096
  s_add_u32 m0, s55, 16384
  v_mfma_f32_16x16x32_bf16 a[208:211], v[164:167], v[164:167], a[208:211]
  ds_read_b64_tr_b16 a[110:111], v179 offset:4608
  s_add_u32 s6, s56, 65536
  v_mfma_f32_16x16x32_bf16 a[200:203], v[28:31], v[168:171], a[200:203]
  ds_read_b64_tr_b16 a[112:113], v179 offset:12288
  buffer_load_dwordx4 v4, s[16:19], s6 offen offset:0 lds
  v_mfma_f32_16x16x32_bf16 a[212:215], v[168:171], v[168:171], a[212:215]
  s_waitcnt lgkmcnt(7)
  ds_read_b64_tr_b16 a[114:115], v179 offset:12800
  s_add_u32 s6, s56, 72704
  v_mfma_f32_16x16x32_bf16 v[32:35], a[96:99], v[28:31], v[32:35]
  ds_read_b64_tr_b16 a[116:117], v179 offset:20480
  v_mfma_f32_16x16x32_bf16 v[36:39], a[100:103], v[28:31], v[36:39]
  ds_read_b64_tr_b16 a[118:119], v179 offset:20992
  buffer_load_dwordx4 v4, s[16:19], s6 offen offset:1024 lds
  v_mfma_f32_16x16x32_bf16 v[116:119], v[28:31], a[104:107], v[116:119]
  ds_read_b128 v[212:215], v178 offset:0
  s_add_u32 s6, s56, 79872
  v_mfma_f32_16x16x32_bf16 v[56:59], a[96:99], v[192:195], v[56:59]
  ds_read_b128 v[216:219], v178 offset:2048
  v_mfma_f32_16x16x32_bf16 v[60:63], a[100:103], v[192:195], v[60:63]
  ds_read_b128 v[220:223], v178 offset:4096
  buffer_load_dwordx4 v4, s[16:19], s6 offen offset:2048 lds
  v_mfma_f32_16x16x32_bf16 v[64:67], v[192:195], a[104:107], v[64:67]
  s_waitcnt lgkmcnt(7)
  ds_read_b128 v[224:227], v178 offset:6144
  s_add_u32 s6, s56, 87040
  v_mfma_f32_16x16x32_bf16 v[68:71], a[96:99], v[196:199], v[68:71]
  ds_read_b128 v[228:231], v178 offset:8192
  v_mfma_f32_16x16x32_bf16 v[72:75], a[100:103], v[196:199], v[72:75]
  ds_read_b128 v[232:235], v180 offset:0
  buffer_load_dwordx4 v4, s[16:19], s6 offen offset:3072 lds
  v_mfma_f32_16x16x32_bf16 v[76:79], v[196:199], a[104:107], v[76:79]
  ds_read_b128 v[236:239], v180 offset:2048
  v_mfma_f32_16x16x32_bf16 v[80:83], a[96:99], v[200:203], v[80:83]
  ds_read_b128 v[240:243], v181 offset:8192
  v_mfma_f32_16x16x32_bf16 v[84:87], a[100:103], v[200:203], v[84:87]
  v_mfma_f32_16x16x32_bf16 v[88:91], v[200:203], a[104:107], v[88:91]
  v_mfma_f32_16x16x32_bf16 v[92:95], a[96:99], v[204:207], v[92:95]
  v_mfma_f32_16x16x32_bf16 v[96:99], a[100:103], v[204:207], v[96:99]
  v_mfma_f32_16x16x32_bf16 v[100:103], v[204:207], a[104:107], v[100:103]
  v_mfma_f32_16x16x32_bf16 v[108:111], a[100:103], v[208:211], v[108:111]
  v_mfma_f32_16x16x32_bf16 v[112:115], v[208:211], a[104:107], v[112:115]
  v_mfma_f32_16x16x32_bf16 v[32:35], a[108:111], v[28:31], v[32:35]
  s_waitcnt lgkmcnt(1)
  v_mfma_f32_16x16x32_bf16 v[36:39], a[112:115], v[28:31], v[36:39]
  v_mfma_f32_16x16x32_bf16 v[116:119], v[28:31], a[116:119], v[116:119]
  v_mfma_f32_16x16x32_bf16 v[56:59], a[108:111], v[212:215], v[56:59]
  v_mfma_f32_16x16x32_bf16 v[60:63], a[112:115], v[212:215], v[60:63]
  v_mfma_f32_16x16x32_bf16 v[64:67], v[212:215], a[116:119], v[64:67]
  v_mfma_f32_16x16x32_bf16 v[68:71], a[108:111], v[216:219], v[68:71]
  v_mfma_f32_16x16x32_bf16 v[72:75], a[112:115], v[216:219], v[72:75]
  v_mfma_f32_16x16x32_bf16 v[76:79], v[216:219], a[116:119], v[76:79]
  s_waitcnt vmcnt(8)
  s_barrier
  ds_read_b128 v[160:163], v180 offset:34816
  v_mfma_f32_16x16x32_bf16 v[80:83], a[108:111], v[220:223], v[80:83]
  ds_read_b128 v[164:167], v180 offset:36864
  v_mov_b32 v7, L_join-L_pc
  v_add_u32 v7, s39, v7
  global_load_dword v6, v7, s[90:91]
  s_add_u32 m0, s55, 32768
  s_add_u32 s6, s56, 131072
  v_mfma_f32_16x16x32_bf16 v[84:87], a[112:115], v[220:223], v[84:87]
  ds_read_b128 v[168:171], v181 offset:43008
  buffer_load_dwordx4 v4, s[16:19], s6 offen offset:0 lds
  v_mfma_f32_16x16x32_bf16 v[88:91], v[220:223], a[116:119], v[88:91]
  ds_read_b64_tr_b16 a[120:121], v179 offset:34816
  s_add_u32 s6, s56, 138240
  v_mfma_f32_16x16x32_bf16 v[92:95], a[108:111], v[224:227], v[92:95]
  ds_read_b64_tr_b16 a[122:123], v179 offset:35328
  v_mfma_f32_16x16x32_bf16 v[96:99], a[112:115], v[224:227], v[96:99]
  ds_read_b64_tr_b16 a[124:125], v179 offset:43008
  buffer_load_dwordx4 v4, s[16:19], s6 offen offset:1024 lds
  v_mfma_f32_16x16x32_bf16 v[100:103], v[224:227], a[116:119], v[100:103]
  ds_read_b64_tr_b16 a[126:127], v179 offset:43520
  s_add_u32 s6, s56, 145408
  v_mfma_f32_16x16x32_bf16 v[108:111], a[112:115], v[228:231], v[108:111]
  ds_read_b64_tr_b16 a[128:129], v179 offset:51200
  v_mfma_f32_16x16x32_bf16 v[112:115], v[228:231], a[116:119], v[112:115]
  ds_read_b64_tr_b16 a[130:131], v179 offset:51712
  buffer_load_dwordx4 v4, s[16:19], s6 offen offset:2048 lds
  v_mfma_f32_16x16x32_bf16 a[192:195], v[28:31], v[232:235], a[192:195]
  ds_read_b128 v[120:123], v177 offset:34816
  s_add_u32 s6, s56, 152576
  v_mfma_f32_16x16x32_bf16 a[204:207], v[232:235], v[232:235], a[204:207]
  ds_read_b128 v[124:127], v177 offset:36864
  v_mfma_f32_16x16x32_bf16 a[196:199], v[28:31], v[236:239], a[196:199]
  ds_read_b128 v[128:131], v177 offset:38912
  buffer_load_dwordx4 v4, s[16:19], s6 offen offset:3072 lds
  v_mfma_f32_16x16x32_bf16 a[208:211], v[236:239], v[236:239], a[208:211]
  s_waitcnt lgkmcnt(7)
  ds_read_b128 v[132:135], v177 offset:40960
  s_add_u32 m0, s55, 49152
  v_mfma_f32_16x16x32_bf16 a[200:203], v[28:31], v[240:243], a[200:203]
  ds_read_b128 v[136:139], v177 offset:43008
  s_add_u32 s6, s56, 196608
  v_mfma_f32_16x16x32_bf16 a[212:215], v[240:243], v[240:243], a[212:215]
  ds_read_b64_tr_b16 a[132:133], v179 offset:38912
  buffer_load_dwordx4 v4, s[16:19], s6 offen offset:0 lds
  v_mfma_f32_16x16x32_bf16 a[192:195], v[28:31], v[160:163], a[192:195]
  ds_read_b64_tr_b16 a[134:135], v179 offset:39424
  s_add_u32 s6, s56, 203776
  s_mul_i32 s3, s83, 768
  s_lshl_b32 s4, s84, 8
  s_add_u32 s3, s3, 148480
  v_add_u32 v201, s3, v17
  v_add_u32 v200, s4, v201
  v_mfma_f32_16x16x32_bf16 a[204:207], v[160:163], v[160:163], a[204:207]
  ds_read_b64_tr_b16 a[136:137], v179 offset:47104
  buffer_load_dwordx4 v4, s[16:19], s6 offen offset:1024 lds
  s_min_u32 s3, s53, 2
  s_lshl_b32 s3, s3, 8
  s_add_u32 s3, s3, 147456
  v_add_u32 v202, s3, v3
  v_mfma_f32_16x16x32_bf16 a[196:199], v[28:31], v[164:167], a[196:199]
  ds_read_b64_tr_b16 a[138:139], v179 offset:47616
  s_add_u32 s6, s56, 210944
  v_mfma_f32_16x16x32_bf16 a[208:211], v[164:167], v[164:167], a[208:211]
  ds_read_b64_tr_b16 a[140:141], v179 offset:55296
  buffer_load_dwordx4 v4, s[16:19], s6 offen offset:2048 lds
  v_mfma_f32_16x16x32_bf16 a[200:203], v[28:31], v[168:171], a[200:203]
  ds_read_b64_tr_b16 a[142:143], v179 offset:55808
  s_add_u32 s6, s56, 218112
  v_mfma_f32_16x16x32_bf16 a[212:215], v[168:171], v[168:171], a[212:215]
  s_waitcnt lgkmcnt(5)
  ds_read_b128 v[140:143], v178 offset:34816
  v_accvgpr_read_b32 v205, a204
  v_accvgpr_read_b32 v206, a205
  v_accvgpr_read_b32 v207, a206
  v_accvgpr_read_b32 v208, a207
  v_mfma_f32_16x16x32_bf16 v[32:35], a[120:123], v[28:31], v[32:35]
  ds_read_b128 v[144:147], v178 offset:36864
  buffer_load_dwordx4 v4, s[16:19], s6 offen offset:3072 lds
  v_accvgpr_read_b32 v204, a192
  v_accvgpr_read_b32 v213, a208
  v_mfma_f32_16x16x32_bf16 v[36:39], a[124:127], v[28:31], v[36:39]
  ds_read_b128 v[148:151], v178 offset:38912
  v_accvgpr_read_b32 v214, a209
  v_accvgpr_read_b32 v215, a210
  v_accvgpr_read_b32 v216, a211
  v_accvgpr_read_b32 v212, a196
  v_mfma_f32_16x16x32_bf16 v[116:119], v[28:31], a[128:131], v[116:119]
  ds_read_b128 v[152:155], v178 offset:40960
  v_accvgpr_read_b32 v221, a212
  v_accvgpr_read_b32 v222, a213
  v_mfma_f32_16x16x32_bf16 v[56:59], a[120:123], v[120:123], v[56:59]
  ds_read_b128 v[156:159], v178 offset:43008
  v_accvgpr_read_b32 v223, a214
  v_accvgpr_read_b32 v224, a215
  v_mfma_f32_16x16x32_bf16 v[60:63], a[124:127], v[120:123], v[60:63]
  v_accvgpr_read_b32 v220, a200
  v_cndmask_b32 v205, v205, v206, s[72:73]
  v_mfma_f32_16x16x32_bf16 v[64:67], v[120:123], a[128:131], v[64:67]
  v_cndmask_b32 v207, v207, v208, s[72:73]
  v_cndmask_b32 v213, v213, v214, s[72:73]
  v_mfma_f32_16x16x32_bf16 v[68:71], a[120:123], v[124:127], v[68:71]
  v_cndmask_b32 v215, v215, v216, s[72:73]
  v_cndmask_b32 v221, v221, v222, s[72:73]
  v_mfma_f32_16x16x32_bf16 v[72:75], a[124:127], v[124:127], v[72:75]
  v_cndmask_b32 v223, v223, v224, s[72:73]
  v_cndmask_b32 v205, v205, v207, s[80:81]
  v_mfma_f32_16x16x32_bf16 v[76:79], v[124:127], a[128:131], v[76:79]
  v_cndmask_b32 v213, v213, v215, s[80:81]
  v_cndmask_b32 v221, v221, v223, s[80:81]
  v_mfma_f32_16x16x32_bf16 v[80:83], a[120:123], v[128:131], v[80:83]
  v_mfma_f32_16x16x32_bf16 v[84:87], a[124:127], v[128:131], v[84:87]
  buffer_load_dword v189, v27, s[40:43], 0 offen sc1
  v_mfma_f32_16x16x32_bf16 v[88:91], v[128:131], a[128:131], v[88:91]
  s_mov_b32 exec_lo, 0x00f0000f
  s_mov_b32 exec_hi, 0xf0000f00
  ds_write2_b32 v200, v204, v205 offset0:0 offset1:32
  ds_write2_b32 v200, v212, v213 offset0:16 offset1:48
  ds_write2_b32 v201, v220, v221 offset0:144 offset1:176
  s_mov_b64 exec, -1
  v_mfma_f32_16x16x32_bf16 v[92:95], a[120:123], v[132:135], v[92:95]
  v_mfma_f32_16x16x32_bf16 v[96:99], a[124:127], v[132:135], v[96:99]
  v_mfma_f32_16x16x32_bf16 v[100:103], v[132:135], a[128:131], v[100:103]
  v_mfma_f32_16x16x32_bf16 v[108:111], a[124:127], v[136:139], v[108:111]
  v_mfma_f32_16x16x32_bf16 v[112:115], v[136:139], a[128:131], v[112:115]
  s_waitcnt lgkmcnt(3)
  v_mfma_f32_16x16x32_bf16 v[32:35], a[132:135], v[28:31], v[32:35]
  s_waitcnt lgkmcnt(0)
  s_barrier
  v_mfma_f32_16x16x32_bf16 v[36:39], a[136:139], v[28:31], v[36:39]
  ds_read_b32 v204, v202 offset:1024
  ds_read_b32 v205, v202 offset:1792
  v_mfma_f32_16x16x32_bf16 v[116:119], v[28:31], a[140:143], v[116:119]
  v_mfma_f32_16x16x32_bf16 v[56:59], a[132:135], v[140:143], v[56:59]
  v_mfma_f32_16x16x32_bf16 v[60:63], a[136:139], v[140:143], v[60:63]
  v_mfma_f32_16x16x32_bf16 v[64:67], v[140:143], a[140:143], v[64:67]
  v_mfma_f32_16x16x32_bf16 v[68:71], a[132:135], v[144:147], v[68:71]
  v_mfma_f32_16x16x32_bf16 v[72:75], a[136:139], v[144:147], v[72:75]
  v_mfma_f32_16x16x32_bf16 v[76:79], v[144:147], a[140:143], v[76:79]
  v_mfma_f32_16x16x32_bf16 v[80:83], a[132:135], v[148:151], v[80:83]
  v_mfma_f32_16x16x32_bf16 v[84:87], a[136:139], v[148:151], v[84:87]
  s_waitcnt lgkmcnt(0)
  v_add_f32 v204, v204, v205
  v_mfma_f32_16x16x32_bf16 v[88:91], v[148:151], a[140:143], v[88:91]
  v_mov_b32 v205, v204
  v_mfma_f32_16x16x32_bf16 v[92:95], a[132:135], v[152:155], v[92:95]
  s_nop 0
  v_permlane32_swap_b32 v204, v205
  v_mfma_f32_16x16x32_bf16 v[96:99], a[136:139], v[152:155], v[96:99]
  v_mul_f32 v206, 0x3b000000, v204
  v_mul_f32 v205, 0x3b000000, v205
  v_mfma_f32_16x16x32_bf16 v[100:103], v[152:155], a[140:143], v[100:103]
  v_fma_f32 v205, -v206, v206, v205
  v_mfma_f32_16x16x32_bf16 v[108:111], a[136:139], v[156:159], v[108:111]
  v_max_f32 v205, 0, v205
  v_mfma_f32_16x16x32_bf16 v[112:115], v[156:159], a[140:143], v[112:115]
  v_add_f32 v207, 0x3727c5ac, v205
  v_rsq_f32 v208, v207
  s_nop 0
  v_cndmask_b32 v206, v206, v208, s[78:79]
  ds_write_b32 v202, v206
  s_branch L_join
L_code_end:
.if (L_code_end - interleave_layers__sliding_local_dilated__geglu_ffn__prompt_kernel) < 65600
.fill (65600 - (L_code_end - interleave_layers__sliding_local_dilated__geglu_ffn__prompt_kernel)) / 4, 4, 0xbf810000
.else
.if (L_code_end - interleave_layers__sliding_local_dilated__geglu_ffn__prompt_kernel) > 67584
.error "code prefetch does not cover the code"
.endif
.endif
.section .rodata,"a"
.p2align 6
.amdhsa_kernel interleave_layers__sliding_local_dilated__geglu_ffn__prompt_kernel
  .amdhsa_next_free_vgpr 512
  .amdhsa_next_free_sgpr 102
  .amdhsa_accum_offset 256
  .amdhsa_group_segment_fixed_size 0
  .amdhsa_kernarg_size 80
  .amdhsa_user_sgpr_count 2
  .amdhsa_user_sgpr_kernarg_segment_ptr 1
  .amdhsa_system_sgpr_workgroup_id_x 1
  .amdhsa_float_denorm_mode_32 3
.end_amdhsa_kernel
```
